```python
import torch

def _softmax(x, axis=-1):
    return torch.softmax(x, dim=axis)
def _gelu(x):
    return torch.nn.functional.gelu(x, approximate="tanh")
def _silu(x):
    return torch.nn.functional.silu(x)
def _sigmoid(x):
    return torch.sigmoid(x)
def _layernorm(x, axis=-1, eps=1e-5):
    m = x.mean(dim=axis, keepdim=True)
    v = x.var(dim=axis, keepdim=True, unbiased=False)
    return (x - m) / torch.sqrt(v + eps)
def _scatter_add(tgt, idx, src, axis=0):
    return tgt.clone().index_add_(axis, idx, src)
def _segment_sum(src, seg, n):
    out = torch.zeros((n,) + src.shape[1:], dtype=src.dtype)
    return out.index_add_(0, seg, src)
def _pad(x, pw):
    flat = tuple(v for pair in reversed(pw) for v in pair)
    return torch.nn.functional.pad(x, flat)

kernel_name = 'parallel_sum__spectral_gfnet__dense_activation_silu__prompt'

def setup_inputs():

    _w = (lambda a: (lambda t: t.to(torch.bfloat16) if t.is_floating_point() else t)(torch.as_tensor(a)))
    def _A_setup():
        B, S, D = 1, 2048, 576
        Df = D // 2 + 1
        return {
            "x": _w((lambda *s: torch.randn(*s, dtype=torch.bfloat16) * 0.05)(B, S, D)),
            "w_r": _w((lambda *s: torch.randn(*s, dtype=torch.bfloat16) * 0.8)(S, Df) * 0.02),
            "w_i": _w((lambda *s: torch.randn(*s, dtype=torch.bfloat16) * 0.8)(S, Df) * 0.02),
        }
    _A_in = _A_setup()

    def _B_setup():
        B, S, D, F = 1, 2048, 576, 4608
        return {
            "x": _w((lambda *s: torch.randn(*s, dtype=torch.bfloat16) * 0.05)(B, S, D)),
            "w1": _w((lambda *s: torch.randn(*s, dtype=torch.bfloat16) * 0.8)(D, F) * (D ** -0.5)),
            "w2": _w((lambda *s: torch.randn(*s, dtype=torch.bfloat16) * 0.1)(F, D) * (F ** -0.5)),
        }
    _B_in = _B_setup()

    return {
        "A_x": _A_in["x"],
        "A_w_r": _A_in["w_r"],
        "A_w_i": _A_in["w_i"],
        "B_x": _B_in["x"],
        "B_w1": _B_in["w1"],
        "B_w2": _B_in["w2"],
    }

def reference(A_x, A_w_r, A_w_i, B_x, B_w1, B_w2):
    def _A_ref(x, w_r, w_i):
        B, S, D = x.shape
        X = (lambda x, axes=(-2,-1): torch.fft.rfft2(x.float(), dim=axes))(x, axes=(-2, -1))
        W = w_r + 1j * w_i
        X = X * W
        y = (lambda x, s, axes=(-2,-1): torch.fft.irfft2(x, s=s, dim=axes).to(torch.bfloat16))(X, (S, D), axes=(-2, -1))
        return y

    def _B_ref(x, w1, w2):
        h = torch.einsum("bsd,df->bsf", x, w1)
        h = _silu(h)
        out = torch.einsum("bsf,fd->bsd", h, w2)
        return out

    x = A_x
    xn = _layernorm(x, axis=-1)
    return x + _A_ref(xn, A_w_r, A_w_i) + _B_ref(xn, B_w1, B_w2)
```

```asm
; @launch grid=(256,1,1) block=(512,1,1) lds=163840
.amdgcn_target "amdgcn-amd-amdhsa--gfx950"
.text
.globl parallel_sum__spectral_gfnet__dense_activation_silu__prompt_kernel
.p2align 8
.type parallel_sum__spectral_gfnet__dense_activation_silu__prompt_kernel,@function
parallel_sum__spectral_gfnet__dense_activation_silu__prompt_kernel:
  s_cmp_ge_u32 s2, 256
  s_cbranch_scc1 L_end
  s_load_dwordx16 s[4:19], s[0:1], 0
  s_load_dwordx2 s[20:21], s[0:1], 64
  s_getpc_b64 s[22:23]
L_pc:
  s_add_u32 s22, s22, parallel_sum__spectral_gfnet__dense_activation_silu__prompt_kernel-L_pc
  s_addc_u32 s23, s23, -1
  s_lshr_b32 s24, s2, 3
  s_and_b32 s24, s24, 15
  s_lshl_b32 s24, s24, 12
  v_lshrrev_b32 v9, 4, v0
  v_lshl_add_u32 v9, v9, 7, s24
  v_min_u32 v9, L_end-parallel_sum__spectral_gfnet__dense_activation_silu__prompt_kernel, v9
  global_load_dword v147, v9, s[22:23]
  v_lshrrev_b32 v4, 6, v0
  v_and_b32 v5, 63, v0
  v_readfirstlane_b32 s59, v4
  s_and_b32 s62, s2, 1
  s_mul_i32 s62, s62, 16
  s_lshr_b32 s57, s2, 4
  s_add_u32 s57, s57, s62
  s_and_b32 s56, s2, 6
  s_bfe_u32 s62, s2, 65539
  s_add_u32 s56, s56, s62
  v_lshrrev_b32 v6, 3, v5
  v_and_b32 v7, 7, v5
  v_mul_u32_u24 v8, 36864, v6
  v_lshl_add_u32 v8, v7, 4, v8
  v_mov_b32 v161, v6
  v_mov_b32 v162, v7
  s_lshl_b32 s3, s59, 8
  s_add_u32 s3, s3, s57
  s_mul_i32 s3, s3, 1152
  s_waitcnt lgkmcnt(0)
  s_mov_b32 s24, s4
  s_mov_b32 s25, s5
  s_mov_b32 s26, 2359296
  s_mov_b32 s27, 0x00020000
  buffer_load_dwordx4 v[112:115], v8, s[24:27], s3 offen offset:0
  buffer_load_dwordx4 v[116:119], v8, s[24:27], s3 offen offset:128
  buffer_load_dwordx4 v[120:123], v8, s[24:27], s3 offen offset:256
  buffer_load_dwordx4 v[124:127], v8, s[24:27], s3 offen offset:384
  buffer_load_dwordx4 v[128:131], v8, s[24:27], s3 offen offset:512
  buffer_load_dwordx4 v[132:135], v8, s[24:27], s3 offen offset:640
  buffer_load_dwordx4 v[136:139], v8, s[24:27], s3 offen offset:768
  buffer_load_dwordx4 v[140:143], v8, s[24:27], s3 offen offset:896
  buffer_load_dwordx4 v[144:147], v8, s[24:27], s3 offen offset:1024
  s_mov_b32 s28, s12
  s_mov_b32 s29, s13
  s_mov_b32 s30, 5308416
  s_mov_b32 s31, 0x00020000
  s_mov_b32 s32, s14
  s_mov_b32 s33, s15
  s_mov_b32 s34, 5308416
  s_mov_b32 s35, 0x00020000
  s_mov_b32 s36, s20
  s_mov_b32 s37, s21
  s_mov_b32 s38, 268435456
  s_mov_b32 s39, 0x00020000
  s_mov_b32 s40, s16
  s_mov_b32 s41, s17
  s_mov_b32 s42, 2359296
  s_mov_b32 s43, 0x00020000
  s_mov_b32 s44, s6
  s_mov_b32 s45, s7
  s_mov_b32 s46, 1183744
  s_mov_b32 s47, 0x00020000
  s_mov_b32 s48, s8
  s_mov_b32 s49, s9
  s_mov_b32 s50, 1183744
  s_mov_b32 s51, 0x00020000
  s_mov_b32 s52, s18
  s_mov_b32 s53, s19
  s_mov_b32 s54, 256
  s_mov_b32 s55, 0x00020000
  s_add_u32 s58, s56, s57
  s_and_b32 s58, s58, 7
  s_and_b32 s60, s59, 3
  s_mov_b32 s70, 0x3f803f80
  s_mov_b32 s71, 0xffff0000
  s_cmp_lt_u32 s59, 4
  s_cbranch_scc1 L_helper
  s_cmp_eq_u32 s60, 0
  s_cbranch_scc0 L_noclear
  s_lshl_b32 s62, s56, 5
  s_add_u32 s62, s62, s57
  s_lshl_b32 s62, s62, 2
  s_lshl_b32 s63, s56, 2
  s_mul_i32 s64, s57, 1152
  s_add_u32 s63, s63, s64
  s_add_u32 s63, s63, 8192
  v_lshlrev_b32 v10, 7, v5
  v_add_u32 v10, s63, v10
  v_subrev_u32 v11, 9, v5
  v_lshlrev_b32 v11, 10, v11
  v_add_u32 v11, s62, v11
  v_cmp_gt_u32 vcc, 9, v5
  v_mov_b32 v12, 0
  s_mov_b64 exec, 2047
  v_cndmask_b32 v10, v11, v10, vcc
  buffer_store_dword v12, v10, s[36:39], 0 offen sc1
  s_mov_b64 exec, -1
L_noclear:
  s_lshl_b32 s75, s56, 5
  s_add_u32 s75, s75, s57
  s_lshl_b32 s75, s75, 2
  s_lshl_b32 s74, s57, 3
  s_add_u32 s74, s74, s56
  s_mul_i32 s74, s74, 73728
  s_add_u32 s74, s74, 7929856
  s_lshl_b32 s62, s56, 2
  s_mul_i32 s77, s57, 1152
  s_add_u32 s77, s77, s62
  s_add_u32 s77, s77, 8192
  s_cmp_eq_u32 s60, 0
  s_cselect_b32 s78, 1, 0
  s_mov_b32 s79, 0
  s_and_b32 s72, s60, 1
  s_lshr_b32 s73, s60, 1
  v_mov_b32 v106, v5
  v_lshrrev_b32 v102, 5, v106
  v_bfe_u32 v103, v106, 2, 2
  v_lshrrev_b32 v104, 1, v103
  v_xor_b32 v104, s72, v104
  v_lshlrev_b32 v104, 6, v104
  v_bfe_u32 v105, v106, 4, 1
  v_lshl_add_u32 v104, v105, 5, v104
  v_and_b32 v105, 3, v106
  v_lshl_add_u32 v104, v105, 3, v104
  v_lshl_add_u32 v104, v103, 7, v104
  v_add_u32 v104, 73728, v104
  v_lshl_add_u32 v4, v102, 10, v104
  v_lshl_add_u32 v6, v102, 9, v104
  v_add_u32 v5, 57344, v4
  v_add_u32 v7, 57344, v6
  s_lshl_b32 s62, s73, 11
  v_and_b32 v104, 31, v106
  v_add_u32 v105, 0, v102
  v_xor_b32 v105, v105, v104
  v_lshlrev_b32 v105, 4, v105
  v_lshl_add_u32 v105, v102, 9, v105
  v_add_u32 v8, s62, v105
  v_add_u32 v20, 57344, v8
  v_add_u32 v105, 2, v102
  v_xor_b32 v105, v105, v104
  v_lshlrev_b32 v105, 4, v105
  v_lshl_add_u32 v105, v102, 9, v105
  v_add_u32 v9, s62, v105
  v_add_u32 v21, 57344, v9
  v_add_u32 v105, 4, v102
  v_xor_b32 v105, v105, v104
  v_lshlrev_b32 v105, 4, v105
  v_lshl_add_u32 v105, v102, 9, v105
  v_add_u32 v10, s62, v105
  v_add_u32 v22, 57344, v10
  v_add_u32 v105, 6, v102
  v_xor_b32 v105, v105, v104
  v_lshlrev_b32 v105, 4, v105
  v_lshl_add_u32 v105, v102, 9, v105
  v_add_u32 v11, s62, v105
  v_add_u32 v23, 57344, v11
  v_lshlrev_b32 v104, 4, v106
  v_add_u32 v14, s62, v104
  v_add_u32 v15, 57344, v14
  s_lshl_b32 s63, s72, 12
  v_add_u32 v12, s63, v14
  v_add_u32 v13, 57344, v12
  s_lshl_b32 s63, s60, 11
  v_add_u32 v28, s63, v104
  v_mov_b32 v30, 0
  v_mov_b32 v31, 1
  s_mul_i32 s62, s56, 36
  s_cmp_eq_u32 s56, 7
  s_cselect_b32 s63, 3, 0
  s_sub_u32 s62, s62, s63
  s_lshl_b32 s63, s72, 4
  s_add_u32 s62, s62, s63
  v_and_b32 v99, 15, v106
  v_add_u32 v98, s62, v99
  v_add_u32 v99, s63, v99
  s_cmp_eq_u32 s56, 7
  s_cselect_b32 s64, 3, 0
  s_cselect_b32 s65, 37, 36
  v_mov_b32 v101, 0x35e38e39
  v_mov_b32 v100, 0x35638e39
  v_cmp_eq_u32 vcc, 0, v98
  s_nop 1
  v_cndmask_b32 v101, v101, v100, vcc
  v_cmp_eq_u32 vcc, 0x120, v98
  s_nop 1
  v_cndmask_b32 v101, v101, v100, vcc
  v_subrev_u32 v100, s64, v99
  v_cmp_gt_u32 vcc, s65, v100
  s_nop 1
  v_cndmask_b32 v101, 0, v101, vcc
  v_lshlrev_b32 v29, 31, v98
  v_or_b32 v29, 1.0, v29
  v_cvt_f32_u32 v98, v98
  v_mul_f32 v98, 0x3ae38e39, v98
  v_bfe_u32 v99, v106, 4, 1
  v_cvt_f32_u32 v99, v99
  v_mul_f32 v99, 0x3e800000, v99
  v_lshrrev_b32 v100, 5, v106
  v_lshlrev_b32 v100, 3, v100
  v_cvt_f32_u32 v100, v100
  v_fmac_f32 v99, v98, v100
  v_mul_f32 v16, 0x41800000, v98
  v_add_f32 v72, v99, v16
  v_cos_f32 v16, v16
  v_cos_f32 v100, v98
  v_add_f32 v65, v99, v98
  v_add_f32 v73, v72, v98
  v_add_f32 v16, v16, v16
  v_add_f32 v100, v100, v100
  v_cos_f32 v64, v99
  v_cos_f32 v65, v65
  v_cos_f32 v72, v72
  v_cos_f32 v73, v73
  v_sub_f32 v17, 0, v16
  v_mul_f32 v64, v101, v64
  v_mul_f32 v65, v101, v65
  v_mul_f32 v72, v101, v72
  v_mul_f32 v73, v101, v73
  v_fma_f32 v66, v100, v65, -v64
  v_fma_f32 v74, v100, v73, -v72
  v_fma_f32 v67, v100, v66, -v65
  v_fma_f32 v75, v100, v74, -v73
  v_fma_f32 v68, v100, v67, -v66
  v_fma_f32 v76, v100, v75, -v74
  v_fma_f32 v69, v100, v68, -v67
  v_fma_f32 v77, v100, v76, -v75
  v_fma_f32 v70, v100, v69, -v68
  v_fma_f32 v78, v100, v77, -v76
  v_fma_f32 v71, v100, v70, -v69
  v_fma_f32 v79, v100, v78, -v77
  v_and_b32 v3, 15, v106
  v_lshlrev_b32 v3, 4, v3
  v_lshrrev_b32 v98, 5, v106
  v_lshl_add_u32 v3, v98, 8, v3
  v_bfe_u32 v98, v106, 4, 1
  v_lshl_add_u32 v3, v98, 11, v3
  s_lshl_b32 s62, s72, 12
  s_lshl_b32 s63, s73, 10
  s_add_u32 s62, s62, s63
  s_add_u32 s62, s62, 147456
  v_add_u32 v3, s62, v3
  v_cvt_pk_bf16_f32 v32, v64, v65
  v_cvt_pk_bf16_f32 v33, v66, v67
  v_cvt_pk_bf16_f32 v34, v68, v69
  v_cvt_pk_bf16_f32 v35, v70, v71
  v_cvt_pk_bf16_f32 v36, v72, v73
  v_cvt_pk_bf16_f32 v37, v74, v75
  v_cvt_pk_bf16_f32 v38, v76, v77
  v_cvt_pk_bf16_f32 v39, v78, v79
  s_lshr_b32 s62, s59, 2
  s_lshl_b32 s62, s62, 11
  s_lshl_b32 s63, s60, 7
  s_add_u32 s62, s62, s63
  v_xor_b32 v158, v161, v162
  v_lshlrev_b32 v158, 4, v158
  v_and_b32 v150, 3, v162
  v_lshl_add_u32 v158, v150, 9, v158
  v_lshrrev_b32 v150, 2, v162
  v_lshl_add_u32 v158, v150, 12, v158
  v_add_u32 v158, s62, v158
  v_add_u32 v159, 8192, v158
  s_waitcnt vmcnt(8)
  v_dot2_f32_bf16 v148, v112, s70, 0
  v_dot2_f32_bf16 v149, v112, v112, 0
  v_dot2_f32_bf16 v148, v113, s70, v148
  v_dot2_f32_bf16 v149, v113, v113, v149
  v_dot2_f32_bf16 v148, v114, s70, v148
  v_dot2_f32_bf16 v149, v114, v114, v149
  v_dot2_f32_bf16 v148, v115, s70, v148
  v_dot2_f32_bf16 v149, v115, v115, v149
  s_waitcnt vmcnt(7)
  v_dot2_f32_bf16 v148, v116, s70, v148
  v_dot2_f32_bf16 v149, v116, v116, v149
  v_dot2_f32_bf16 v148, v117, s70, v148
  v_dot2_f32_bf16 v149, v117, v117, v149
  v_dot2_f32_bf16 v148, v118, s70, v148
  v_dot2_f32_bf16 v149, v118, v118, v149
  v_dot2_f32_bf16 v148, v119, s70, v148
  v_dot2_f32_bf16 v149, v119, v119, v149
  s_waitcnt vmcnt(6)
  v_dot2_f32_bf16 v148, v120, s70, v148
  v_dot2_f32_bf16 v149, v120, v120, v149
  v_dot2_f32_bf16 v148, v121, s70, v148
  v_dot2_f32_bf16 v149, v121, v121, v149
  v_dot2_f32_bf16 v148, v122, s70, v148
  v_dot2_f32_bf16 v149, v122, v122, v149
  v_dot2_f32_bf16 v148, v123, s70, v148
  v_dot2_f32_bf16 v149, v123, v123, v149
  s_waitcnt vmcnt(5)
  v_dot2_f32_bf16 v148, v124, s70, v148
  v_dot2_f32_bf16 v149, v124, v124, v149
  v_dot2_f32_bf16 v148, v125, s70, v148
  v_dot2_f32_bf16 v149, v125, v125, v149
  v_dot2_f32_bf16 v148, v126, s70, v148
  v_dot2_f32_bf16 v149, v126, v126, v149
  v_dot2_f32_bf16 v148, v127, s70, v148
  v_dot2_f32_bf16 v149, v127, v127, v149
  s_waitcnt vmcnt(4)
  v_dot2_f32_bf16 v148, v128, s70, v148
  v_dot2_f32_bf16 v149, v128, v128, v149
  v_dot2_f32_bf16 v148, v129, s70, v148
  v_dot2_f32_bf16 v149, v129, v129, v149
  v_dot2_f32_bf16 v148, v130, s70, v148
  v_dot2_f32_bf16 v149, v130, v130, v149
  v_dot2_f32_bf16 v148, v131, s70, v148
  v_dot2_f32_bf16 v149, v131, v131, v149
  s_waitcnt vmcnt(3)
  v_dot2_f32_bf16 v148, v132, s70, v148
  v_dot2_f32_bf16 v149, v132, v132, v149
  v_dot2_f32_bf16 v148, v133, s70, v148
  v_dot2_f32_bf16 v149, v133, v133, v149
  v_dot2_f32_bf16 v148, v134, s70, v148
  v_dot2_f32_bf16 v149, v134, v134, v149
  v_dot2_f32_bf16 v148, v135, s70, v148
  v_dot2_f32_bf16 v149, v135, v135, v149
  s_waitcnt vmcnt(2)
  v_dot2_f32_bf16 v148, v136, s70, v148
  v_dot2_f32_bf16 v149, v136, v136, v149
  v_dot2_f32_bf16 v148, v137, s70, v148
  v_dot2_f32_bf16 v149, v137, v137, v149
  v_dot2_f32_bf16 v148, v138, s70, v148
  v_dot2_f32_bf16 v149, v138, v138, v149
  v_dot2_f32_bf16 v148, v139, s70, v148
  v_dot2_f32_bf16 v149, v139, v139, v149
  s_waitcnt vmcnt(1)
  v_dot2_f32_bf16 v148, v140, s70, v148
  v_dot2_f32_bf16 v149, v140, v140, v149
  v_dot2_f32_bf16 v148, v141, s70, v148
  v_dot2_f32_bf16 v149, v141, v141, v149
  v_dot2_f32_bf16 v148, v142, s70, v148
  v_dot2_f32_bf16 v149, v142, v142, v149
  v_dot2_f32_bf16 v148, v143, s70, v148
  v_dot2_f32_bf16 v149, v143, v143, v149
  s_waitcnt vmcnt(0)
  v_dot2_f32_bf16 v148, v144, s70, v148
  v_dot2_f32_bf16 v149, v144, v144, v149
  v_dot2_f32_bf16 v148, v145, s70, v148
  v_dot2_f32_bf16 v149, v145, v145, v149
  v_dot2_f32_bf16 v148, v146, s70, v148
  v_dot2_f32_bf16 v149, v146, v146, v149
  v_dot2_f32_bf16 v148, v147, s70, v148
  v_dot2_f32_bf16 v149, v147, v147, v149
  s_nop 1
  v_add_f32_dpp v148, v148, v148 quad_perm:[1,0,3,2] row_mask:0xf bank_mask:0xf
  v_add_f32_dpp v149, v149, v149 quad_perm:[1,0,3,2] row_mask:0xf bank_mask:0xf
  s_nop 0
  v_add_f32_dpp v148, v148, v148 quad_perm:[2,3,0,1] row_mask:0xf bank_mask:0xf
  v_add_f32_dpp v149, v149, v149 quad_perm:[2,3,0,1] row_mask:0xf bank_mask:0xf
  s_nop 0
  v_add_f32_dpp v148, v148, v148 row_half_mirror row_mask:0xf bank_mask:0xf
  v_add_f32_dpp v149, v149, v149 row_half_mirror row_mask:0xf bank_mask:0xf
  v_mul_f32 v148, 0x3ae38e39, v148
  v_mul_f32 v149, 0x3ae38e39, v149
  v_fma_f32 v149, -v148, v148, v149
  v_max_f32 v149, 0, v149
  v_add_f32 v149, 0x3727c5ac, v149
  v_rsq_f32 v149, v149
  s_nop 0
  v_mul_f32 v149, 0x3fb8aa3b, v149
  v_cvt_pk_bf16_f32 v149, v149, 0
  v_lshlrev_b32 v160, 16, v149
  v_mul_f32 v148, -v148, v160
  v_dot2_f32_bf16 v150, v112, v149, v148
  v_dot2_f32_bf16 v151, v112, v160, v148
  v_dot2_f32_bf16 v152, v113, v149, v148
  v_dot2_f32_bf16 v153, v113, v160, v148
  v_dot2_f32_bf16 v154, v114, v149, v148
  v_dot2_f32_bf16 v155, v114, v160, v148
  v_dot2_f32_bf16 v156, v115, v149, v148
  v_dot2_f32_bf16 v157, v115, v160, v148
  v_cvt_pk_bf16_f32 v112, v150, v151
  v_cvt_pk_bf16_f32 v113, v152, v153
  v_cvt_pk_bf16_f32 v114, v154, v155
  v_cvt_pk_bf16_f32 v115, v156, v157
  ds_write_b128 v158, v[112:115] offset:0
  v_dot2_f32_bf16 v150, v116, v149, v148
  v_dot2_f32_bf16 v151, v116, v160, v148
  v_dot2_f32_bf16 v152, v117, v149, v148
  v_dot2_f32_bf16 v153, v117, v160, v148
  v_dot2_f32_bf16 v154, v118, v149, v148
  v_dot2_f32_bf16 v155, v118, v160, v148
  v_dot2_f32_bf16 v156, v119, v149, v148
  v_dot2_f32_bf16 v157, v119, v160, v148
  v_cvt_pk_bf16_f32 v116, v150, v151
  v_cvt_pk_bf16_f32 v117, v152, v153
  v_cvt_pk_bf16_f32 v118, v154, v155
  v_cvt_pk_bf16_f32 v119, v156, v157
  ds_write_b128 v158, v[116:119] offset:8192
  v_dot2_f32_bf16 v150, v120, v149, v148
  v_dot2_f32_bf16 v151, v120, v160, v148
  v_dot2_f32_bf16 v152, v121, v149, v148
  v_dot2_f32_bf16 v153, v121, v160, v148
  v_dot2_f32_bf16 v154, v122, v149, v148
  v_dot2_f32_bf16 v155, v122, v160, v148
  v_dot2_f32_bf16 v156, v123, v149, v148
  v_dot2_f32_bf16 v157, v123, v160, v148
  v_cvt_pk_bf16_f32 v120, v150, v151
  v_cvt_pk_bf16_f32 v121, v152, v153
  v_cvt_pk_bf16_f32 v122, v154, v155
  v_cvt_pk_bf16_f32 v123, v156, v157
  ds_write_b128 v158, v[120:123] offset:16384
  v_dot2_f32_bf16 v150, v124, v149, v148
  v_dot2_f32_bf16 v151, v124, v160, v148
  v_dot2_f32_bf16 v152, v125, v149, v148
  v_dot2_f32_bf16 v153, v125, v160, v148
  v_dot2_f32_bf16 v154, v126, v149, v148
  v_dot2_f32_bf16 v155, v126, v160, v148
  v_dot2_f32_bf16 v156, v127, v149, v148
  v_dot2_f32_bf16 v157, v127, v160, v148
  v_cvt_pk_bf16_f32 v124, v150, v151
  v_cvt_pk_bf16_f32 v125, v152, v153
  v_cvt_pk_bf16_f32 v126, v154, v155
  v_cvt_pk_bf16_f32 v127, v156, v157
  ds_write_b128 v158, v[124:127] offset:24576
  v_dot2_f32_bf16 v150, v128, v149, v148
  v_dot2_f32_bf16 v151, v128, v160, v148
  v_dot2_f32_bf16 v152, v129, v149, v148
  v_dot2_f32_bf16 v153, v129, v160, v148
  v_dot2_f32_bf16 v154, v130, v149, v148
  v_dot2_f32_bf16 v155, v130, v160, v148
  v_dot2_f32_bf16 v156, v131, v149, v148
  v_dot2_f32_bf16 v157, v131, v160, v148
  v_cvt_pk_bf16_f32 v128, v150, v151
  v_cvt_pk_bf16_f32 v129, v152, v153
  v_cvt_pk_bf16_f32 v130, v154, v155
  v_cvt_pk_bf16_f32 v131, v156, v157
  ds_write_b128 v158, v[128:131] offset:32768
  v_dot2_f32_bf16 v150, v132, v149, v148
  v_dot2_f32_bf16 v151, v132, v160, v148
  v_dot2_f32_bf16 v152, v133, v149, v148
  v_dot2_f32_bf16 v153, v133, v160, v148
  v_dot2_f32_bf16 v154, v134, v149, v148
  v_dot2_f32_bf16 v155, v134, v160, v148
  v_dot2_f32_bf16 v156, v135, v149, v148
  v_dot2_f32_bf16 v157, v135, v160, v148
  v_cvt_pk_bf16_f32 v132, v150, v151
  v_cvt_pk_bf16_f32 v133, v152, v153
  v_cvt_pk_bf16_f32 v134, v154, v155
  v_cvt_pk_bf16_f32 v135, v156, v157
  ds_write_b128 v158, v[132:135] offset:40960
  v_dot2_f32_bf16 v150, v136, v149, v148
  v_dot2_f32_bf16 v151, v136, v160, v148
  v_dot2_f32_bf16 v152, v137, v149, v148
  v_dot2_f32_bf16 v153, v137, v160, v148
  v_dot2_f32_bf16 v154, v138, v149, v148
  v_dot2_f32_bf16 v155, v138, v160, v148
  v_dot2_f32_bf16 v156, v139, v149, v148
  v_dot2_f32_bf16 v157, v139, v160, v148
  v_cvt_pk_bf16_f32 v136, v150, v151
  v_cvt_pk_bf16_f32 v137, v152, v153
  v_cvt_pk_bf16_f32 v138, v154, v155
  v_cvt_pk_bf16_f32 v139, v156, v157
  ds_write_b128 v158, v[136:139] offset:49152
  v_dot2_f32_bf16 v150, v140, v149, v148
  v_dot2_f32_bf16 v151, v140, v160, v148
  v_dot2_f32_bf16 v152, v141, v149, v148
  v_dot2_f32_bf16 v153, v141, v160, v148
  v_dot2_f32_bf16 v154, v142, v149, v148
  v_dot2_f32_bf16 v155, v142, v160, v148
  v_dot2_f32_bf16 v156, v143, v149, v148
  v_dot2_f32_bf16 v157, v143, v160, v148
  v_cvt_pk_bf16_f32 v140, v150, v151
  v_cvt_pk_bf16_f32 v141, v152, v153
  v_cvt_pk_bf16_f32 v142, v154, v155
  v_cvt_pk_bf16_f32 v143, v156, v157
  ds_write_b128 v158, v[140:143] offset:57344
  v_dot2_f32_bf16 v150, v144, v149, v148
  v_dot2_f32_bf16 v151, v144, v160, v148
  v_dot2_f32_bf16 v152, v145, v149, v148
  v_dot2_f32_bf16 v153, v145, v160, v148
  v_dot2_f32_bf16 v154, v146, v149, v148
  v_dot2_f32_bf16 v155, v146, v160, v148
  v_dot2_f32_bf16 v156, v147, v149, v148
  v_dot2_f32_bf16 v157, v147, v160, v148
  v_cvt_pk_bf16_f32 v144, v150, v151
  v_cvt_pk_bf16_f32 v145, v152, v153
  v_cvt_pk_bf16_f32 v146, v154, v155
  v_cvt_pk_bf16_f32 v147, v156, v157
  ds_write_b128 v159, v[144:147] offset:57344
L_c_nosig:
  s_waitcnt lgkmcnt(0)
  s_barrier
  s_waitcnt vmcnt(0)
  s_lshl_b32 s64, s56, 5
  s_mov_b64 exec, s[78:79]
  buffer_atomic_add v31, v30, s[52:55], s64 offen sc1
  s_mov_b64 exec, -1
  ds_read_b128 v[112:115], v8 offset:0
  ds_read_b128 v[184:187], v10 offset:36864
  ds_read_b128 v[116:119], v9 offset:1024
  ds_read_b128 v[188:191], v11 offset:37888
  ds_read_b128 v[120:123], v10 offset:4096
  ds_read_b128 v[192:195], v8 offset:40960
  ds_read_b128 v[124:127], v11 offset:5120
  ds_read_b128 v[196:199], v9 offset:41984
  ds_read_b128 v[128:131], v8 offset:8192
  ds_read_b128 v[200:203], v10 offset:45056
  ds_read_b128 v[132:135], v9 offset:9216
  ds_read_b128 v[204:207], v11 offset:46080
  s_waitcnt lgkmcnt(11)
  v_mfma_f32_32x32x16_bf16 v[80:95], v[112:115], v[32:35], 0
  ds_read_b128 v[136:139], v10 offset:12288
  v_fmac_f32 v64, v17, v72
  v_fmac_f32 v65, v17, v73
  v_fmac_f32 v66, v17, v74
  v_fmac_f32 v67, v17, v75
  v_fmac_f32 v68, v17, v76
  v_fmac_f32 v69, v17, v77
  s_waitcnt lgkmcnt(11)
  v_mfma_f32_32x32x16_bf16 v[96:111], v[184:187], v[32:35], 0
  ds_read_b128 v[208:211], v8 offset:49152
  v_fmac_f32 v70, v17, v78
  v_fmac_f32 v71, v17, v79
  v_cvt_pk_bf16_f32 v40, -v64, -v65
  v_cvt_pk_bf16_f32 v41, -v66, -v67
  v_cvt_pk_bf16_f32 v42, -v68, -v69
  v_cvt_pk_bf16_f32 v43, -v70, -v71
  s_waitcnt lgkmcnt(11)
  v_mfma_f32_32x32x16_bf16 v[80:95], v[116:119], v[36:39], v[80:95]
  ds_read_b128 v[140:143], v11 offset:13312
  v_fmac_f32 v72, v16, v64
  v_fmac_f32 v73, v16, v65
  v_fmac_f32 v74, v16, v66
  v_fmac_f32 v75, v16, v67
  v_fmac_f32 v76, v16, v68
  v_fmac_f32 v77, v16, v69
  s_waitcnt lgkmcnt(11)
  v_mfma_f32_32x32x16_bf16 v[96:111], v[188:191], v[36:39], v[96:111]
  ds_read_b128 v[212:215], v9 offset:50176
  v_fmac_f32 v78, v16, v70
  v_fmac_f32 v79, v16, v71
  v_cvt_pk_bf16_f32 v44, -v72, -v73
  v_cvt_pk_bf16_f32 v45, -v74, -v75
  v_cvt_pk_bf16_f32 v46, -v76, -v77
  v_cvt_pk_bf16_f32 v47, -v78, -v79
  s_waitcnt lgkmcnt(11)
  v_mfma_f32_32x32x16_bf16 v[80:95], v[120:123], v[40:43], v[80:95]
  ds_read_b128 v[144:147], v8 offset:16384
  v_fmac_f32 v64, v17, v72
  v_fmac_f32 v65, v17, v73
  v_fmac_f32 v66, v17, v74
  v_fmac_f32 v67, v17, v75
  v_fmac_f32 v68, v17, v76
  v_fmac_f32 v69, v17, v77
  s_waitcnt lgkmcnt(11)
  v_mfma_f32_32x32x16_bf16 v[96:111], v[192:195], v[40:43], v[96:111]
  ds_read_b128 v[216:219], v10 offset:53248
  v_fmac_f32 v70, v17, v78
  v_fmac_f32 v71, v17, v79
  v_cvt_pk_bf16_f32 v48, v64, v65
  v_cvt_pk_bf16_f32 v49, v66, v67
  v_cvt_pk_bf16_f32 v50, v68, v69
  v_cvt_pk_bf16_f32 v51, v70, v71
  s_waitcnt lgkmcnt(11)
  v_mfma_f32_32x32x16_bf16 v[80:95], v[124:127], v[44:47], v[80:95]
  ds_read_b128 v[148:151], v9 offset:17408
  v_fmac_f32 v72, v16, v64
  v_fmac_f32 v73, v16, v65
  v_fmac_f32 v74, v16, v66
  v_fmac_f32 v75, v16, v67
  v_fmac_f32 v76, v16, v68
  v_fmac_f32 v77, v16, v69
  s_waitcnt lgkmcnt(11)
  v_mfma_f32_32x32x16_bf16 v[96:111], v[196:199], v[44:47], v[96:111]
  ds_read_b128 v[220:223], v11 offset:54272
  v_fmac_f32 v78, v16, v70
  v_fmac_f32 v79, v16, v71
  v_cvt_pk_bf16_f32 v52, v72, v73
  v_cvt_pk_bf16_f32 v53, v74, v75
  v_cvt_pk_bf16_f32 v54, v76, v77
  v_cvt_pk_bf16_f32 v55, v78, v79
  s_waitcnt lgkmcnt(11)
  v_mfma_f32_32x32x16_bf16 v[80:95], v[128:131], v[48:51], v[80:95]
  ds_read_b128 v[152:155], v10 offset:20480
  v_fmac_f32 v64, v17, v72
  v_fmac_f32 v65, v17, v73
  v_fmac_f32 v66, v17, v74
  v_fmac_f32 v67, v17, v75
  v_fmac_f32 v68, v17, v76
  v_fmac_f32 v69, v17, v77
  s_waitcnt lgkmcnt(11)
  v_mfma_f32_32x32x16_bf16 v[96:111], v[200:203], v[48:51], v[96:111]
  ds_read_b128 v[224:227], v20 offset:0
  v_fmac_f32 v70, v17, v78
  v_fmac_f32 v71, v17, v79
  v_cvt_pk_bf16_f32 v56, -v64, -v65
  v_cvt_pk_bf16_f32 v57, -v66, -v67
  v_cvt_pk_bf16_f32 v58, -v68, -v69
  v_cvt_pk_bf16_f32 v59, -v70, -v71
  s_waitcnt lgkmcnt(11)
  v_mfma_f32_32x32x16_bf16 v[80:95], v[132:135], v[52:55], v[80:95]
  ds_read_b128 v[156:159], v11 offset:21504
  v_fmac_f32 v72, v16, v64
  v_fmac_f32 v73, v16, v65
  v_fmac_f32 v74, v16, v66
  v_fmac_f32 v75, v16, v67
  v_fmac_f32 v76, v16, v68
  v_fmac_f32 v77, v16, v69
  s_waitcnt lgkmcnt(11)
  v_mfma_f32_32x32x16_bf16 v[96:111], v[204:207], v[52:55], v[96:111]
  ds_read_b128 v[228:231], v21 offset:1024
  v_fmac_f32 v78, v16, v70
  v_fmac_f32 v79, v16, v71
  v_cvt_pk_bf16_f32 v60, -v72, -v73
  v_cvt_pk_bf16_f32 v61, -v74, -v75
  v_cvt_pk_bf16_f32 v62, -v76, -v77
  v_cvt_pk_bf16_f32 v63, -v78, -v79
  s_waitcnt lgkmcnt(11)
  v_mfma_f32_32x32x16_bf16 v[80:95], v[136:139], v[56:59], v[80:95]
  ds_read_b128 v[160:163], v8 offset:24576
  v_fmac_f32 v64, v17, v72
  v_fmac_f32 v65, v17, v73
  v_fmac_f32 v66, v17, v74
  v_fmac_f32 v67, v17, v75
  v_fmac_f32 v68, v17, v76
  v_fmac_f32 v69, v17, v77
  s_waitcnt lgkmcnt(11)
  v_mfma_f32_32x32x16_bf16 v[96:111], v[208:211], v[56:59], v[96:111]
  ds_read_b128 v[232:235], v22 offset:4096
  v_fmac_f32 v70, v17, v78
  v_fmac_f32 v71, v17, v79
  v_cvt_pk_bf16_f32 v32, v64, v65
  v_cvt_pk_bf16_f32 v33, v66, v67
  v_cvt_pk_bf16_f32 v34, v68, v69
  v_cvt_pk_bf16_f32 v35, v70, v71
  s_waitcnt lgkmcnt(11)
  v_mfma_f32_32x32x16_bf16 v[80:95], v[140:143], v[60:63], v[80:95]
  ds_read_b128 v[164:167], v9 offset:25600
  v_fmac_f32 v72, v16, v64
  v_fmac_f32 v73, v16, v65
  v_fmac_f32 v74, v16, v66
  v_fmac_f32 v75, v16, v67
  v_fmac_f32 v76, v16, v68
  v_fmac_f32 v77, v16, v69
  s_waitcnt lgkmcnt(11)
  v_mfma_f32_32x32x16_bf16 v[96:111], v[212:215], v[60:63], v[96:111]
  ds_read_b128 v[236:239], v23 offset:5120
  v_fmac_f32 v78, v16, v70
  v_fmac_f32 v79, v16, v71
  v_cvt_pk_bf16_f32 v36, v72, v73
  v_cvt_pk_bf16_f32 v37, v74, v75
  v_cvt_pk_bf16_f32 v38, v76, v77
  v_cvt_pk_bf16_f32 v39, v78, v79
  s_waitcnt lgkmcnt(11)
  v_mfma_f32_32x32x16_bf16 v[80:95], v[144:147], v[32:35], v[80:95]
  ds_read_b128 v[168:171], v10 offset:28672
  v_fmac_f32 v64, v17, v72
  v_fmac_f32 v65, v17, v73
  v_fmac_f32 v66, v17, v74
  v_fmac_f32 v67, v17, v75
  v_fmac_f32 v68, v17, v76
  v_fmac_f32 v69, v17, v77
  s_waitcnt lgkmcnt(11)
  v_mfma_f32_32x32x16_bf16 v[96:111], v[216:219], v[32:35], v[96:111]
  ds_read_b128 v[240:243], v20 offset:8192
  v_fmac_f32 v70, v17, v78
  v_fmac_f32 v71, v17, v79
  v_cvt_pk_bf16_f32 v40, -v64, -v65
  v_cvt_pk_bf16_f32 v41, -v66, -v67
  v_cvt_pk_bf16_f32 v42, -v68, -v69
  v_cvt_pk_bf16_f32 v43, -v70, -v71
  s_waitcnt lgkmcnt(11)
  v_mfma_f32_32x32x16_bf16 v[80:95], v[148:151], v[36:39], v[80:95]
  ds_read_b128 v[172:175], v11 offset:29696
  v_fmac_f32 v72, v16, v64
  v_fmac_f32 v73, v16, v65
  v_fmac_f32 v74, v16, v66
  v_fmac_f32 v75, v16, v67
  v_fmac_f32 v76, v16, v68
  v_fmac_f32 v77, v16, v69
  s_waitcnt lgkmcnt(11)
  v_mfma_f32_32x32x16_bf16 v[96:111], v[220:223], v[36:39], v[96:111]
  ds_read_b128 v[244:247], v21 offset:9216
  v_fmac_f32 v78, v16, v70
  v_fmac_f32 v79, v16, v71
  v_cvt_pk_bf16_f32 v44, -v72, -v73
  v_cvt_pk_bf16_f32 v45, -v74, -v75
  v_cvt_pk_bf16_f32 v46, -v76, -v77
  v_cvt_pk_bf16_f32 v47, -v78, -v79
  s_waitcnt lgkmcnt(11)
  v_mfma_f32_32x32x16_bf16 v[80:95], v[152:155], v[40:43], v[80:95]
  ds_read_b128 v[176:179], v8 offset:32768
  v_fmac_f32 v64, v17, v72
  v_fmac_f32 v65, v17, v73
  v_fmac_f32 v66, v17, v74
  v_fmac_f32 v67, v17, v75
  v_fmac_f32 v68, v17, v76
  v_fmac_f32 v69, v17, v77
  s_waitcnt lgkmcnt(11)
  v_mfma_f32_32x32x16_bf16 v[96:111], v[224:227], v[40:43], v[96:111]
  ds_read_b128 v[248:251], v22 offset:12288
  v_fmac_f32 v70, v17, v78
  v_fmac_f32 v71, v17, v79
  v_cvt_pk_bf16_f32 v48, v64, v65
  v_cvt_pk_bf16_f32 v49, v66, v67
  v_cvt_pk_bf16_f32 v50, v68, v69
  v_cvt_pk_bf16_f32 v51, v70, v71
  s_waitcnt lgkmcnt(11)
  v_mfma_f32_32x32x16_bf16 v[80:95], v[156:159], v[44:47], v[80:95]
  ds_read_b128 v[180:183], v9 offset:33792
  v_fmac_f32 v72, v16, v64
  v_fmac_f32 v73, v16, v65
  v_fmac_f32 v74, v16, v66
  v_fmac_f32 v75, v16, v67
  v_fmac_f32 v76, v16, v68
  v_fmac_f32 v77, v16, v69
  s_waitcnt lgkmcnt(11)
  v_mfma_f32_32x32x16_bf16 v[96:111], v[228:231], v[44:47], v[96:111]
  ds_read_b128 v[252:255], v23 offset:13312
  v_fmac_f32 v78, v16, v70
  v_fmac_f32 v79, v16, v71
  v_cvt_pk_bf16_f32 v52, v72, v73
  v_cvt_pk_bf16_f32 v53, v74, v75
  v_cvt_pk_bf16_f32 v54, v76, v77
  v_cvt_pk_bf16_f32 v55, v78, v79
  s_waitcnt lgkmcnt(11)
  v_mfma_f32_32x32x16_bf16 v[80:95], v[160:163], v[48:51], v[80:95]
  v_fmac_f32 v64, v17, v72
  v_fmac_f32 v65, v17, v73
  v_fmac_f32 v66, v17, v74
  v_fmac_f32 v67, v17, v75
  v_fmac_f32 v68, v17, v76
  v_fmac_f32 v69, v17, v77
  s_waitcnt lgkmcnt(10)
  v_mfma_f32_32x32x16_bf16 v[96:111], v[232:235], v[48:51], v[96:111]
  v_fmac_f32 v70, v17, v78
  v_fmac_f32 v71, v17, v79
  v_cvt_pk_bf16_f32 v56, -v64, -v65
  v_cvt_pk_bf16_f32 v57, -v66, -v67
  v_cvt_pk_bf16_f32 v58, -v68, -v69
  v_cvt_pk_bf16_f32 v59, -v70, -v71
  s_waitcnt lgkmcnt(9)
  v_mfma_f32_32x32x16_bf16 v[80:95], v[164:167], v[52:55], v[80:95]
  v_fmac_f32 v72, v16, v64
  v_fmac_f32 v73, v16, v65
  v_fmac_f32 v74, v16, v66
  v_fmac_f32 v75, v16, v67
  v_fmac_f32 v76, v16, v68
  v_fmac_f32 v77, v16, v69
  s_waitcnt lgkmcnt(8)
  v_mfma_f32_32x32x16_bf16 v[96:111], v[236:239], v[52:55], v[96:111]
  v_fmac_f32 v78, v16, v70
  v_fmac_f32 v79, v16, v71
  v_cvt_pk_bf16_f32 v60, -v72, -v73
  v_cvt_pk_bf16_f32 v61, -v74, -v75
  v_cvt_pk_bf16_f32 v62, -v76, -v77
  v_cvt_pk_bf16_f32 v63, -v78, -v79
  s_waitcnt lgkmcnt(7)
  v_mfma_f32_32x32x16_bf16 v[80:95], v[168:171], v[56:59], v[80:95]
  v_fmac_f32 v64, v17, v72
  v_fmac_f32 v65, v17, v73
  v_fmac_f32 v66, v17, v74
  v_fmac_f32 v67, v17, v75
  v_fmac_f32 v68, v17, v76
  v_fmac_f32 v69, v17, v77
  s_waitcnt lgkmcnt(6)
  v_mfma_f32_32x32x16_bf16 v[96:111], v[240:243], v[56:59], v[96:111]
  v_fmac_f32 v70, v17, v78
  v_fmac_f32 v71, v17, v79
  v_cvt_pk_bf16_f32 v32, v64, v65
  v_cvt_pk_bf16_f32 v33, v66, v67
  v_cvt_pk_bf16_f32 v34, v68, v69
  v_cvt_pk_bf16_f32 v35, v70, v71
  s_waitcnt lgkmcnt(5)
  v_mfma_f32_32x32x16_bf16 v[80:95], v[172:175], v[60:63], v[80:95]
  v_fmac_f32 v72, v16, v64
  v_fmac_f32 v73, v16, v65
  v_fmac_f32 v74, v16, v66
  v_fmac_f32 v75, v16, v67
  v_fmac_f32 v76, v16, v68
  v_fmac_f32 v77, v16, v69
  s_waitcnt lgkmcnt(4)
  v_mfma_f32_32x32x16_bf16 v[96:111], v[244:247], v[60:63], v[96:111]
  v_fmac_f32 v78, v16, v70
  v_fmac_f32 v79, v16, v71
  v_cvt_pk_bf16_f32 v36, v72, v73
  v_cvt_pk_bf16_f32 v37, v74, v75
  v_cvt_pk_bf16_f32 v38, v76, v77
  v_cvt_pk_bf16_f32 v39, v78, v79
  s_waitcnt lgkmcnt(3)
  v_mfma_f32_32x32x16_bf16 v[80:95], v[176:179], v[32:35], v[80:95]
  s_waitcnt lgkmcnt(2)
  v_mfma_f32_32x32x16_bf16 v[96:111], v[248:251], v[32:35], v[96:111]
  s_waitcnt lgkmcnt(1)
  v_mfma_f32_32x32x16_bf16 v[80:95], v[180:183], v[36:39], v[80:95]
  s_waitcnt lgkmcnt(0)
  v_mfma_f32_32x32x16_bf16 v[96:111], v[252:255], v[36:39], v[96:111]
  s_nop 11
  v_fmac_f32 v80, v29, v96
  v_fmac_f32 v81, v29, v97
  v_fmac_f32 v82, v29, v98
  v_fmac_f32 v83, v29, v99
  v_fmac_f32 v84, v29, v100
  v_fmac_f32 v85, v29, v101
  v_fmac_f32 v86, v29, v102
  v_fmac_f32 v87, v29, v103
  v_fmac_f32 v88, v29, v104
  v_fmac_f32 v89, v29, v105
  v_fmac_f32 v90, v29, v106
  v_fmac_f32 v91, v29, v107
  v_fmac_f32 v92, v29, v108
  v_fmac_f32 v93, v29, v109
  v_fmac_f32 v94, v29, v110
  v_fmac_f32 v95, v29, v111
  v_cvt_pk_bf16_f32 v32, v80, v81
  v_cvt_pk_bf16_f32 v33, v82, v83
  v_cvt_pk_bf16_f32 v34, v88, v89
  v_cvt_pk_bf16_f32 v35, v90, v91
  ds_write_b128 v3, v[32:35] offset:0
  v_cvt_pk_bf16_f32 v36, v84, v85
  v_cvt_pk_bf16_f32 v37, v86, v87
  v_cvt_pk_bf16_f32 v38, v92, v93
  v_cvt_pk_bf16_f32 v39, v94, v95
  ds_write_b128 v3, v[36:39] offset:512
  s_waitcnt lgkmcnt(0)
  s_barrier
  ds_read_b64_tr_b16 v[32:33], v4 offset:0
  ds_read_b64_tr_b16 v[34:35], v4 offset:512
  ds_read_b64_tr_b16 v[36:37], v4 offset:2048
  ds_read_b64_tr_b16 v[38:39], v4 offset:2560
  ds_read_b64_tr_b16 v[40:41], v4 offset:4096
  ds_read_b64_tr_b16 v[42:43], v4 offset:4608
  ds_read_b64_tr_b16 v[44:45], v4 offset:6144
  ds_read_b64_tr_b16 v[46:47], v4 offset:6656
  ds_read_b64_tr_b16 v[48:49], v4 offset:8192
  ds_read_b64_tr_b16 v[50:51], v4 offset:8704
  ds_read_b64_tr_b16 v[52:53], v4 offset:10240
  ds_read_b64_tr_b16 v[54:55], v4 offset:10752
  s_waitcnt lgkmcnt(10)
  v_mfma_f32_32x32x16_bf16 v[80:95], v[32:35], v[112:115], 0
  s_waitcnt lgkmcnt(8)
  ds_read_b64_tr_b16 v[56:57], v4 offset:12288
  ds_read_b64_tr_b16 v[58:59], v4 offset:12800
  ds_read_b64_tr_b16 v[60:61], v4 offset:14336
  v_mfma_f32_32x32x16_bf16 v[80:95], v[36:39], v[116:119], v[80:95]
  s_waitcnt lgkmcnt(9)
  ds_read_b64_tr_b16 v[62:63], v4 offset:14848
  ds_read_b64_tr_b16 v[64:65], v4 offset:16384
  ds_read_b64_tr_b16 v[66:67], v4 offset:16896
  v_mfma_f32_32x32x16_bf16 v[80:95], v[40:43], v[120:123], v[80:95]
  s_waitcnt lgkmcnt(10)
  ds_read_b64_tr_b16 v[68:69], v4 offset:18432
  ds_read_b64_tr_b16 v[70:71], v4 offset:18944
  ds_read_b64_tr_b16 v[72:73], v4 offset:20480
  v_mfma_f32_32x32x16_bf16 v[80:95], v[44:47], v[124:127], v[80:95]
  s_waitcnt lgkmcnt(11)
  ds_read_b64_tr_b16 v[74:75], v4 offset:20992
  ds_read_b64_tr_b16 v[76:77], v4 offset:22528
  ds_read_b64_tr_b16 v[78:79], v4 offset:23040
  v_mfma_f32_32x32x16_bf16 v[80:95], v[48:51], v[128:131], v[80:95]
  s_waitcnt lgkmcnt(12)
  s_waitcnt lgkmcnt(0)
  s_barrier
  v_mfma_f32_32x32x16_bf16 v[80:95], v[52:55], v[132:135], v[80:95]
  v_mfma_f32_32x32x16_bf16 v[80:95], v[56:59], v[136:139], v[80:95]
  v_mfma_f32_32x32x16_bf16 v[80:95], v[60:63], v[140:143], v[80:95]
  v_mfma_f32_32x32x16_bf16 v[80:95], v[64:67], v[144:147], v[80:95]
  ds_read_b64_tr_b16 v[32:33], v4 offset:24576
  ds_read_b64_tr_b16 v[34:35], v4 offset:25088
  ds_read_b64_tr_b16 v[36:37], v4 offset:26624
  v_mfma_f32_32x32x16_bf16 v[80:95], v[68:71], v[148:151], v[80:95]
  ds_read_b64_tr_b16 v[38:39], v4 offset:27136
  ds_read_b64_tr_b16 v[40:41], v4 offset:28672
  ds_read_b64_tr_b16 v[42:43], v4 offset:29184
  v_mfma_f32_32x32x16_bf16 v[80:95], v[72:75], v[152:155], v[80:95]
  ds_read_b64_tr_b16 v[44:45], v4 offset:30720
  ds_read_b64_tr_b16 v[46:47], v4 offset:31232
  ds_read_b64_tr_b16 v[48:49], v4 offset:32768
  v_mfma_f32_32x32x16_bf16 v[80:95], v[76:79], v[156:159], v[80:95]
  s_waitcnt lgkmcnt(7)
  ds_read_b64_tr_b16 v[50:51], v4 offset:33280
  ds_read_b64_tr_b16 v[52:53], v4 offset:34816
  ds_read_b64_tr_b16 v[54:55], v4 offset:35328
  v_mfma_f32_32x32x16_bf16 v[80:95], v[32:35], v[160:163], v[80:95]
  s_waitcnt lgkmcnt(8)
  ds_read_b64_tr_b16 v[56:57], v4 offset:36864
  ds_read_b64_tr_b16 v[58:59], v4 offset:37376
  ds_read_b64_tr_b16 v[60:61], v4 offset:38912
  v_mfma_f32_32x32x16_bf16 v[80:95], v[36:39], v[164:167], v[80:95]
  s_waitcnt lgkmcnt(9)
  ds_read_b64_tr_b16 v[62:63], v4 offset:39424
  ds_read_b64_tr_b16 v[64:65], v4 offset:40960
  ds_read_b64_tr_b16 v[66:67], v4 offset:41472
  v_mfma_f32_32x32x16_bf16 v[80:95], v[40:43], v[168:171], v[80:95]
  s_waitcnt lgkmcnt(10)
  ds_read_b64_tr_b16 v[68:69], v4 offset:43008
  ds_read_b64_tr_b16 v[70:71], v4 offset:43520
  ds_read_b64_tr_b16 v[72:73], v4 offset:45056
  v_mfma_f32_32x32x16_bf16 v[80:95], v[44:47], v[172:175], v[80:95]
  s_waitcnt lgkmcnt(11)
  ds_read_b64_tr_b16 v[74:75], v4 offset:45568
  ds_read_b64_tr_b16 v[76:77], v4 offset:47104
  ds_read_b64_tr_b16 v[78:79], v4 offset:47616
  v_mfma_f32_32x32x16_bf16 v[80:95], v[48:51], v[176:179], v[80:95]
  s_waitcnt lgkmcnt(12)
  s_waitcnt lgkmcnt(0)
  s_barrier
  v_mfma_f32_32x32x16_bf16 v[80:95], v[52:55], v[180:183], v[80:95]
  v_mfma_f32_32x32x16_bf16 v[80:95], v[56:59], v[184:187], v[80:95]
  v_mfma_f32_32x32x16_bf16 v[80:95], v[60:63], v[188:191], v[80:95]
  v_mfma_f32_32x32x16_bf16 v[80:95], v[64:67], v[192:195], v[80:95]
  ds_read_b64_tr_b16 v[32:33], v4 offset:49152
  ds_read_b64_tr_b16 v[34:35], v4 offset:49664
  ds_read_b64_tr_b16 v[36:37], v4 offset:51200
  v_mfma_f32_32x32x16_bf16 v[80:95], v[68:71], v[196:199], v[80:95]
  ds_read_b64_tr_b16 v[38:39], v4 offset:51712
  ds_read_b64_tr_b16 v[40:41], v4 offset:53248
  ds_read_b64_tr_b16 v[42:43], v4 offset:53760
  v_mfma_f32_32x32x16_bf16 v[80:95], v[72:75], v[200:203], v[80:95]
  ds_read_b64_tr_b16 v[44:45], v4 offset:55296
  ds_read_b64_tr_b16 v[46:47], v4 offset:55808
  ds_read_b64_tr_b16 v[48:49], v5 offset:0
  v_mfma_f32_32x32x16_bf16 v[80:95], v[76:79], v[204:207], v[80:95]
  s_waitcnt lgkmcnt(7)
  ds_read_b64_tr_b16 v[50:51], v5 offset:512
  ds_read_b64_tr_b16 v[52:53], v5 offset:2048
  ds_read_b64_tr_b16 v[54:55], v5 offset:2560
  v_mfma_f32_32x32x16_bf16 v[80:95], v[32:35], v[208:211], v[80:95]
  s_waitcnt lgkmcnt(8)
  ds_read_b64_tr_b16 v[56:57], v5 offset:4096
  ds_read_b64_tr_b16 v[58:59], v5 offset:4608
  ds_read_b64_tr_b16 v[60:61], v5 offset:6144
  v_mfma_f32_32x32x16_bf16 v[80:95], v[36:39], v[212:215], v[80:95]
  s_waitcnt lgkmcnt(9)
  ds_read_b64_tr_b16 v[62:63], v5 offset:6656
  ds_read_b64_tr_b16 v[64:65], v5 offset:8192
  ds_read_b64_tr_b16 v[66:67], v5 offset:8704
  v_mfma_f32_32x32x16_bf16 v[80:95], v[40:43], v[216:219], v[80:95]
  s_waitcnt lgkmcnt(10)
  ds_read_b64_tr_b16 v[68:69], v5 offset:10240
  ds_read_b64_tr_b16 v[70:71], v5 offset:10752
  ds_read_b64_tr_b16 v[72:73], v5 offset:12288
  v_mfma_f32_32x32x16_bf16 v[80:95], v[44:47], v[220:223], v[80:95]
  s_waitcnt lgkmcnt(11)
  ds_read_b64_tr_b16 v[74:75], v5 offset:12800
  ds_read_b64_tr_b16 v[76:77], v5 offset:14336
  ds_read_b64_tr_b16 v[78:79], v5 offset:14848
  v_mfma_f32_32x32x16_bf16 v[80:95], v[48:51], v[224:227], v[80:95]
  s_waitcnt lgkmcnt(12)
  s_waitcnt lgkmcnt(0)
  s_barrier
  s_mov_b32 s63, s75
  s_mov_b64 exec, s[78:79]
  buffer_store_dword v31, v30, s[36:39], s63 offen sc1
  s_mov_b64 exec, -1
  v_mfma_f32_32x32x16_bf16 v[80:95], v[52:55], v[228:231], v[80:95]
  v_mfma_f32_32x32x16_bf16 v[80:95], v[56:59], v[232:235], v[80:95]
  v_mfma_f32_32x32x16_bf16 v[80:95], v[60:63], v[236:239], v[80:95]
  v_mfma_f32_32x32x16_bf16 v[80:95], v[64:67], v[240:243], v[80:95]
  ds_read_b64_tr_b16 v[32:33], v4 offset:0
  ds_read_b64_tr_b16 v[34:35], v4 offset:512
  ds_read_b64_tr_b16 v[36:37], v4 offset:2048
  v_mfma_f32_32x32x16_bf16 v[80:95], v[68:71], v[244:247], v[80:95]
  ds_read_b64_tr_b16 v[38:39], v4 offset:2560
  ds_read_b64_tr_b16 v[40:41], v4 offset:4096
  ds_read_b64_tr_b16 v[42:43], v4 offset:4608
  v_mfma_f32_32x32x16_bf16 v[80:95], v[72:75], v[248:251], v[80:95]
  ds_read_b64_tr_b16 v[44:45], v4 offset:6144
  ds_read_b64_tr_b16 v[46:47], v4 offset:6656
  ds_read_b64_tr_b16 v[48:49], v4 offset:8192
  v_mfma_f32_32x32x16_bf16 v[80:95], v[76:79], v[252:255], v[80:95]
  s_waitcnt lgkmcnt(7)
  ds_read_b64_tr_b16 v[50:51], v4 offset:8704
  ds_read_b64_tr_b16 v[52:53], v4 offset:10240
  ds_read_b64_tr_b16 v[54:55], v4 offset:10752
  v_mfma_f32_32x32x16_bf16 v[96:111], v[32:35], v[112:115], 0
  s_waitcnt lgkmcnt(8)
  ds_read_b64_tr_b16 v[56:57], v4 offset:12288
  ds_read_b64_tr_b16 v[58:59], v4 offset:12800
  ds_read_b64_tr_b16 v[60:61], v4 offset:14336
  v_mfma_f32_32x32x16_bf16 v[96:111], v[36:39], v[116:119], v[96:111]
  s_waitcnt lgkmcnt(9)
  ds_read_b64_tr_b16 v[62:63], v4 offset:14848
  ds_read_b64_tr_b16 v[64:65], v4 offset:16384
  ds_read_b64_tr_b16 v[66:67], v4 offset:16896
  v_exp_f32 v16, -v80
  v_mfma_f32_32x32x16_bf16 v[96:111], v[40:43], v[120:123], v[96:111]
  s_waitcnt lgkmcnt(10)
  ds_read_b64_tr_b16 v[68:69], v4 offset:18432
  ds_read_b64_tr_b16 v[70:71], v4 offset:18944
  ds_read_b64_tr_b16 v[72:73], v4 offset:20480
  v_exp_f32 v17, -v81
  v_mfma_f32_32x32x16_bf16 v[96:111], v[44:47], v[124:127], v[96:111]
  s_waitcnt lgkmcnt(11)
  ds_read_b64_tr_b16 v[74:75], v4 offset:20992
  ds_read_b64_tr_b16 v[76:77], v4 offset:22528
  ds_read_b64_tr_b16 v[78:79], v4 offset:23040
  v_exp_f32 v18, -v82
  v_mfma_f32_32x32x16_bf16 v[96:111], v[48:51], v[128:131], v[96:111]
  s_waitcnt lgkmcnt(12)
  s_waitcnt lgkmcnt(0)
  s_barrier
  v_exp_f32 v19, -v83
  v_add_f32 v16, 1.0, v16
  v_add_f32 v17, 1.0, v17
  v_add_f32 v18, 1.0, v18
  v_add_f32 v19, 1.0, v19
  v_mfma_f32_32x32x16_bf16 v[96:111], v[52:55], v[132:135], v[96:111]
  v_rcp_f32 v16, v16
  v_rcp_f32 v17, v17
  v_rcp_f32 v18, v18
  v_mfma_f32_32x32x16_bf16 v[96:111], v[56:59], v[136:139], v[96:111]
  v_rcp_f32 v19, v19
  v_mul_f32 v16, v80, v16
  v_mul_f32 v17, v81, v17
  v_mul_f32 v18, v82, v18
  v_mul_f32 v19, v83, v19
  v_mfma_f32_32x32x16_bf16 v[96:111], v[60:63], v[140:143], v[96:111]
  v_cvt_pk_bf16_f32 v20, v16, v17
  v_cvt_pk_bf16_f32 v21, v18, v19
  v_exp_f32 v16, -v84
  v_exp_f32 v17, -v85
  v_mfma_f32_32x32x16_bf16 v[96:111], v[64:67], v[144:147], v[96:111]
  ds_read_b64_tr_b16 v[32:33], v4 offset:24576
  ds_read_b64_tr_b16 v[34:35], v4 offset:25088
  ds_read_b64_tr_b16 v[36:37], v4 offset:26624
  v_exp_f32 v18, -v86
  v_mfma_f32_32x32x16_bf16 v[96:111], v[68:71], v[148:151], v[96:111]
  ds_read_b64_tr_b16 v[38:39], v4 offset:27136
  ds_read_b64_tr_b16 v[40:41], v4 offset:28672
  ds_read_b64_tr_b16 v[42:43], v4 offset:29184
  v_exp_f32 v19, -v87
  v_add_f32 v16, 1.0, v16
  v_mfma_f32_32x32x16_bf16 v[96:111], v[72:75], v[152:155], v[96:111]
  ds_read_b64_tr_b16 v[44:45], v4 offset:30720
  ds_read_b64_tr_b16 v[46:47], v4 offset:31232
  ds_read_b64_tr_b16 v[48:49], v4 offset:32768
  v_add_f32 v17, 1.0, v17
  v_add_f32 v18, 1.0, v18
  v_add_f32 v19, 1.0, v19
  v_mfma_f32_32x32x16_bf16 v[96:111], v[76:79], v[156:159], v[96:111]
  s_waitcnt lgkmcnt(7)
  ds_read_b64_tr_b16 v[50:51], v4 offset:33280
  ds_read_b64_tr_b16 v[52:53], v4 offset:34816
  ds_read_b64_tr_b16 v[54:55], v4 offset:35328
  v_rcp_f32 v16, v16
  v_mfma_f32_32x32x16_bf16 v[96:111], v[32:35], v[160:163], v[96:111]
  s_waitcnt lgkmcnt(8)
  ds_read_b64_tr_b16 v[56:57], v4 offset:36864
  ds_read_b64_tr_b16 v[58:59], v4 offset:37376
  ds_read_b64_tr_b16 v[60:61], v4 offset:38912
  v_rcp_f32 v17, v17
  v_mfma_f32_32x32x16_bf16 v[96:111], v[36:39], v[164:167], v[96:111]
  s_waitcnt lgkmcnt(9)
  ds_read_b64_tr_b16 v[62:63], v4 offset:39424
  ds_read_b64_tr_b16 v[64:65], v4 offset:40960
  ds_read_b64_tr_b16 v[66:67], v4 offset:41472
  v_rcp_f32 v18, v18
  v_mfma_f32_32x32x16_bf16 v[96:111], v[40:43], v[168:171], v[96:111]
  s_waitcnt lgkmcnt(10)
  ds_read_b64_tr_b16 v[68:69], v4 offset:43008
  ds_read_b64_tr_b16 v[70:71], v4 offset:43520
  ds_read_b64_tr_b16 v[72:73], v4 offset:45056
  v_rcp_f32 v19, v19
  v_mul_f32 v16, v84, v16
  v_mfma_f32_32x32x16_bf16 v[96:111], v[44:47], v[172:175], v[96:111]
  s_waitcnt lgkmcnt(11)
  ds_read_b64_tr_b16 v[74:75], v4 offset:45568
  ds_read_b64_tr_b16 v[76:77], v4 offset:47104
  ds_read_b64_tr_b16 v[78:79], v4 offset:47616
  v_mul_f32 v17, v85, v17
  v_mul_f32 v18, v86, v18
  v_mul_f32 v19, v87, v19
  v_mfma_f32_32x32x16_bf16 v[96:111], v[48:51], v[176:179], v[96:111]
  s_waitcnt lgkmcnt(12)
  s_waitcnt lgkmcnt(0)
  s_barrier
  v_cvt_pk_bf16_f32 v22, v16, v17
  v_cvt_pk_bf16_f32 v23, v18, v19
  v_exp_f32 v16, -v88
  v_exp_f32 v17, -v89
  v_mfma_f32_32x32x16_bf16 v[96:111], v[52:55], v[180:183], v[96:111]
  ds_write_b128 v12, v[20:23] offset:0
  v_exp_f32 v18, -v90
  v_exp_f32 v19, -v91
  v_add_f32 v16, 1.0, v16
  v_mfma_f32_32x32x16_bf16 v[96:111], v[56:59], v[184:187], v[96:111]
  v_add_f32 v17, 1.0, v17
  v_add_f32 v18, 1.0, v18
  v_add_f32 v19, 1.0, v19
  v_rcp_f32 v16, v16
  v_mfma_f32_32x32x16_bf16 v[96:111], v[60:63], v[188:191], v[96:111]
  v_rcp_f32 v17, v17
  v_rcp_f32 v18, v18
  v_rcp_f32 v19, v19
  v_mfma_f32_32x32x16_bf16 v[96:111], v[64:67], v[192:195], v[96:111]
  ds_read_b64_tr_b16 v[32:33], v4 offset:49152
  ds_read_b64_tr_b16 v[34:35], v4 offset:49664
  ds_read_b64_tr_b16 v[36:37], v4 offset:51200
  v_mul_f32 v16, v88, v16
  v_mul_f32 v17, v89, v17
  v_mul_f32 v18, v90, v18
  v_mfma_f32_32x32x16_bf16 v[96:111], v[68:71], v[196:199], v[96:111]
  ds_read_b64_tr_b16 v[38:39], v4 offset:51712
  ds_read_b64_tr_b16 v[40:41], v4 offset:53248
  ds_read_b64_tr_b16 v[42:43], v4 offset:53760
  v_mul_f32 v19, v91, v19
  v_cvt_pk_bf16_f32 v24, v16, v17
  v_cvt_pk_bf16_f32 v25, v18, v19
  v_mfma_f32_32x32x16_bf16 v[96:111], v[72:75], v[200:203], v[96:111]
  ds_read_b64_tr_b16 v[44:45], v4 offset:55296
  ds_read_b64_tr_b16 v[46:47], v4 offset:55808
  ds_read_b64_tr_b16 v[48:49], v5 offset:0
  v_exp_f32 v16, -v92
  v_mfma_f32_32x32x16_bf16 v[96:111], v[76:79], v[204:207], v[96:111]
  s_waitcnt lgkmcnt(7)
  ds_read_b64_tr_b16 v[50:51], v5 offset:512
  ds_read_b64_tr_b16 v[52:53], v5 offset:2048
  ds_read_b64_tr_b16 v[54:55], v5 offset:2560
  v_exp_f32 v17, -v93
  v_mfma_f32_32x32x16_bf16 v[96:111], v[32:35], v[208:211], v[96:111]
  s_waitcnt lgkmcnt(8)
  ds_read_b64_tr_b16 v[56:57], v5 offset:4096
  ds_read_b64_tr_b16 v[58:59], v5 offset:4608
  ds_read_b64_tr_b16 v[60:61], v5 offset:6144
  v_exp_f32 v18, -v94
  v_mfma_f32_32x32x16_bf16 v[96:111], v[36:39], v[212:215], v[96:111]
  s_waitcnt lgkmcnt(9)
  ds_read_b64_tr_b16 v[62:63], v5 offset:6656
  ds_read_b64_tr_b16 v[64:65], v5 offset:8192
  ds_read_b64_tr_b16 v[66:67], v5 offset:8704
  v_exp_f32 v19, -v95
  v_add_f32 v16, 1.0, v16
  v_mfma_f32_32x32x16_bf16 v[96:111], v[40:43], v[216:219], v[96:111]
  s_waitcnt lgkmcnt(10)
  ds_read_b64_tr_b16 v[68:69], v5 offset:10240
  ds_read_b64_tr_b16 v[70:71], v5 offset:10752
  ds_read_b64_tr_b16 v[72:73], v5 offset:12288
  v_add_f32 v17, 1.0, v17
  v_add_f32 v18, 1.0, v18
  v_add_f32 v19, 1.0, v19
  v_mfma_f32_32x32x16_bf16 v[96:111], v[44:47], v[220:223], v[96:111]
  s_waitcnt lgkmcnt(11)
  ds_read_b64_tr_b16 v[74:75], v5 offset:12800
  ds_read_b64_tr_b16 v[76:77], v5 offset:14336
  ds_read_b64_tr_b16 v[78:79], v5 offset:14848
  v_rcp_f32 v16, v16
  v_mfma_f32_32x32x16_bf16 v[96:111], v[48:51], v[224:227], v[96:111]
  s_waitcnt lgkmcnt(12)
  s_waitcnt lgkmcnt(0)
  s_barrier
  v_rcp_f32 v17, v17
  v_rcp_f32 v18, v18
  v_mfma_f32_32x32x16_bf16 v[96:111], v[52:55], v[228:231], v[96:111]
  v_rcp_f32 v19, v19
  v_mul_f32 v16, v92, v16
  v_mul_f32 v17, v93, v17
  v_mfma_f32_32x32x16_bf16 v[96:111], v[56:59], v[232:235], v[96:111]
  v_mul_f32 v18, v94, v18
  v_mul_f32 v19, v95, v19
  v_cvt_pk_bf16_f32 v26, v16, v17
  v_mfma_f32_32x32x16_bf16 v[96:111], v[60:63], v[236:239], v[96:111]
  v_cvt_pk_bf16_f32 v27, v18, v19
  v_mfma_f32_32x32x16_bf16 v[96:111], v[64:67], v[240:243], v[96:111]
  ds_read_b64_tr_b16 v[32:33], v4 offset:0
  ds_read_b64_tr_b16 v[34:35], v4 offset:512
  ds_read_b64_tr_b16 v[36:37], v4 offset:2048
  v_mfma_f32_32x32x16_bf16 v[96:111], v[68:71], v[244:247], v[96:111]
  ds_read_b64_tr_b16 v[38:39], v4 offset:2560
  ds_read_b64_tr_b16 v[40:41], v4 offset:4096
  ds_read_b64_tr_b16 v[42:43], v4 offset:4608
  v_mfma_f32_32x32x16_bf16 v[96:111], v[72:75], v[248:251], v[96:111]
  ds_read_b64_tr_b16 v[44:45], v4 offset:6144
  ds_read_b64_tr_b16 v[46:47], v4 offset:6656
  ds_read_b64_tr_b16 v[48:49], v4 offset:8192
  v_mfma_f32_32x32x16_bf16 v[96:111], v[76:79], v[252:255], v[96:111]
  s_waitcnt lgkmcnt(7)
  ds_read_b64_tr_b16 v[50:51], v4 offset:8704
  ds_read_b64_tr_b16 v[52:53], v4 offset:10240
  ds_read_b64_tr_b16 v[54:55], v4 offset:10752
  v_mfma_f32_32x32x16_bf16 v[80:95], v[32:35], v[112:115], 0
  s_waitcnt lgkmcnt(8)
  ds_read_b64_tr_b16 v[56:57], v4 offset:12288
  ds_read_b64_tr_b16 v[58:59], v4 offset:12800
  ds_read_b64_tr_b16 v[60:61], v4 offset:14336
  v_mfma_f32_32x32x16_bf16 v[80:95], v[36:39], v[116:119], v[80:95]
  s_waitcnt lgkmcnt(9)
  ds_read_b64_tr_b16 v[62:63], v4 offset:14848
  ds_read_b64_tr_b16 v[64:65], v4 offset:16384
  ds_read_b64_tr_b16 v[66:67], v4 offset:16896
  v_exp_f32 v16, -v96
  v_mfma_f32_32x32x16_bf16 v[80:95], v[40:43], v[120:123], v[80:95]
  s_waitcnt lgkmcnt(10)
  ds_read_b64_tr_b16 v[68:69], v4 offset:18432
  ds_read_b64_tr_b16 v[70:71], v4 offset:18944
  ds_read_b64_tr_b16 v[72:73], v4 offset:20480
  v_exp_f32 v17, -v97
  v_mfma_f32_32x32x16_bf16 v[80:95], v[44:47], v[124:127], v[80:95]
  s_waitcnt lgkmcnt(11)
  ds_read_b64_tr_b16 v[74:75], v4 offset:20992
  ds_read_b64_tr_b16 v[76:77], v4 offset:22528
  ds_read_b64_tr_b16 v[78:79], v4 offset:23040
  v_exp_f32 v18, -v98
  v_mfma_f32_32x32x16_bf16 v[80:95], v[48:51], v[128:131], v[80:95]
  s_waitcnt lgkmcnt(12)
  s_waitcnt lgkmcnt(0)
  s_barrier
  v_exp_f32 v19, -v99
  v_add_f32 v16, 1.0, v16
  v_add_f32 v17, 1.0, v17
  v_add_f32 v18, 1.0, v18
  v_add_f32 v19, 1.0, v19
  v_mfma_f32_32x32x16_bf16 v[80:95], v[52:55], v[132:135], v[80:95]
  ds_write_b128 v12, v[24:27] offset:1024
  v_rcp_f32 v16, v16
  v_rcp_f32 v17, v17
  v_mfma_f32_32x32x16_bf16 v[80:95], v[56:59], v[136:139], v[80:95]
  v_rcp_f32 v18, v18
  v_rcp_f32 v19, v19
  v_mul_f32 v16, v96, v16
  v_mul_f32 v17, v97, v17
  v_mfma_f32_32x32x16_bf16 v[80:95], v[60:63], v[140:143], v[80:95]
  v_mul_f32 v18, v98, v18
  v_mul_f32 v19, v99, v19
  v_cvt_pk_bf16_f32 v20, v16, v17
  v_cvt_pk_bf16_f32 v21, v18, v19
  v_exp_f32 v16, -v100
  v_mfma_f32_32x32x16_bf16 v[80:95], v[64:67], v[144:147], v[80:95]
  ds_read_b64_tr_b16 v[32:33], v4 offset:24576
  ds_read_b64_tr_b16 v[34:35], v4 offset:25088
  ds_read_b64_tr_b16 v[36:37], v4 offset:26624
  v_exp_f32 v17, -v101
  v_mfma_f32_32x32x16_bf16 v[80:95], v[68:71], v[148:151], v[80:95]
  ds_read_b64_tr_b16 v[38:39], v4 offset:27136
  ds_read_b64_tr_b16 v[40:41], v4 offset:28672
  ds_read_b64_tr_b16 v[42:43], v4 offset:29184
  v_exp_f32 v18, -v102
  v_mfma_f32_32x32x16_bf16 v[80:95], v[72:75], v[152:155], v[80:95]
  ds_read_b64_tr_b16 v[44:45], v4 offset:30720
  ds_read_b64_tr_b16 v[46:47], v4 offset:31232
  ds_read_b64_tr_b16 v[48:49], v4 offset:32768
  v_exp_f32 v19, -v103
  v_add_f32 v16, 1.0, v16
  v_mfma_f32_32x32x16_bf16 v[80:95], v[76:79], v[156:159], v[80:95]
  s_waitcnt lgkmcnt(7)
  ds_read_b64_tr_b16 v[50:51], v4 offset:33280
  ds_read_b64_tr_b16 v[52:53], v4 offset:34816
  ds_read_b64_tr_b16 v[54:55], v4 offset:35328
  v_add_f32 v17, 1.0, v17
  v_add_f32 v18, 1.0, v18
  v_add_f32 v19, 1.0, v19
  v_mfma_f32_32x32x16_bf16 v[80:95], v[32:35], v[160:163], v[80:95]
  s_waitcnt lgkmcnt(8)
  ds_read_b64_tr_b16 v[56:57], v4 offset:36864
  ds_read_b64_tr_b16 v[58:59], v4 offset:37376
  ds_read_b64_tr_b16 v[60:61], v4 offset:38912
  v_rcp_f32 v16, v16
  v_mfma_f32_32x32x16_bf16 v[80:95], v[36:39], v[164:167], v[80:95]
  s_waitcnt lgkmcnt(9)
  ds_read_b64_tr_b16 v[62:63], v4 offset:39424
  ds_read_b64_tr_b16 v[64:65], v4 offset:40960
  ds_read_b64_tr_b16 v[66:67], v4 offset:41472
  v_rcp_f32 v17, v17
  v_mfma_f32_32x32x16_bf16 v[80:95], v[40:43], v[168:171], v[80:95]
  s_waitcnt lgkmcnt(10)
  ds_read_b64_tr_b16 v[68:69], v4 offset:43008
  ds_read_b64_tr_b16 v[70:71], v4 offset:43520
  ds_read_b64_tr_b16 v[72:73], v4 offset:45056
  v_rcp_f32 v18, v18
  v_mfma_f32_32x32x16_bf16 v[80:95], v[44:47], v[172:175], v[80:95]
  s_waitcnt lgkmcnt(11)
  ds_read_b64_tr_b16 v[74:75], v4 offset:45568
  ds_read_b64_tr_b16 v[76:77], v4 offset:47104
  ds_read_b64_tr_b16 v[78:79], v4 offset:47616
  v_rcp_f32 v19, v19
  v_mul_f32 v16, v100, v16
  v_mfma_f32_32x32x16_bf16 v[80:95], v[48:51], v[176:179], v[80:95]
  s_waitcnt lgkmcnt(12)
  s_waitcnt lgkmcnt(0)
  s_barrier
  v_mul_f32 v17, v101, v17
  v_mul_f32 v18, v102, v18
  v_mul_f32 v19, v103, v19
  v_cvt_pk_bf16_f32 v22, v16, v17
  v_cvt_pk_bf16_f32 v23, v18, v19
  v_mfma_f32_32x32x16_bf16 v[80:95], v[52:55], v[180:183], v[80:95]
  ds_write_b128 v12, v[20:23] offset:8192
  v_exp_f32 v16, -v104
  v_exp_f32 v17, -v105
  v_mfma_f32_32x32x16_bf16 v[80:95], v[56:59], v[184:187], v[80:95]
  v_exp_f32 v18, -v106
  v_exp_f32 v19, -v107
  v_add_f32 v16, 1.0, v16
  v_mfma_f32_32x32x16_bf16 v[80:95], v[60:63], v[188:191], v[80:95]
  v_add_f32 v17, 1.0, v17
  v_add_f32 v18, 1.0, v18
  v_add_f32 v19, 1.0, v19
  v_rcp_f32 v16, v16
  v_mfma_f32_32x32x16_bf16 v[80:95], v[64:67], v[192:195], v[80:95]
  ds_read_b64_tr_b16 v[32:33], v4 offset:49152
  ds_read_b64_tr_b16 v[34:35], v4 offset:49664
  ds_read_b64_tr_b16 v[36:37], v4 offset:51200
  v_rcp_f32 v17, v17
  v_mfma_f32_32x32x16_bf16 v[80:95], v[68:71], v[196:199], v[80:95]
  ds_read_b64_tr_b16 v[38:39], v4 offset:51712
  ds_read_b64_tr_b16 v[40:41], v4 offset:53248
  ds_read_b64_tr_b16 v[42:43], v4 offset:53760
  v_rcp_f32 v18, v18
  v_mfma_f32_32x32x16_bf16 v[80:95], v[72:75], v[200:203], v[80:95]
  ds_read_b64_tr_b16 v[44:45], v4 offset:55296
  ds_read_b64_tr_b16 v[46:47], v4 offset:55808
  ds_read_b64_tr_b16 v[48:49], v5 offset:0
  v_rcp_f32 v19, v19
  v_mul_f32 v16, v104, v16
  v_mfma_f32_32x32x16_bf16 v[80:95], v[76:79], v[204:207], v[80:95]
  s_waitcnt lgkmcnt(7)
  ds_read_b64_tr_b16 v[50:51], v5 offset:512
  ds_read_b64_tr_b16 v[52:53], v5 offset:2048
  ds_read_b64_tr_b16 v[54:55], v5 offset:2560
  v_mul_f32 v17, v105, v17
  v_mul_f32 v18, v106, v18
  v_mul_f32 v19, v107, v19
  v_mfma_f32_32x32x16_bf16 v[80:95], v[32:35], v[208:211], v[80:95]
  s_waitcnt lgkmcnt(8)
  ds_read_b64_tr_b16 v[56:57], v5 offset:4096
  ds_read_b64_tr_b16 v[58:59], v5 offset:4608
  ds_read_b64_tr_b16 v[60:61], v5 offset:6144
  v_cvt_pk_bf16_f32 v24, v16, v17
  v_cvt_pk_bf16_f32 v25, v18, v19
  v_mfma_f32_32x32x16_bf16 v[80:95], v[36:39], v[212:215], v[80:95]
  s_waitcnt lgkmcnt(9)
  ds_read_b64_tr_b16 v[62:63], v5 offset:6656
  ds_read_b64_tr_b16 v[64:65], v5 offset:8192
  ds_read_b64_tr_b16 v[66:67], v5 offset:8704
  v_exp_f32 v16, -v108
  v_mfma_f32_32x32x16_bf16 v[80:95], v[40:43], v[216:219], v[80:95]
  s_waitcnt lgkmcnt(10)
  ds_read_b64_tr_b16 v[68:69], v5 offset:10240
  ds_read_b64_tr_b16 v[70:71], v5 offset:10752
  ds_read_b64_tr_b16 v[72:73], v5 offset:12288
  v_exp_f32 v17, -v109
  v_mfma_f32_32x32x16_bf16 v[80:95], v[44:47], v[220:223], v[80:95]
  s_waitcnt lgkmcnt(11)
  ds_read_b64_tr_b16 v[74:75], v5 offset:12800
  ds_read_b64_tr_b16 v[76:77], v5 offset:14336
  ds_read_b64_tr_b16 v[78:79], v5 offset:14848
  v_exp_f32 v18, -v110
  v_mfma_f32_32x32x16_bf16 v[80:95], v[48:51], v[224:227], v[80:95]
  s_waitcnt lgkmcnt(12)
  s_waitcnt lgkmcnt(0)
  s_barrier
  v_exp_f32 v19, -v111
  v_add_f32 v16, 1.0, v16
  v_add_f32 v17, 1.0, v17
  v_add_f32 v18, 1.0, v18
  v_add_f32 v19, 1.0, v19
  v_mfma_f32_32x32x16_bf16 v[80:95], v[52:55], v[228:231], v[80:95]
  v_rcp_f32 v16, v16
  v_rcp_f32 v17, v17
  v_rcp_f32 v18, v18
  v_mfma_f32_32x32x16_bf16 v[80:95], v[56:59], v[232:235], v[80:95]
  v_rcp_f32 v19, v19
  v_mul_f32 v16, v108, v16
  v_mul_f32 v17, v109, v17
  v_mfma_f32_32x32x16_bf16 v[80:95], v[60:63], v[236:239], v[80:95]
  v_mul_f32 v18, v110, v18
  v_mul_f32 v19, v111, v19
  v_cvt_pk_bf16_f32 v26, v16, v17
  v_cvt_pk_bf16_f32 v27, v18, v19
  v_mfma_f32_32x32x16_bf16 v[80:95], v[64:67], v[240:243], v[80:95]
  ds_read_b64_tr_b16 v[32:33], v4 offset:0
  ds_read_b64_tr_b16 v[34:35], v4 offset:512
  ds_read_b64_tr_b16 v[36:37], v4 offset:2048
  v_mfma_f32_32x32x16_bf16 v[80:95], v[68:71], v[244:247], v[80:95]
  ds_read_b64_tr_b16 v[38:39], v4 offset:2560
  ds_read_b64_tr_b16 v[40:41], v4 offset:4096
  ds_read_b64_tr_b16 v[42:43], v4 offset:4608
  v_mfma_f32_32x32x16_bf16 v[80:95], v[72:75], v[248:251], v[80:95]
  ds_read_b64_tr_b16 v[44:45], v4 offset:6144
  ds_read_b64_tr_b16 v[46:47], v4 offset:6656
  ds_read_b64_tr_b16 v[48:49], v4 offset:8192
  v_mfma_f32_32x32x16_bf16 v[80:95], v[76:79], v[252:255], v[80:95]
  s_waitcnt lgkmcnt(7)
  ds_read_b64_tr_b16 v[50:51], v4 offset:8704
  ds_read_b64_tr_b16 v[52:53], v4 offset:10240
  ds_read_b64_tr_b16 v[54:55], v4 offset:10752
  v_mfma_f32_32x32x16_bf16 v[96:111], v[32:35], v[112:115], 0
  s_waitcnt lgkmcnt(8)
  ds_read_b64_tr_b16 v[56:57], v4 offset:12288
  ds_read_b64_tr_b16 v[58:59], v4 offset:12800
  ds_read_b64_tr_b16 v[60:61], v4 offset:14336
  v_mfma_f32_32x32x16_bf16 v[96:111], v[36:39], v[116:119], v[96:111]
  s_waitcnt lgkmcnt(9)
  ds_read_b64_tr_b16 v[62:63], v4 offset:14848
  ds_read_b64_tr_b16 v[64:65], v4 offset:16384
  ds_read_b64_tr_b16 v[66:67], v4 offset:16896
  v_exp_f32 v16, -v80
  v_mfma_f32_32x32x16_bf16 v[96:111], v[40:43], v[120:123], v[96:111]
  s_waitcnt lgkmcnt(10)
  ds_read_b64_tr_b16 v[68:69], v4 offset:18432
  ds_read_b64_tr_b16 v[70:71], v4 offset:18944
  ds_read_b64_tr_b16 v[72:73], v4 offset:20480
  v_exp_f32 v17, -v81
  v_mfma_f32_32x32x16_bf16 v[96:111], v[44:47], v[124:127], v[96:111]
  s_waitcnt lgkmcnt(11)
  ds_read_b64_tr_b16 v[74:75], v4 offset:20992
  ds_read_b64_tr_b16 v[76:77], v4 offset:22528
  ds_read_b64_tr_b16 v[78:79], v4 offset:23040
  v_exp_f32 v18, -v82
  v_mfma_f32_32x32x16_bf16 v[96:111], v[48:51], v[128:131], v[96:111]
  s_waitcnt lgkmcnt(12)
  s_waitcnt lgkmcnt(0)
  s_barrier
  v_exp_f32 v19, -v83
  v_add_f32 v16, 1.0, v16
  v_add_f32 v17, 1.0, v17
  v_add_f32 v18, 1.0, v18
  v_add_f32 v19, 1.0, v19
  v_mfma_f32_32x32x16_bf16 v[96:111], v[52:55], v[132:135], v[96:111]
  ds_write_b128 v12, v[24:27] offset:9216
  v_rcp_f32 v16, v16
  v_rcp_f32 v17, v17
  v_mfma_f32_32x32x16_bf16 v[96:111], v[56:59], v[136:139], v[96:111]
  v_rcp_f32 v18, v18
  v_rcp_f32 v19, v19
  v_mul_f32 v16, v80, v16
  v_mul_f32 v17, v81, v17
  v_mfma_f32_32x32x16_bf16 v[96:111], v[60:63], v[140:143], v[96:111]
  v_mul_f32 v18, v82, v18
  v_mul_f32 v19, v83, v19
  v_cvt_pk_bf16_f32 v20, v16, v17
  v_cvt_pk_bf16_f32 v21, v18, v19
  v_exp_f32 v16, -v84
  v_mfma_f32_32x32x16_bf16 v[96:111], v[64:67], v[144:147], v[96:111]
  ds_read_b64_tr_b16 v[32:33], v4 offset:24576
  ds_read_b64_tr_b16 v[34:35], v4 offset:25088
  ds_read_b64_tr_b16 v[36:37], v4 offset:26624
  v_exp_f32 v17, -v85
  v_mfma_f32_32x32x16_bf16 v[96:111], v[68:71], v[148:151], v[96:111]
  ds_read_b64_tr_b16 v[38:39], v4 offset:27136
  ds_read_b64_tr_b16 v[40:41], v4 offset:28672
  ds_read_b64_tr_b16 v[42:43], v4 offset:29184
  v_exp_f32 v18, -v86
  v_mfma_f32_32x32x16_bf16 v[96:111], v[72:75], v[152:155], v[96:111]
  ds_read_b64_tr_b16 v[44:45], v4 offset:30720
  ds_read_b64_tr_b16 v[46:47], v4 offset:31232
  ds_read_b64_tr_b16 v[48:49], v4 offset:32768
  v_exp_f32 v19, -v87
  v_add_f32 v16, 1.0, v16
  v_mfma_f32_32x32x16_bf16 v[96:111], v[76:79], v[156:159], v[96:111]
  s_waitcnt lgkmcnt(7)
  ds_read_b64_tr_b16 v[50:51], v4 offset:33280
  ds_read_b64_tr_b16 v[52:53], v4 offset:34816
  ds_read_b64_tr_b16 v[54:55], v4 offset:35328
  v_add_f32 v17, 1.0, v17
  v_add_f32 v18, 1.0, v18
  v_add_f32 v19, 1.0, v19
  v_mfma_f32_32x32x16_bf16 v[96:111], v[32:35], v[160:163], v[96:111]
  s_waitcnt lgkmcnt(8)
  ds_read_b64_tr_b16 v[56:57], v4 offset:36864
  ds_read_b64_tr_b16 v[58:59], v4 offset:37376
  ds_read_b64_tr_b16 v[60:61], v4 offset:38912
  v_rcp_f32 v16, v16
  v_mfma_f32_32x32x16_bf16 v[96:111], v[36:39], v[164:167], v[96:111]
  s_waitcnt lgkmcnt(9)
  ds_read_b64_tr_b16 v[62:63], v4 offset:39424
  ds_read_b64_tr_b16 v[64:65], v4 offset:40960
  ds_read_b64_tr_b16 v[66:67], v4 offset:41472
  v_rcp_f32 v17, v17
  v_mfma_f32_32x32x16_bf16 v[96:111], v[40:43], v[168:171], v[96:111]
  s_waitcnt lgkmcnt(10)
  ds_read_b64_tr_b16 v[68:69], v4 offset:43008
  ds_read_b64_tr_b16 v[70:71], v4 offset:43520
  ds_read_b64_tr_b16 v[72:73], v4 offset:45056
  v_rcp_f32 v18, v18
  v_mfma_f32_32x32x16_bf16 v[96:111], v[44:47], v[172:175], v[96:111]
  s_waitcnt lgkmcnt(11)
  ds_read_b64_tr_b16 v[74:75], v4 offset:45568
  ds_read_b64_tr_b16 v[76:77], v4 offset:47104
  ds_read_b64_tr_b16 v[78:79], v4 offset:47616
  v_rcp_f32 v19, v19
  v_mul_f32 v16, v84, v16
  v_mfma_f32_32x32x16_bf16 v[96:111], v[48:51], v[176:179], v[96:111]
  s_waitcnt lgkmcnt(12)
  s_waitcnt lgkmcnt(0)
  s_barrier
  v_mul_f32 v17, v85, v17
  v_mul_f32 v18, v86, v18
  v_mul_f32 v19, v87, v19
  v_cvt_pk_bf16_f32 v22, v16, v17
  v_cvt_pk_bf16_f32 v23, v18, v19
  v_mfma_f32_32x32x16_bf16 v[96:111], v[52:55], v[180:183], v[96:111]
  ds_write_b128 v12, v[20:23] offset:16384
  v_exp_f32 v16, -v88
  v_exp_f32 v17, -v89
  v_mfma_f32_32x32x16_bf16 v[96:111], v[56:59], v[184:187], v[96:111]
  v_exp_f32 v18, -v90
  v_exp_f32 v19, -v91
  v_add_f32 v16, 1.0, v16
  v_mfma_f32_32x32x16_bf16 v[96:111], v[60:63], v[188:191], v[96:111]
  v_add_f32 v17, 1.0, v17
  v_add_f32 v18, 1.0, v18
  v_add_f32 v19, 1.0, v19
  v_rcp_f32 v16, v16
  v_mfma_f32_32x32x16_bf16 v[96:111], v[64:67], v[192:195], v[96:111]
  ds_read_b64_tr_b16 v[32:33], v4 offset:49152
  ds_read_b64_tr_b16 v[34:35], v4 offset:49664
  ds_read_b64_tr_b16 v[36:37], v4 offset:51200
  v_rcp_f32 v17, v17
  v_mfma_f32_32x32x16_bf16 v[96:111], v[68:71], v[196:199], v[96:111]
  ds_read_b64_tr_b16 v[38:39], v4 offset:51712
  ds_read_b64_tr_b16 v[40:41], v4 offset:53248
  ds_read_b64_tr_b16 v[42:43], v4 offset:53760
  v_rcp_f32 v18, v18
  v_mfma_f32_32x32x16_bf16 v[96:111], v[72:75], v[200:203], v[96:111]
  ds_read_b64_tr_b16 v[44:45], v4 offset:55296
  ds_read_b64_tr_b16 v[46:47], v4 offset:55808
  ds_read_b64_tr_b16 v[48:49], v5 offset:0
  v_rcp_f32 v19, v19
  v_mul_f32 v16, v88, v16
  v_mfma_f32_32x32x16_bf16 v[96:111], v[76:79], v[204:207], v[96:111]
  s_waitcnt lgkmcnt(7)
  ds_read_b64_tr_b16 v[50:51], v5 offset:512
  ds_read_b64_tr_b16 v[52:53], v5 offset:2048
  ds_read_b64_tr_b16 v[54:55], v5 offset:2560
  v_mul_f32 v17, v89, v17
  v_mul_f32 v18, v90, v18
  v_mul_f32 v19, v91, v19
  v_mfma_f32_32x32x16_bf16 v[96:111], v[32:35], v[208:211], v[96:111]
  s_waitcnt lgkmcnt(8)
  ds_read_b64_tr_b16 v[56:57], v5 offset:4096
  ds_read_b64_tr_b16 v[58:59], v5 offset:4608
  ds_read_b64_tr_b16 v[60:61], v5 offset:6144
  v_cvt_pk_bf16_f32 v24, v16, v17
  v_cvt_pk_bf16_f32 v25, v18, v19
  v_mfma_f32_32x32x16_bf16 v[96:111], v[36:39], v[212:215], v[96:111]
  s_waitcnt lgkmcnt(9)
  ds_read_b64_tr_b16 v[62:63], v5 offset:6656
  ds_read_b64_tr_b16 v[64:65], v5 offset:8192
  ds_read_b64_tr_b16 v[66:67], v5 offset:8704
  v_exp_f32 v16, -v92
  v_mfma_f32_32x32x16_bf16 v[96:111], v[40:43], v[216:219], v[96:111]
  s_waitcnt lgkmcnt(10)
  ds_read_b64_tr_b16 v[68:69], v5 offset:10240
  ds_read_b64_tr_b16 v[70:71], v5 offset:10752
  ds_read_b64_tr_b16 v[72:73], v5 offset:12288
  v_exp_f32 v17, -v93
  v_mfma_f32_32x32x16_bf16 v[96:111], v[44:47], v[220:223], v[96:111]
  s_waitcnt lgkmcnt(11)
  ds_read_b64_tr_b16 v[74:75], v5 offset:12800
  ds_read_b64_tr_b16 v[76:77], v5 offset:14336
  ds_read_b64_tr_b16 v[78:79], v5 offset:14848
  v_exp_f32 v18, -v94
  v_mfma_f32_32x32x16_bf16 v[96:111], v[48:51], v[224:227], v[96:111]
  s_waitcnt lgkmcnt(12)
  s_waitcnt lgkmcnt(0)
  s_barrier
  v_exp_f32 v19, -v95
  v_add_f32 v16, 1.0, v16
  v_add_f32 v17, 1.0, v17
  v_add_f32 v18, 1.0, v18
  v_add_f32 v19, 1.0, v19
  v_mfma_f32_32x32x16_bf16 v[96:111], v[52:55], v[228:231], v[96:111]
  v_rcp_f32 v16, v16
  v_rcp_f32 v17, v17
  v_rcp_f32 v18, v18
  v_mfma_f32_32x32x16_bf16 v[96:111], v[56:59], v[232:235], v[96:111]
  v_rcp_f32 v19, v19
  v_mul_f32 v16, v92, v16
  v_mul_f32 v17, v93, v17
  v_mfma_f32_32x32x16_bf16 v[96:111], v[60:63], v[236:239], v[96:111]
  v_mul_f32 v18, v94, v18
  v_mul_f32 v19, v95, v19
  v_cvt_pk_bf16_f32 v26, v16, v17
  v_cvt_pk_bf16_f32 v27, v18, v19
  v_mfma_f32_32x32x16_bf16 v[96:111], v[64:67], v[240:243], v[96:111]
  ds_read_b64_tr_b16 v[32:33], v4 offset:0
  ds_read_b64_tr_b16 v[34:35], v4 offset:512
  ds_read_b64_tr_b16 v[36:37], v4 offset:2048
  v_mfma_f32_32x32x16_bf16 v[96:111], v[68:71], v[244:247], v[96:111]
  ds_read_b64_tr_b16 v[38:39], v4 offset:2560
  ds_read_b64_tr_b16 v[40:41], v4 offset:4096
  ds_read_b64_tr_b16 v[42:43], v4 offset:4608
  v_mfma_f32_32x32x16_bf16 v[96:111], v[72:75], v[248:251], v[96:111]
  ds_read_b64_tr_b16 v[44:45], v4 offset:6144
  ds_read_b64_tr_b16 v[46:47], v4 offset:6656
  ds_read_b64_tr_b16 v[48:49], v4 offset:8192
  v_mfma_f32_32x32x16_bf16 v[96:111], v[76:79], v[252:255], v[96:111]
  s_waitcnt lgkmcnt(7)
  ds_read_b64_tr_b16 v[50:51], v4 offset:8704
  ds_read_b64_tr_b16 v[52:53], v4 offset:10240
  ds_read_b64_tr_b16 v[54:55], v4 offset:10752
  v_mfma_f32_32x32x16_bf16 v[80:95], v[32:35], v[112:115], 0
  s_waitcnt lgkmcnt(8)
  ds_read_b64_tr_b16 v[56:57], v4 offset:12288
  ds_read_b64_tr_b16 v[58:59], v4 offset:12800
  ds_read_b64_tr_b16 v[60:61], v4 offset:14336
  v_mfma_f32_32x32x16_bf16 v[80:95], v[36:39], v[116:119], v[80:95]
  s_waitcnt lgkmcnt(9)
  ds_read_b64_tr_b16 v[62:63], v4 offset:14848
  ds_read_b64_tr_b16 v[64:65], v4 offset:16384
  ds_read_b64_tr_b16 v[66:67], v4 offset:16896
  v_exp_f32 v16, -v96
  v_mfma_f32_32x32x16_bf16 v[80:95], v[40:43], v[120:123], v[80:95]
  s_waitcnt lgkmcnt(10)
  ds_read_b64_tr_b16 v[68:69], v4 offset:18432
  ds_read_b64_tr_b16 v[70:71], v4 offset:18944
  ds_read_b64_tr_b16 v[72:73], v4 offset:20480
  v_exp_f32 v17, -v97
  v_mfma_f32_32x32x16_bf16 v[80:95], v[44:47], v[124:127], v[80:95]
  s_waitcnt lgkmcnt(11)
  ds_read_b64_tr_b16 v[74:75], v4 offset:20992
  ds_read_b64_tr_b16 v[76:77], v4 offset:22528
  ds_read_b64_tr_b16 v[78:79], v4 offset:23040
  v_exp_f32 v18, -v98
  v_mfma_f32_32x32x16_bf16 v[80:95], v[48:51], v[128:131], v[80:95]
  s_waitcnt lgkmcnt(12)
  s_waitcnt lgkmcnt(0)
  s_barrier
  v_exp_f32 v19, -v99
  v_add_f32 v16, 1.0, v16
  v_add_f32 v17, 1.0, v17
  v_add_f32 v18, 1.0, v18
  v_add_f32 v19, 1.0, v19
  v_mfma_f32_32x32x16_bf16 v[80:95], v[52:55], v[132:135], v[80:95]
  ds_write_b128 v12, v[24:27] offset:17408
  v_rcp_f32 v16, v16
  v_rcp_f32 v17, v17
  v_mfma_f32_32x32x16_bf16 v[80:95], v[56:59], v[136:139], v[80:95]
  v_rcp_f32 v18, v18
  v_rcp_f32 v19, v19
  v_mul_f32 v16, v96, v16
  v_mul_f32 v17, v97, v17
  v_mfma_f32_32x32x16_bf16 v[80:95], v[60:63], v[140:143], v[80:95]
  v_mul_f32 v18, v98, v18
  v_mul_f32 v19, v99, v19
  v_cvt_pk_bf16_f32 v20, v16, v17
  v_cvt_pk_bf16_f32 v21, v18, v19
  v_exp_f32 v16, -v100
  v_mfma_f32_32x32x16_bf16 v[80:95], v[64:67], v[144:147], v[80:95]
  ds_read_b64_tr_b16 v[32:33], v4 offset:24576
  ds_read_b64_tr_b16 v[34:35], v4 offset:25088
  ds_read_b64_tr_b16 v[36:37], v4 offset:26624
  v_exp_f32 v17, -v101
  v_mfma_f32_32x32x16_bf16 v[80:95], v[68:71], v[148:151], v[80:95]
  ds_read_b64_tr_b16 v[38:39], v4 offset:27136
  ds_read_b64_tr_b16 v[40:41], v4 offset:28672
  ds_read_b64_tr_b16 v[42:43], v4 offset:29184
  v_exp_f32 v18, -v102
  v_mfma_f32_32x32x16_bf16 v[80:95], v[72:75], v[152:155], v[80:95]
  ds_read_b64_tr_b16 v[44:45], v4 offset:30720
  ds_read_b64_tr_b16 v[46:47], v4 offset:31232
  ds_read_b64_tr_b16 v[48:49], v4 offset:32768
  v_exp_f32 v19, -v103
  v_add_f32 v16, 1.0, v16
  v_mfma_f32_32x32x16_bf16 v[80:95], v[76:79], v[156:159], v[80:95]
  s_waitcnt lgkmcnt(7)
  ds_read_b64_tr_b16 v[50:51], v4 offset:33280
  ds_read_b64_tr_b16 v[52:53], v4 offset:34816
  ds_read_b64_tr_b16 v[54:55], v4 offset:35328
  v_add_f32 v17, 1.0, v17
  v_add_f32 v18, 1.0, v18
  v_add_f32 v19, 1.0, v19
  v_mfma_f32_32x32x16_bf16 v[80:95], v[32:35], v[160:163], v[80:95]
  s_waitcnt lgkmcnt(8)
  ds_read_b64_tr_b16 v[56:57], v4 offset:36864
  ds_read_b64_tr_b16 v[58:59], v4 offset:37376
  ds_read_b64_tr_b16 v[60:61], v4 offset:38912
  v_rcp_f32 v16, v16
  v_mfma_f32_32x32x16_bf16 v[80:95], v[36:39], v[164:167], v[80:95]
  s_waitcnt lgkmcnt(9)
  ds_read_b64_tr_b16 v[62:63], v4 offset:39424
  ds_read_b64_tr_b16 v[64:65], v4 offset:40960
  ds_read_b64_tr_b16 v[66:67], v4 offset:41472
  v_rcp_f32 v17, v17
  v_mfma_f32_32x32x16_bf16 v[80:95], v[40:43], v[168:171], v[80:95]
  s_waitcnt lgkmcnt(10)
  ds_read_b64_tr_b16 v[68:69], v4 offset:43008
  ds_read_b64_tr_b16 v[70:71], v4 offset:43520
  ds_read_b64_tr_b16 v[72:73], v4 offset:45056
  v_rcp_f32 v18, v18
  v_mfma_f32_32x32x16_bf16 v[80:95], v[44:47], v[172:175], v[80:95]
  s_waitcnt lgkmcnt(11)
  ds_read_b64_tr_b16 v[74:75], v4 offset:45568
  ds_read_b64_tr_b16 v[76:77], v4 offset:47104
  ds_read_b64_tr_b16 v[78:79], v4 offset:47616
  v_rcp_f32 v19, v19
  v_mul_f32 v16, v100, v16
  v_mfma_f32_32x32x16_bf16 v[80:95], v[48:51], v[176:179], v[80:95]
  s_waitcnt lgkmcnt(12)
  s_waitcnt lgkmcnt(0)
  s_barrier
  v_mul_f32 v17, v101, v17
  v_mul_f32 v18, v102, v18
  v_mul_f32 v19, v103, v19
  v_cvt_pk_bf16_f32 v22, v16, v17
  v_cvt_pk_bf16_f32 v23, v18, v19
  v_mfma_f32_32x32x16_bf16 v[80:95], v[52:55], v[180:183], v[80:95]
  ds_write_b128 v12, v[20:23] offset:24576
  v_exp_f32 v16, -v104
  v_exp_f32 v17, -v105
  v_mfma_f32_32x32x16_bf16 v[80:95], v[56:59], v[184:187], v[80:95]
  v_exp_f32 v18, -v106
  v_exp_f32 v19, -v107
  v_add_f32 v16, 1.0, v16
  v_mfma_f32_32x32x16_bf16 v[80:95], v[60:63], v[188:191], v[80:95]
  v_add_f32 v17, 1.0, v17
  v_add_f32 v18, 1.0, v18
  v_add_f32 v19, 1.0, v19
  v_rcp_f32 v16, v16
  v_mfma_f32_32x32x16_bf16 v[80:95], v[64:67], v[192:195], v[80:95]
  ds_read_b64_tr_b16 v[32:33], v4 offset:49152
  ds_read_b64_tr_b16 v[34:35], v4 offset:49664
  ds_read_b64_tr_b16 v[36:37], v4 offset:51200
  v_rcp_f32 v17, v17
  v_mfma_f32_32x32x16_bf16 v[80:95], v[68:71], v[196:199], v[80:95]
  ds_read_b64_tr_b16 v[38:39], v4 offset:51712
  ds_read_b64_tr_b16 v[40:41], v4 offset:53248
  ds_read_b64_tr_b16 v[42:43], v4 offset:53760
  v_rcp_f32 v18, v18
  v_mfma_f32_32x32x16_bf16 v[80:95], v[72:75], v[200:203], v[80:95]
  ds_read_b64_tr_b16 v[44:45], v4 offset:55296
  ds_read_b64_tr_b16 v[46:47], v4 offset:55808
  ds_read_b64_tr_b16 v[48:49], v5 offset:0
  v_rcp_f32 v19, v19
  v_mul_f32 v16, v104, v16
  v_mfma_f32_32x32x16_bf16 v[80:95], v[76:79], v[204:207], v[80:95]
  s_waitcnt lgkmcnt(7)
  ds_read_b64_tr_b16 v[50:51], v5 offset:512
  ds_read_b64_tr_b16 v[52:53], v5 offset:2048
  ds_read_b64_tr_b16 v[54:55], v5 offset:2560
  v_mul_f32 v17, v105, v17
  v_mul_f32 v18, v106, v18
  v_mul_f32 v19, v107, v19
  v_mfma_f32_32x32x16_bf16 v[80:95], v[32:35], v[208:211], v[80:95]
  s_waitcnt lgkmcnt(8)
  ds_read_b64_tr_b16 v[56:57], v5 offset:4096
  ds_read_b64_tr_b16 v[58:59], v5 offset:4608
  ds_read_b64_tr_b16 v[60:61], v5 offset:6144
  v_cvt_pk_bf16_f32 v24, v16, v17
  v_cvt_pk_bf16_f32 v25, v18, v19
  v_mfma_f32_32x32x16_bf16 v[80:95], v[36:39], v[212:215], v[80:95]
  s_waitcnt lgkmcnt(9)
  ds_read_b64_tr_b16 v[62:63], v5 offset:6656
  ds_read_b64_tr_b16 v[64:65], v5 offset:8192
  ds_read_b64_tr_b16 v[66:67], v5 offset:8704
  v_exp_f32 v16, -v108
  v_mfma_f32_32x32x16_bf16 v[80:95], v[40:43], v[216:219], v[80:95]
  s_waitcnt lgkmcnt(10)
  ds_read_b64_tr_b16 v[68:69], v5 offset:10240
  ds_read_b64_tr_b16 v[70:71], v5 offset:10752
  ds_read_b64_tr_b16 v[72:73], v5 offset:12288
  v_exp_f32 v17, -v109
  v_mfma_f32_32x32x16_bf16 v[80:95], v[44:47], v[220:223], v[80:95]
  s_waitcnt lgkmcnt(11)
  ds_read_b64_tr_b16 v[74:75], v5 offset:12800
  ds_read_b64_tr_b16 v[76:77], v5 offset:14336
  ds_read_b64_tr_b16 v[78:79], v5 offset:14848
  v_exp_f32 v18, -v110
  v_mfma_f32_32x32x16_bf16 v[80:95], v[48:51], v[224:227], v[80:95]
  s_waitcnt lgkmcnt(12)
  s_waitcnt lgkmcnt(0)
  s_barrier
  v_exp_f32 v19, -v111
  v_add_f32 v16, 1.0, v16
  v_add_f32 v17, 1.0, v17
  v_add_f32 v18, 1.0, v18
  v_add_f32 v19, 1.0, v19
  v_mfma_f32_32x32x16_bf16 v[80:95], v[52:55], v[228:231], v[80:95]
  v_rcp_f32 v16, v16
  v_rcp_f32 v17, v17
  v_rcp_f32 v18, v18
  v_mfma_f32_32x32x16_bf16 v[80:95], v[56:59], v[232:235], v[80:95]
  v_rcp_f32 v19, v19
  v_mul_f32 v16, v108, v16
  v_mul_f32 v17, v109, v17
  v_mfma_f32_32x32x16_bf16 v[80:95], v[60:63], v[236:239], v[80:95]
  v_mul_f32 v18, v110, v18
  v_mul_f32 v19, v111, v19
  v_cvt_pk_bf16_f32 v26, v16, v17
  v_cvt_pk_bf16_f32 v27, v18, v19
  v_mfma_f32_32x32x16_bf16 v[80:95], v[64:67], v[240:243], v[80:95]
  ds_read_b64_tr_b16 v[32:33], v4 offset:0
  ds_read_b64_tr_b16 v[34:35], v4 offset:512
  ds_read_b64_tr_b16 v[36:37], v4 offset:2048
  v_mfma_f32_32x32x16_bf16 v[80:95], v[68:71], v[244:247], v[80:95]
  ds_read_b64_tr_b16 v[38:39], v4 offset:2560
  ds_read_b64_tr_b16 v[40:41], v4 offset:4096
  ds_read_b64_tr_b16 v[42:43], v4 offset:4608
  v_mfma_f32_32x32x16_bf16 v[80:95], v[72:75], v[248:251], v[80:95]
  ds_read_b64_tr_b16 v[44:45], v4 offset:6144
  ds_read_b64_tr_b16 v[46:47], v4 offset:6656
  ds_read_b64_tr_b16 v[48:49], v4 offset:8192
  v_mfma_f32_32x32x16_bf16 v[80:95], v[76:79], v[252:255], v[80:95]
  s_waitcnt lgkmcnt(7)
  ds_read_b64_tr_b16 v[50:51], v4 offset:8704
  ds_read_b64_tr_b16 v[52:53], v4 offset:10240
  ds_read_b64_tr_b16 v[54:55], v4 offset:10752
  v_mfma_f32_32x32x16_bf16 v[96:111], v[32:35], v[112:115], 0
  s_waitcnt lgkmcnt(8)
  ds_read_b64_tr_b16 v[56:57], v4 offset:12288
  ds_read_b64_tr_b16 v[58:59], v4 offset:12800
  ds_read_b64_tr_b16 v[60:61], v4 offset:14336
  v_mfma_f32_32x32x16_bf16 v[96:111], v[36:39], v[116:119], v[96:111]
  s_waitcnt lgkmcnt(9)
  ds_read_b64_tr_b16 v[62:63], v4 offset:14848
  ds_read_b64_tr_b16 v[64:65], v4 offset:16384
  ds_read_b64_tr_b16 v[66:67], v4 offset:16896
  v_exp_f32 v16, -v80
  v_mfma_f32_32x32x16_bf16 v[96:111], v[40:43], v[120:123], v[96:111]
  s_waitcnt lgkmcnt(10)
  ds_read_b64_tr_b16 v[68:69], v4 offset:18432
  ds_read_b64_tr_b16 v[70:71], v4 offset:18944
  ds_read_b64_tr_b16 v[72:73], v4 offset:20480
  v_exp_f32 v17, -v81
  v_mfma_f32_32x32x16_bf16 v[96:111], v[44:47], v[124:127], v[96:111]
  s_waitcnt lgkmcnt(11)
  ds_read_b64_tr_b16 v[74:75], v4 offset:20992
  ds_read_b64_tr_b16 v[76:77], v4 offset:22528
  ds_read_b64_tr_b16 v[78:79], v4 offset:23040
  v_exp_f32 v18, -v82
  v_mfma_f32_32x32x16_bf16 v[96:111], v[48:51], v[128:131], v[96:111]
  s_waitcnt lgkmcnt(12)
  s_waitcnt lgkmcnt(0)
  s_barrier
  s_add_u32 s63, s75, 1024
  s_mov_b64 exec, s[78:79]
  buffer_store_dword v31, v30, s[36:39], s63 offen sc1
  s_mov_b64 exec, -1
  v_exp_f32 v19, -v83
  v_add_f32 v16, 1.0, v16
  v_mfma_f32_32x32x16_bf16 v[96:111], v[52:55], v[132:135], v[96:111]
  ds_write_b128 v12, v[24:27] offset:25600
  v_add_f32 v17, 1.0, v17
  v_add_f32 v18, 1.0, v18
  v_add_f32 v19, 1.0, v19
  v_rcp_f32 v16, v16
  v_mfma_f32_32x32x16_bf16 v[96:111], v[56:59], v[136:139], v[96:111]
  v_rcp_f32 v17, v17
  v_rcp_f32 v18, v18
  v_rcp_f32 v19, v19
  v_mfma_f32_32x32x16_bf16 v[96:111], v[60:63], v[140:143], v[96:111]
  v_mul_f32 v16, v80, v16
  v_mul_f32 v17, v81, v17
  v_mul_f32 v18, v82, v18
  v_mul_f32 v19, v83, v19
  v_cvt_pk_bf16_f32 v20, v16, v17
  v_cvt_pk_bf16_f32 v21, v18, v19
  v_mfma_f32_32x32x16_bf16 v[96:111], v[64:67], v[144:147], v[96:111]
  ds_read_b64_tr_b16 v[32:33], v4 offset:24576
  ds_read_b64_tr_b16 v[34:35], v4 offset:25088
  ds_read_b64_tr_b16 v[36:37], v4 offset:26624
  v_exp_f32 v16, -v84
  v_mfma_f32_32x32x16_bf16 v[96:111], v[68:71], v[148:151], v[96:111]
  ds_read_b64_tr_b16 v[38:39], v4 offset:27136
  ds_read_b64_tr_b16 v[40:41], v4 offset:28672
  ds_read_b64_tr_b16 v[42:43], v4 offset:29184
  v_exp_f32 v17, -v85
  v_mfma_f32_32x32x16_bf16 v[96:111], v[72:75], v[152:155], v[96:111]
  ds_read_b64_tr_b16 v[44:45], v4 offset:30720
  ds_read_b64_tr_b16 v[46:47], v4 offset:31232
  ds_read_b64_tr_b16 v[48:49], v4 offset:32768
  v_exp_f32 v18, -v86
  v_mfma_f32_32x32x16_bf16 v[96:111], v[76:79], v[156:159], v[96:111]
  s_waitcnt lgkmcnt(7)
  ds_read_b64_tr_b16 v[50:51], v4 offset:33280
  ds_read_b64_tr_b16 v[52:53], v4 offset:34816
  ds_read_b64_tr_b16 v[54:55], v4 offset:35328
  v_exp_f32 v19, -v87
  v_add_f32 v16, 1.0, v16
  v_mfma_f32_32x32x16_bf16 v[96:111], v[32:35], v[160:163], v[96:111]
  s_waitcnt lgkmcnt(8)
  ds_read_b64_tr_b16 v[56:57], v4 offset:36864
  ds_read_b64_tr_b16 v[58:59], v4 offset:37376
  ds_read_b64_tr_b16 v[60:61], v4 offset:38912
  v_add_f32 v17, 1.0, v17
  v_add_f32 v18, 1.0, v18
  v_add_f32 v19, 1.0, v19
  v_mfma_f32_32x32x16_bf16 v[96:111], v[36:39], v[164:167], v[96:111]
  s_waitcnt lgkmcnt(9)
  ds_read_b64_tr_b16 v[62:63], v4 offset:39424
  ds_read_b64_tr_b16 v[64:65], v4 offset:40960
  ds_read_b64_tr_b16 v[66:67], v4 offset:41472
  v_rcp_f32 v16, v16
  v_mfma_f32_32x32x16_bf16 v[96:111], v[40:43], v[168:171], v[96:111]
  s_waitcnt lgkmcnt(10)
  ds_read_b64_tr_b16 v[68:69], v4 offset:43008
  ds_read_b64_tr_b16 v[70:71], v4 offset:43520
  ds_read_b64_tr_b16 v[72:73], v4 offset:45056
  v_rcp_f32 v17, v17
  v_mfma_f32_32x32x16_bf16 v[96:111], v[44:47], v[172:175], v[96:111]
  s_waitcnt lgkmcnt(11)
  ds_read_b64_tr_b16 v[74:75], v4 offset:45568
  ds_read_b64_tr_b16 v[76:77], v4 offset:47104
  ds_read_b64_tr_b16 v[78:79], v4 offset:47616
  v_rcp_f32 v18, v18
  v_mfma_f32_32x32x16_bf16 v[96:111], v[48:51], v[176:179], v[96:111]
  s_waitcnt lgkmcnt(12)
  s_waitcnt lgkmcnt(0)
  s_barrier
  v_rcp_f32 v19, v19
  v_mul_f32 v16, v84, v16
  v_mul_f32 v17, v85, v17
  v_mul_f32 v18, v86, v18
  v_mul_f32 v19, v87, v19
  v_mfma_f32_32x32x16_bf16 v[96:111], v[52:55], v[180:183], v[96:111]
  v_cvt_pk_bf16_f32 v22, v16, v17
  v_cvt_pk_bf16_f32 v23, v18, v19
  v_exp_f32 v16, -v88
  v_exp_f32 v17, -v89
  v_mfma_f32_32x32x16_bf16 v[96:111], v[56:59], v[184:187], v[96:111]
  v_exp_f32 v18, -v90
  v_exp_f32 v19, -v91
  v_add_f32 v16, 1.0, v16
  v_mfma_f32_32x32x16_bf16 v[96:111], v[60:63], v[188:191], v[96:111]
  v_add_f32 v17, 1.0, v17
  v_add_f32 v18, 1.0, v18
  v_add_f32 v19, 1.0, v19
  v_rcp_f32 v16, v16
  v_mfma_f32_32x32x16_bf16 v[96:111], v[64:67], v[192:195], v[96:111]
  ds_read_b64_tr_b16 v[32:33], v4 offset:49152
  ds_read_b64_tr_b16 v[34:35], v4 offset:49664
  ds_read_b64_tr_b16 v[36:37], v4 offset:51200
  v_rcp_f32 v17, v17
  v_mfma_f32_32x32x16_bf16 v[96:111], v[68:71], v[196:199], v[96:111]
  ds_read_b64_tr_b16 v[38:39], v4 offset:51712
  ds_read_b64_tr_b16 v[40:41], v4 offset:53248
  ds_read_b64_tr_b16 v[42:43], v4 offset:53760
  v_rcp_f32 v18, v18
  v_mfma_f32_32x32x16_bf16 v[96:111], v[72:75], v[200:203], v[96:111]
  ds_read_b64_tr_b16 v[44:45], v4 offset:55296
  ds_read_b64_tr_b16 v[46:47], v4 offset:55808
  ds_read_b64_tr_b16 v[48:49], v5 offset:0
  v_rcp_f32 v19, v19
  v_mul_f32 v16, v88, v16
  v_mfma_f32_32x32x16_bf16 v[96:111], v[76:79], v[204:207], v[96:111]
  s_waitcnt lgkmcnt(7)
  ds_read_b64_tr_b16 v[50:51], v5 offset:512
  ds_read_b64_tr_b16 v[52:53], v5 offset:2048
  ds_read_b64_tr_b16 v[54:55], v5 offset:2560
  v_mul_f32 v17, v89, v17
  v_mul_f32 v18, v90, v18
  v_mul_f32 v19, v91, v19
  v_mfma_f32_32x32x16_bf16 v[96:111], v[32:35], v[208:211], v[96:111]
  s_waitcnt lgkmcnt(8)
  ds_read_b64_tr_b16 v[56:57], v5 offset:4096
  ds_read_b64_tr_b16 v[58:59], v5 offset:4608
  ds_read_b64_tr_b16 v[60:61], v5 offset:6144
  v_cvt_pk_bf16_f32 v24, v16, v17
  v_cvt_pk_bf16_f32 v25, v18, v19
  v_mfma_f32_32x32x16_bf16 v[96:111], v[36:39], v[212:215], v[96:111]
  s_waitcnt lgkmcnt(9)
  ds_read_b64_tr_b16 v[62:63], v5 offset:6656
  ds_read_b64_tr_b16 v[64:65], v5 offset:8192
  ds_read_b64_tr_b16 v[66:67], v5 offset:8704
  v_exp_f32 v16, -v92
  v_mfma_f32_32x32x16_bf16 v[96:111], v[40:43], v[216:219], v[96:111]
  s_waitcnt lgkmcnt(10)
  ds_read_b64_tr_b16 v[68:69], v5 offset:10240
  ds_read_b64_tr_b16 v[70:71], v5 offset:10752
  ds_read_b64_tr_b16 v[72:73], v5 offset:12288
  v_exp_f32 v17, -v93
  v_mfma_f32_32x32x16_bf16 v[96:111], v[44:47], v[220:223], v[96:111]
  s_waitcnt lgkmcnt(11)
  ds_read_b64_tr_b16 v[74:75], v5 offset:12800
  ds_read_b64_tr_b16 v[76:77], v5 offset:14336
  ds_read_b64_tr_b16 v[78:79], v5 offset:14848
  v_exp_f32 v18, -v94
  v_mfma_f32_32x32x16_bf16 v[96:111], v[48:51], v[224:227], v[96:111]
  s_waitcnt lgkmcnt(12)
  s_waitcnt lgkmcnt(0)
  s_barrier
  v_exp_f32 v19, -v95
  v_add_f32 v16, 1.0, v16
  v_add_f32 v17, 1.0, v17
  v_add_f32 v18, 1.0, v18
  v_add_f32 v19, 1.0, v19
  v_mfma_f32_32x32x16_bf16 v[96:111], v[52:55], v[228:231], v[96:111]
  ds_write_b128 v12, v[20:23] offset:32768
  v_rcp_f32 v16, v16
  v_rcp_f32 v17, v17
  v_mfma_f32_32x32x16_bf16 v[96:111], v[56:59], v[232:235], v[96:111]
  v_rcp_f32 v18, v18
  v_rcp_f32 v19, v19
  v_mul_f32 v16, v92, v16
  v_mfma_f32_32x32x16_bf16 v[96:111], v[60:63], v[236:239], v[96:111]
  v_mul_f32 v17, v93, v17
  v_mul_f32 v18, v94, v18
  v_mul_f32 v19, v95, v19
  v_cvt_pk_bf16_f32 v26, v16, v17
  v_mfma_f32_32x32x16_bf16 v[96:111], v[64:67], v[240:243], v[96:111]
  ds_read_b64_tr_b16 v[32:33], v4 offset:0
  ds_read_b64_tr_b16 v[34:35], v4 offset:512
  ds_read_b64_tr_b16 v[36:37], v4 offset:2048
  v_cvt_pk_bf16_f32 v27, v18, v19
  v_mfma_f32_32x32x16_bf16 v[96:111], v[68:71], v[244:247], v[96:111]
  ds_read_b64_tr_b16 v[38:39], v4 offset:2560
  ds_read_b64_tr_b16 v[40:41], v4 offset:4096
  ds_read_b64_tr_b16 v[42:43], v4 offset:4608
  v_mfma_f32_32x32x16_bf16 v[96:111], v[72:75], v[248:251], v[96:111]
  ds_read_b64_tr_b16 v[44:45], v4 offset:6144
  ds_read_b64_tr_b16 v[46:47], v4 offset:6656
  ds_read_b64_tr_b16 v[48:49], v4 offset:8192
  v_mfma_f32_32x32x16_bf16 v[96:111], v[76:79], v[252:255], v[96:111]
  s_waitcnt lgkmcnt(7)
  ds_read_b64_tr_b16 v[50:51], v4 offset:8704
  ds_read_b64_tr_b16 v[52:53], v4 offset:10240
  ds_read_b64_tr_b16 v[54:55], v4 offset:10752
  v_mfma_f32_32x32x16_bf16 v[80:95], v[32:35], v[112:115], 0
  s_waitcnt lgkmcnt(8)
  ds_read_b64_tr_b16 v[56:57], v4 offset:12288
  ds_read_b64_tr_b16 v[58:59], v4 offset:12800
  ds_read_b64_tr_b16 v[60:61], v4 offset:14336
  v_mfma_f32_32x32x16_bf16 v[80:95], v[36:39], v[116:119], v[80:95]
  s_waitcnt lgkmcnt(9)
  ds_read_b64_tr_b16 v[62:63], v4 offset:14848
  ds_read_b64_tr_b16 v[64:65], v4 offset:16384
  ds_read_b64_tr_b16 v[66:67], v4 offset:16896
  v_exp_f32 v16, -v96
  v_mfma_f32_32x32x16_bf16 v[80:95], v[40:43], v[120:123], v[80:95]
  s_waitcnt lgkmcnt(10)
  ds_read_b64_tr_b16 v[68:69], v4 offset:18432
  ds_read_b64_tr_b16 v[70:71], v4 offset:18944
  ds_read_b64_tr_b16 v[72:73], v4 offset:20480
  v_exp_f32 v17, -v97
  v_mfma_f32_32x32x16_bf16 v[80:95], v[44:47], v[124:127], v[80:95]
  s_waitcnt lgkmcnt(11)
  ds_read_b64_tr_b16 v[74:75], v4 offset:20992
  ds_read_b64_tr_b16 v[76:77], v4 offset:22528
  ds_read_b64_tr_b16 v[78:79], v4 offset:23040
  v_exp_f32 v18, -v98
  v_mfma_f32_32x32x16_bf16 v[80:95], v[48:51], v[128:131], v[80:95]
  s_waitcnt lgkmcnt(12)
  s_waitcnt lgkmcnt(0)
  s_barrier
  v_exp_f32 v19, -v99
  v_add_f32 v16, 1.0, v16
  v_add_f32 v17, 1.0, v17
  v_add_f32 v18, 1.0, v18
  v_add_f32 v19, 1.0, v19
  v_mfma_f32_32x32x16_bf16 v[80:95], v[52:55], v[132:135], v[80:95]
  ds_write_b128 v12, v[24:27] offset:33792
  v_rcp_f32 v16, v16
  v_rcp_f32 v17, v17
  v_mfma_f32_32x32x16_bf16 v[80:95], v[56:59], v[136:139], v[80:95]
  v_rcp_f32 v18, v18
  v_rcp_f32 v19, v19
  v_mul_f32 v16, v96, v16
  v_mul_f32 v17, v97, v17
  v_mfma_f32_32x32x16_bf16 v[80:95], v[60:63], v[140:143], v[80:95]
  v_mul_f32 v18, v98, v18
  v_mul_f32 v19, v99, v19
  v_cvt_pk_bf16_f32 v20, v16, v17
  v_cvt_pk_bf16_f32 v21, v18, v19
  v_exp_f32 v16, -v100
  v_mfma_f32_32x32x16_bf16 v[80:95], v[64:67], v[144:147], v[80:95]
  ds_read_b64_tr_b16 v[32:33], v4 offset:24576
  ds_read_b64_tr_b16 v[34:35], v4 offset:25088
  ds_read_b64_tr_b16 v[36:37], v4 offset:26624
  v_exp_f32 v17, -v101
  v_mfma_f32_32x32x16_bf16 v[80:95], v[68:71], v[148:151], v[80:95]
  ds_read_b64_tr_b16 v[38:39], v4 offset:27136
  ds_read_b64_tr_b16 v[40:41], v4 offset:28672
  ds_read_b64_tr_b16 v[42:43], v4 offset:29184
  v_exp_f32 v18, -v102
  v_mfma_f32_32x32x16_bf16 v[80:95], v[72:75], v[152:155], v[80:95]
  ds_read_b64_tr_b16 v[44:45], v4 offset:30720
  ds_read_b64_tr_b16 v[46:47], v4 offset:31232
  ds_read_b64_tr_b16 v[48:49], v4 offset:32768
  v_exp_f32 v19, -v103
  v_add_f32 v16, 1.0, v16
  v_mfma_f32_32x32x16_bf16 v[80:95], v[76:79], v[156:159], v[80:95]
  s_waitcnt lgkmcnt(7)
  ds_read_b64_tr_b16 v[50:51], v4 offset:33280
  ds_read_b64_tr_b16 v[52:53], v4 offset:34816
  ds_read_b64_tr_b16 v[54:55], v4 offset:35328
  v_add_f32 v17, 1.0, v17
  v_add_f32 v18, 1.0, v18
  v_add_f32 v19, 1.0, v19
  v_mfma_f32_32x32x16_bf16 v[80:95], v[32:35], v[160:163], v[80:95]
  s_waitcnt lgkmcnt(8)
  ds_read_b64_tr_b16 v[56:57], v4 offset:36864
  ds_read_b64_tr_b16 v[58:59], v4 offset:37376
  ds_read_b64_tr_b16 v[60:61], v4 offset:38912
  v_rcp_f32 v16, v16
  v_mfma_f32_32x32x16_bf16 v[80:95], v[36:39], v[164:167], v[80:95]
  s_waitcnt lgkmcnt(9)
  ds_read_b64_tr_b16 v[62:63], v4 offset:39424
  ds_read_b64_tr_b16 v[64:65], v4 offset:40960
  ds_read_b64_tr_b16 v[66:67], v4 offset:41472
  v_rcp_f32 v17, v17
  v_mfma_f32_32x32x16_bf16 v[80:95], v[40:43], v[168:171], v[80:95]
  s_waitcnt lgkmcnt(10)
  ds_read_b64_tr_b16 v[68:69], v4 offset:43008
  ds_read_b64_tr_b16 v[70:71], v4 offset:43520
  ds_read_b64_tr_b16 v[72:73], v4 offset:45056
  v_rcp_f32 v18, v18
  v_mfma_f32_32x32x16_bf16 v[80:95], v[44:47], v[172:175], v[80:95]
  s_waitcnt lgkmcnt(11)
  ds_read_b64_tr_b16 v[74:75], v4 offset:45568
  ds_read_b64_tr_b16 v[76:77], v4 offset:47104
  ds_read_b64_tr_b16 v[78:79], v4 offset:47616
  v_rcp_f32 v19, v19
  v_mul_f32 v16, v100, v16
  v_mfma_f32_32x32x16_bf16 v[80:95], v[48:51], v[176:179], v[80:95]
  s_waitcnt lgkmcnt(12)
  s_waitcnt lgkmcnt(0)
  s_barrier
  v_mul_f32 v17, v101, v17
  v_mul_f32 v18, v102, v18
  v_mul_f32 v19, v103, v19
  v_cvt_pk_bf16_f32 v22, v16, v17
  v_cvt_pk_bf16_f32 v23, v18, v19
  v_mfma_f32_32x32x16_bf16 v[80:95], v[52:55], v[180:183], v[80:95]
  ds_write_b128 v12, v[20:23] offset:40960
  v_exp_f32 v16, -v104
  v_exp_f32 v17, -v105
  v_mfma_f32_32x32x16_bf16 v[80:95], v[56:59], v[184:187], v[80:95]
  v_exp_f32 v18, -v106
  v_exp_f32 v19, -v107
  v_add_f32 v16, 1.0, v16
  v_mfma_f32_32x32x16_bf16 v[80:95], v[60:63], v[188:191], v[80:95]
  v_add_f32 v17, 1.0, v17
  v_add_f32 v18, 1.0, v18
  v_add_f32 v19, 1.0, v19
  v_rcp_f32 v16, v16
  v_mfma_f32_32x32x16_bf16 v[80:95], v[64:67], v[192:195], v[80:95]
  ds_read_b64_tr_b16 v[32:33], v4 offset:49152
  ds_read_b64_tr_b16 v[34:35], v4 offset:49664
  ds_read_b64_tr_b16 v[36:37], v4 offset:51200
  v_rcp_f32 v17, v17
  v_mfma_f32_32x32x16_bf16 v[80:95], v[68:71], v[196:199], v[80:95]
  ds_read_b64_tr_b16 v[38:39], v4 offset:51712
  ds_read_b64_tr_b16 v[40:41], v4 offset:53248
  ds_read_b64_tr_b16 v[42:43], v4 offset:53760
  v_rcp_f32 v18, v18
  v_mfma_f32_32x32x16_bf16 v[80:95], v[72:75], v[200:203], v[80:95]
  ds_read_b64_tr_b16 v[44:45], v4 offset:55296
  ds_read_b64_tr_b16 v[46:47], v4 offset:55808
  ds_read_b64_tr_b16 v[48:49], v5 offset:0
  v_rcp_f32 v19, v19
  v_mul_f32 v16, v104, v16
  v_mfma_f32_32x32x16_bf16 v[80:95], v[76:79], v[204:207], v[80:95]
  s_waitcnt lgkmcnt(7)
  ds_read_b64_tr_b16 v[50:51], v5 offset:512
  ds_read_b64_tr_b16 v[52:53], v5 offset:2048
  ds_read_b64_tr_b16 v[54:55], v5 offset:2560
  v_mul_f32 v17, v105, v17
  v_mul_f32 v18, v106, v18
  v_mul_f32 v19, v107, v19
  v_mfma_f32_32x32x16_bf16 v[80:95], v[32:35], v[208:211], v[80:95]
  s_waitcnt lgkmcnt(8)
  ds_read_b64_tr_b16 v[56:57], v5 offset:4096
  ds_read_b64_tr_b16 v[58:59], v5 offset:4608
  ds_read_b64_tr_b16 v[60:61], v5 offset:6144
  v_cvt_pk_bf16_f32 v24, v16, v17
  v_cvt_pk_bf16_f32 v25, v18, v19
  v_mfma_f32_32x32x16_bf16 v[80:95], v[36:39], v[212:215], v[80:95]
  s_waitcnt lgkmcnt(9)
  ds_read_b64_tr_b16 v[62:63], v5 offset:6656
  ds_read_b64_tr_b16 v[64:65], v5 offset:8192
  ds_read_b64_tr_b16 v[66:67], v5 offset:8704
  v_exp_f32 v16, -v108
  v_mfma_f32_32x32x16_bf16 v[80:95], v[40:43], v[216:219], v[80:95]
  s_waitcnt lgkmcnt(10)
  ds_read_b64_tr_b16 v[68:69], v5 offset:10240
  ds_read_b64_tr_b16 v[70:71], v5 offset:10752
  ds_read_b64_tr_b16 v[72:73], v5 offset:12288
  v_exp_f32 v17, -v109
  v_mfma_f32_32x32x16_bf16 v[80:95], v[44:47], v[220:223], v[80:95]
  s_waitcnt lgkmcnt(11)
  ds_read_b64_tr_b16 v[74:75], v5 offset:12800
  ds_read_b64_tr_b16 v[76:77], v5 offset:14336
  ds_read_b64_tr_b16 v[78:79], v5 offset:14848
  v_exp_f32 v18, -v110
  v_mfma_f32_32x32x16_bf16 v[80:95], v[48:51], v[224:227], v[80:95]
  s_waitcnt lgkmcnt(12)
  s_waitcnt lgkmcnt(0)
  s_barrier
  v_exp_f32 v19, -v111
  v_add_f32 v16, 1.0, v16
  v_add_f32 v17, 1.0, v17
  v_add_f32 v18, 1.0, v18
  v_add_f32 v19, 1.0, v19
  v_mfma_f32_32x32x16_bf16 v[80:95], v[52:55], v[228:231], v[80:95]
  v_rcp_f32 v16, v16
  v_rcp_f32 v17, v17
  v_rcp_f32 v18, v18
  v_mfma_f32_32x32x16_bf16 v[80:95], v[56:59], v[232:235], v[80:95]
  v_rcp_f32 v19, v19
  v_mul_f32 v16, v108, v16
  v_mul_f32 v17, v109, v17
  v_mfma_f32_32x32x16_bf16 v[80:95], v[60:63], v[236:239], v[80:95]
  v_mul_f32 v18, v110, v18
  v_mul_f32 v19, v111, v19
  v_cvt_pk_bf16_f32 v26, v16, v17
  v_cvt_pk_bf16_f32 v27, v18, v19
  v_mfma_f32_32x32x16_bf16 v[80:95], v[64:67], v[240:243], v[80:95]
  ds_read_b64_tr_b16 v[32:33], v4 offset:0
  ds_read_b64_tr_b16 v[34:35], v4 offset:512
  ds_read_b64_tr_b16 v[36:37], v4 offset:2048
  v_mfma_f32_32x32x16_bf16 v[80:95], v[68:71], v[244:247], v[80:95]
  ds_read_b64_tr_b16 v[38:39], v4 offset:2560
  ds_read_b64_tr_b16 v[40:41], v4 offset:4096
  ds_read_b64_tr_b16 v[42:43], v4 offset:4608
  v_mfma_f32_32x32x16_bf16 v[80:95], v[72:75], v[248:251], v[80:95]
  ds_read_b64_tr_b16 v[44:45], v4 offset:6144
  ds_read_b64_tr_b16 v[46:47], v4 offset:6656
  ds_read_b64_tr_b16 v[48:49], v4 offset:8192
  v_mfma_f32_32x32x16_bf16 v[80:95], v[76:79], v[252:255], v[80:95]
  s_waitcnt lgkmcnt(7)
  ds_read_b64_tr_b16 v[50:51], v4 offset:8704
  ds_read_b64_tr_b16 v[52:53], v4 offset:10240
  ds_read_b64_tr_b16 v[54:55], v4 offset:10752
  v_mfma_f32_32x32x16_bf16 v[96:111], v[32:35], v[112:115], 0
  s_waitcnt lgkmcnt(8)
  ds_read_b64_tr_b16 v[56:57], v4 offset:12288
  ds_read_b64_tr_b16 v[58:59], v4 offset:12800
  ds_read_b64_tr_b16 v[60:61], v4 offset:14336
  v_mfma_f32_32x32x16_bf16 v[96:111], v[36:39], v[116:119], v[96:111]
  s_waitcnt lgkmcnt(9)
  ds_read_b64_tr_b16 v[62:63], v4 offset:14848
  ds_read_b64_tr_b16 v[64:65], v4 offset:16384
  ds_read_b64_tr_b16 v[66:67], v4 offset:16896
  v_exp_f32 v16, -v80
  v_mfma_f32_32x32x16_bf16 v[96:111], v[40:43], v[120:123], v[96:111]
  s_waitcnt lgkmcnt(10)
  ds_read_b64_tr_b16 v[68:69], v4 offset:18432
  ds_read_b64_tr_b16 v[70:71], v4 offset:18944
  ds_read_b64_tr_b16 v[72:73], v4 offset:20480
  v_exp_f32 v17, -v81
  v_mfma_f32_32x32x16_bf16 v[96:111], v[44:47], v[124:127], v[96:111]
  s_waitcnt lgkmcnt(11)
  ds_read_b64_tr_b16 v[74:75], v4 offset:20992
  ds_read_b64_tr_b16 v[76:77], v4 offset:22528
  ds_read_b64_tr_b16 v[78:79], v4 offset:23040
  v_exp_f32 v18, -v82
  v_mfma_f32_32x32x16_bf16 v[96:111], v[48:51], v[128:131], v[96:111]
  s_waitcnt lgkmcnt(12)
  s_waitcnt lgkmcnt(0)
  s_barrier
  v_exp_f32 v19, -v83
  v_add_f32 v16, 1.0, v16
  v_add_f32 v17, 1.0, v17
  v_add_f32 v18, 1.0, v18
  v_add_f32 v19, 1.0, v19
  v_mfma_f32_32x32x16_bf16 v[96:111], v[52:55], v[132:135], v[96:111]
  ds_write_b128 v12, v[24:27] offset:41984
  v_rcp_f32 v16, v16
  v_rcp_f32 v17, v17
  v_mfma_f32_32x32x16_bf16 v[96:111], v[56:59], v[136:139], v[96:111]
  v_rcp_f32 v18, v18
  v_rcp_f32 v19, v19
  v_mul_f32 v16, v80, v16
  v_mul_f32 v17, v81, v17
  v_mfma_f32_32x32x16_bf16 v[96:111], v[60:63], v[140:143], v[96:111]
  v_mul_f32 v18, v82, v18
  v_mul_f32 v19, v83, v19
  v_cvt_pk_bf16_f32 v20, v16, v17
  v_cvt_pk_bf16_f32 v21, v18, v19
  v_exp_f32 v16, -v84
  v_mfma_f32_32x32x16_bf16 v[96:111], v[64:67], v[144:147], v[96:111]
  ds_read_b64_tr_b16 v[32:33], v4 offset:24576
  ds_read_b64_tr_b16 v[34:35], v4 offset:25088
  ds_read_b64_tr_b16 v[36:37], v4 offset:26624
  v_exp_f32 v17, -v85
  v_mfma_f32_32x32x16_bf16 v[96:111], v[68:71], v[148:151], v[96:111]
  ds_read_b64_tr_b16 v[38:39], v4 offset:27136
  ds_read_b64_tr_b16 v[40:41], v4 offset:28672
  ds_read_b64_tr_b16 v[42:43], v4 offset:29184
  v_exp_f32 v18, -v86
  v_mfma_f32_32x32x16_bf16 v[96:111], v[72:75], v[152:155], v[96:111]
  ds_read_b64_tr_b16 v[44:45], v4 offset:30720
  ds_read_b64_tr_b16 v[46:47], v4 offset:31232
  ds_read_b64_tr_b16 v[48:49], v4 offset:32768
  v_exp_f32 v19, -v87
  v_add_f32 v16, 1.0, v16
  v_mfma_f32_32x32x16_bf16 v[96:111], v[76:79], v[156:159], v[96:111]
  s_waitcnt lgkmcnt(7)
  ds_read_b64_tr_b16 v[50:51], v4 offset:33280
  ds_read_b64_tr_b16 v[52:53], v4 offset:34816
  ds_read_b64_tr_b16 v[54:55], v4 offset:35328
  v_add_f32 v17, 1.0, v17
  v_add_f32 v18, 1.0, v18
  v_add_f32 v19, 1.0, v19
  v_mfma_f32_32x32x16_bf16 v[96:111], v[32:35], v[160:163], v[96:111]
  s_waitcnt lgkmcnt(8)
  ds_read_b64_tr_b16 v[56:57], v4 offset:36864
  ds_read_b64_tr_b16 v[58:59], v4 offset:37376
  ds_read_b64_tr_b16 v[60:61], v4 offset:38912
  v_rcp_f32 v16, v16
  v_mfma_f32_32x32x16_bf16 v[96:111], v[36:39], v[164:167], v[96:111]
  s_waitcnt lgkmcnt(9)
  ds_read_b64_tr_b16 v[62:63], v4 offset:39424
  ds_read_b64_tr_b16 v[64:65], v4 offset:40960
  ds_read_b64_tr_b16 v[66:67], v4 offset:41472
  v_rcp_f32 v17, v17
  v_mfma_f32_32x32x16_bf16 v[96:111], v[40:43], v[168:171], v[96:111]
  s_waitcnt lgkmcnt(10)
  ds_read_b64_tr_b16 v[68:69], v4 offset:43008
  ds_read_b64_tr_b16 v[70:71], v4 offset:43520
  ds_read_b64_tr_b16 v[72:73], v4 offset:45056
  v_rcp_f32 v18, v18
  v_mfma_f32_32x32x16_bf16 v[96:111], v[44:47], v[172:175], v[96:111]
  s_waitcnt lgkmcnt(11)
  ds_read_b64_tr_b16 v[74:75], v4 offset:45568
  ds_read_b64_tr_b16 v[76:77], v4 offset:47104
  ds_read_b64_tr_b16 v[78:79], v4 offset:47616
  v_rcp_f32 v19, v19
  v_mul_f32 v16, v84, v16
  v_mfma_f32_32x32x16_bf16 v[96:111], v[48:51], v[176:179], v[96:111]
  s_waitcnt lgkmcnt(12)
  s_waitcnt lgkmcnt(0)
  s_barrier
  v_mul_f32 v17, v85, v17
  v_mul_f32 v18, v86, v18
  v_mul_f32 v19, v87, v19
  v_cvt_pk_bf16_f32 v22, v16, v17
  v_cvt_pk_bf16_f32 v23, v18, v19
  v_mfma_f32_32x32x16_bf16 v[96:111], v[52:55], v[180:183], v[96:111]
  ds_write_b128 v12, v[20:23] offset:49152
  v_exp_f32 v16, -v88
  v_exp_f32 v17, -v89
  v_mfma_f32_32x32x16_bf16 v[96:111], v[56:59], v[184:187], v[96:111]
  v_exp_f32 v18, -v90
  v_exp_f32 v19, -v91
  v_add_f32 v16, 1.0, v16
  v_mfma_f32_32x32x16_bf16 v[96:111], v[60:63], v[188:191], v[96:111]
  v_add_f32 v17, 1.0, v17
  v_add_f32 v18, 1.0, v18
  v_add_f32 v19, 1.0, v19
  v_rcp_f32 v16, v16
  v_mfma_f32_32x32x16_bf16 v[96:111], v[64:67], v[192:195], v[96:111]
  ds_read_b64_tr_b16 v[32:33], v4 offset:49152
  ds_read_b64_tr_b16 v[34:35], v4 offset:49664
  ds_read_b64_tr_b16 v[36:37], v4 offset:51200
  v_rcp_f32 v17, v17
  v_mfma_f32_32x32x16_bf16 v[96:111], v[68:71], v[196:199], v[96:111]
  ds_read_b64_tr_b16 v[38:39], v4 offset:51712
  ds_read_b64_tr_b16 v[40:41], v4 offset:53248
  ds_read_b64_tr_b16 v[42:43], v4 offset:53760
  v_rcp_f32 v18, v18
  v_mfma_f32_32x32x16_bf16 v[96:111], v[72:75], v[200:203], v[96:111]
  ds_read_b64_tr_b16 v[44:45], v4 offset:55296
  ds_read_b64_tr_b16 v[46:47], v4 offset:55808
  ds_read_b64_tr_b16 v[48:49], v5 offset:0
  v_rcp_f32 v19, v19
  v_mul_f32 v16, v88, v16
  v_mfma_f32_32x32x16_bf16 v[96:111], v[76:79], v[204:207], v[96:111]
  s_waitcnt lgkmcnt(7)
  ds_read_b64_tr_b16 v[50:51], v5 offset:512
  ds_read_b64_tr_b16 v[52:53], v5 offset:2048
  ds_read_b64_tr_b16 v[54:55], v5 offset:2560
  v_mul_f32 v17, v89, v17
  v_mul_f32 v18, v90, v18
  v_mul_f32 v19, v91, v19
  v_mfma_f32_32x32x16_bf16 v[96:111], v[32:35], v[208:211], v[96:111]
  s_waitcnt lgkmcnt(8)
  ds_read_b64_tr_b16 v[56:57], v5 offset:4096
  ds_read_b64_tr_b16 v[58:59], v5 offset:4608
  ds_read_b64_tr_b16 v[60:61], v5 offset:6144
  v_cvt_pk_bf16_f32 v24, v16, v17
  v_cvt_pk_bf16_f32 v25, v18, v19
  v_mfma_f32_32x32x16_bf16 v[96:111], v[36:39], v[212:215], v[96:111]
  s_waitcnt lgkmcnt(9)
  ds_read_b64_tr_b16 v[62:63], v5 offset:6656
  ds_read_b64_tr_b16 v[64:65], v5 offset:8192
  ds_read_b64_tr_b16 v[66:67], v5 offset:8704
  v_exp_f32 v16, -v92
  v_mfma_f32_32x32x16_bf16 v[96:111], v[40:43], v[216:219], v[96:111]
  s_waitcnt lgkmcnt(10)
  ds_read_b64_tr_b16 v[68:69], v5 offset:10240
  ds_read_b64_tr_b16 v[70:71], v5 offset:10752
  ds_read_b64_tr_b16 v[72:73], v5 offset:12288
  v_exp_f32 v17, -v93
  v_mfma_f32_32x32x16_bf16 v[96:111], v[44:47], v[220:223], v[96:111]
  s_waitcnt lgkmcnt(11)
  ds_read_b64_tr_b16 v[74:75], v5 offset:12800
  ds_read_b64_tr_b16 v[76:77], v5 offset:14336
  ds_read_b64_tr_b16 v[78:79], v5 offset:14848
  v_exp_f32 v18, -v94
  v_mfma_f32_32x32x16_bf16 v[96:111], v[48:51], v[224:227], v[96:111]
  s_waitcnt lgkmcnt(12)
  s_waitcnt lgkmcnt(0)
  s_barrier
  v_exp_f32 v19, -v95
  v_add_f32 v16, 1.0, v16
  v_add_f32 v17, 1.0, v17
  v_add_f32 v18, 1.0, v18
  v_add_f32 v19, 1.0, v19
  v_mfma_f32_32x32x16_bf16 v[96:111], v[52:55], v[228:231], v[96:111]
  v_rcp_f32 v16, v16
  v_rcp_f32 v17, v17
  v_rcp_f32 v18, v18
  v_mfma_f32_32x32x16_bf16 v[96:111], v[56:59], v[232:235], v[96:111]
  v_rcp_f32 v19, v19
  v_mul_f32 v16, v92, v16
  v_mul_f32 v17, v93, v17
  v_mfma_f32_32x32x16_bf16 v[96:111], v[60:63], v[236:239], v[96:111]
  v_mul_f32 v18, v94, v18
  v_mul_f32 v19, v95, v19
  v_cvt_pk_bf16_f32 v26, v16, v17
  v_cvt_pk_bf16_f32 v27, v18, v19
  v_mfma_f32_32x32x16_bf16 v[96:111], v[64:67], v[240:243], v[96:111]
  ds_read_b64_tr_b16 v[32:33], v4 offset:0
  ds_read_b64_tr_b16 v[34:35], v4 offset:512
  ds_read_b64_tr_b16 v[36:37], v4 offset:2048
  v_mfma_f32_32x32x16_bf16 v[96:111], v[68:71], v[244:247], v[96:111]
  ds_read_b64_tr_b16 v[38:39], v4 offset:2560
  ds_read_b64_tr_b16 v[40:41], v4 offset:4096
  ds_read_b64_tr_b16 v[42:43], v4 offset:4608
  v_mfma_f32_32x32x16_bf16 v[96:111], v[72:75], v[248:251], v[96:111]
  ds_read_b64_tr_b16 v[44:45], v4 offset:6144
  ds_read_b64_tr_b16 v[46:47], v4 offset:6656
  ds_read_b64_tr_b16 v[48:49], v4 offset:8192
  v_mfma_f32_32x32x16_bf16 v[96:111], v[76:79], v[252:255], v[96:111]
  s_waitcnt lgkmcnt(7)
  ds_read_b64_tr_b16 v[50:51], v4 offset:8704
  ds_read_b64_tr_b16 v[52:53], v4 offset:10240
  ds_read_b64_tr_b16 v[54:55], v4 offset:10752
  v_mfma_f32_32x32x16_bf16 v[80:95], v[32:35], v[112:115], 0
  s_waitcnt lgkmcnt(8)
  ds_read_b64_tr_b16 v[56:57], v4 offset:12288
  ds_read_b64_tr_b16 v[58:59], v4 offset:12800
  ds_read_b64_tr_b16 v[60:61], v4 offset:14336
  v_mfma_f32_32x32x16_bf16 v[80:95], v[36:39], v[116:119], v[80:95]
  s_waitcnt lgkmcnt(9)
  ds_read_b64_tr_b16 v[62:63], v4 offset:14848
  ds_read_b64_tr_b16 v[64:65], v4 offset:16384
  ds_read_b64_tr_b16 v[66:67], v4 offset:16896
  v_exp_f32 v16, -v96
  v_mfma_f32_32x32x16_bf16 v[80:95], v[40:43], v[120:123], v[80:95]
  s_waitcnt lgkmcnt(10)
  ds_read_b64_tr_b16 v[68:69], v4 offset:18432
  ds_read_b64_tr_b16 v[70:71], v4 offset:18944
  ds_read_b64_tr_b16 v[72:73], v4 offset:20480
  ds_read_b128 v[112:115], v14 offset:0
  v_exp_f32 v17, -v97
  v_mfma_f32_32x32x16_bf16 v[80:95], v[44:47], v[124:127], v[80:95]
  s_waitcnt lgkmcnt(12)
  ds_read_b64_tr_b16 v[74:75], v4 offset:20992
  ds_read_b64_tr_b16 v[76:77], v4 offset:22528
  ds_read_b64_tr_b16 v[78:79], v4 offset:23040
  ds_read_b128 v[116:119], v14 offset:1024
  v_exp_f32 v18, -v98
  v_mfma_f32_32x32x16_bf16 v[80:95], v[48:51], v[128:131], v[80:95]
  s_waitcnt lgkmcnt(14)
  s_waitcnt lgkmcnt(1)
  s_barrier
  ds_read_b128 v[120:123], v14 offset:4096
  v_exp_f32 v19, -v99
  v_add_f32 v16, 1.0, v16
  v_add_f32 v17, 1.0, v17
  v_add_f32 v18, 1.0, v18
  v_mfma_f32_32x32x16_bf16 v[80:95], v[52:55], v[132:135], v[80:95]
  ds_read_b128 v[124:127], v14 offset:5120
  ds_write_b128 v12, v[24:27] offset:50176
  v_add_f32 v19, 1.0, v19
  v_rcp_f32 v16, v16
  v_mfma_f32_32x32x16_bf16 v[80:95], v[56:59], v[136:139], v[80:95]
  ds_read_b128 v[128:131], v14 offset:8192
  v_rcp_f32 v17, v17
  v_rcp_f32 v18, v18
  v_mfma_f32_32x32x16_bf16 v[80:95], v[60:63], v[140:143], v[80:95]
  ds_read_b128 v[132:135], v14 offset:9216
  v_rcp_f32 v19, v19
  v_mul_f32 v16, v96, v16
  v_mul_f32 v17, v97, v17
  v_mul_f32 v18, v98, v18
  v_mfma_f32_32x32x16_bf16 v[80:95], v[64:67], v[144:147], v[80:95]
  ds_read_b64_tr_b16 v[32:33], v4 offset:24576
  ds_read_b64_tr_b16 v[34:35], v4 offset:25088
  ds_read_b64_tr_b16 v[36:37], v4 offset:26624
  ds_read_b128 v[136:139], v14 offset:12288
  v_mul_f32 v19, v99, v19
  v_cvt_pk_bf16_f32 v20, v16, v17
  v_mfma_f32_32x32x16_bf16 v[80:95], v[68:71], v[148:151], v[80:95]
  ds_read_b64_tr_b16 v[38:39], v4 offset:27136
  ds_read_b64_tr_b16 v[40:41], v4 offset:28672
  ds_read_b64_tr_b16 v[42:43], v4 offset:29184
  ds_read_b128 v[140:143], v14 offset:13312
  v_cvt_pk_bf16_f32 v21, v18, v19
  v_mfma_f32_32x32x16_bf16 v[80:95], v[72:75], v[152:155], v[80:95]
  ds_read_b64_tr_b16 v[44:45], v4 offset:30720
  ds_read_b64_tr_b16 v[46:47], v4 offset:31232
  ds_read_b64_tr_b16 v[48:49], v4 offset:32768
  ds_read_b128 v[144:147], v14 offset:16384
  v_exp_f32 v16, -v100
  v_mfma_f32_32x32x16_bf16 v[80:95], v[76:79], v[156:159], v[80:95]
  s_waitcnt lgkmcnt(10)
  ds_read_b64_tr_b16 v[50:51], v4 offset:33280
  ds_read_b64_tr_b16 v[52:53], v4 offset:34816
  ds_read_b64_tr_b16 v[54:55], v4 offset:35328
  ds_read_b128 v[148:151], v14 offset:17408
  v_exp_f32 v17, -v101
  v_mfma_f32_32x32x16_bf16 v[80:95], v[32:35], v[160:163], v[80:95]
  s_waitcnt lgkmcnt(11)
  ds_read_b64_tr_b16 v[56:57], v4 offset:36864
  ds_read_b64_tr_b16 v[58:59], v4 offset:37376
  ds_read_b64_tr_b16 v[60:61], v4 offset:38912
  ds_read_b128 v[152:155], v14 offset:20480
  v_exp_f32 v18, -v102
  v_mfma_f32_32x32x16_bf16 v[80:95], v[36:39], v[164:167], v[80:95]
  s_waitcnt lgkmcnt(13)
  ds_read_b64_tr_b16 v[62:63], v4 offset:39424
  ds_read_b64_tr_b16 v[64:65], v4 offset:40960
  ds_read_b64_tr_b16 v[66:67], v4 offset:41472
  ds_read_b128 v[156:159], v14 offset:21504
  v_exp_f32 v19, -v103
  v_mfma_f32_32x32x16_bf16 v[80:95], v[40:43], v[168:171], v[80:95]
  s_waitcnt lgkmcnt(14)
  ds_read_b64_tr_b16 v[68:69], v4 offset:43008
  ds_read_b64_tr_b16 v[70:71], v4 offset:43520
  ds_read_b64_tr_b16 v[72:73], v4 offset:45056
  ds_read_b128 v[160:163], v14 offset:24576
  v_add_f32 v16, 1.0, v16
  v_add_f32 v17, 1.0, v17
  v_mfma_f32_32x32x16_bf16 v[80:95], v[44:47], v[172:175], v[80:95]
  s_waitcnt lgkmcnt(15)
  ds_read_b64_tr_b16 v[74:75], v4 offset:45568
  ds_read_b64_tr_b16 v[76:77], v4 offset:47104
  ds_read_b64_tr_b16 v[78:79], v4 offset:47616
  ds_read_b128 v[164:167], v14 offset:25600
  v_add_f32 v18, 1.0, v18
  v_add_f32 v19, 1.0, v19
  v_mfma_f32_32x32x16_bf16 v[80:95], v[48:51], v[176:179], v[80:95]
  s_waitcnt lgkmcnt(15)
  s_waitcnt lgkmcnt(1)
  s_barrier
  ds_read_b128 v[168:171], v14 offset:28672
  v_rcp_f32 v16, v16
  v_rcp_f32 v17, v17
  v_mfma_f32_32x32x16_bf16 v[80:95], v[52:55], v[180:183], v[80:95]
  ds_read_b128 v[172:175], v14 offset:29696
  v_rcp_f32 v18, v18
  v_rcp_f32 v19, v19
  v_mul_f32 v16, v100, v16
  v_mfma_f32_32x32x16_bf16 v[80:95], v[56:59], v[184:187], v[80:95]
  ds_read_b128 v[176:179], v14 offset:32768
  v_mul_f32 v17, v101, v17
  v_mul_f32 v18, v102, v18
  v_mul_f32 v19, v103, v19
  v_cvt_pk_bf16_f32 v22, v16, v17
  v_cvt_pk_bf16_f32 v23, v18, v19
  v_mfma_f32_32x32x16_bf16 v[80:95], v[60:63], v[188:191], v[80:95]
  ds_read_b128 v[180:183], v14 offset:33792
  v_exp_f32 v16, -v104
  v_exp_f32 v17, -v105
  v_mfma_f32_32x32x16_bf16 v[80:95], v[64:67], v[192:195], v[80:95]
  ds_read_b64_tr_b16 v[32:33], v4 offset:49152
  ds_read_b64_tr_b16 v[34:35], v4 offset:49664
  ds_read_b64_tr_b16 v[36:37], v4 offset:51200
  ds_read_b128 v[184:187], v14 offset:36864
  v_exp_f32 v18, -v106
  v_mfma_f32_32x32x16_bf16 v[80:95], v[68:71], v[196:199], v[80:95]
  ds_read_b64_tr_b16 v[38:39], v4 offset:51712
  ds_read_b64_tr_b16 v[40:41], v4 offset:53248
  ds_read_b64_tr_b16 v[42:43], v4 offset:53760
  ds_read_b128 v[188:191], v14 offset:37888
  v_exp_f32 v19, -v107
  v_mfma_f32_32x32x16_bf16 v[80:95], v[72:75], v[200:203], v[80:95]
  ds_read_b64_tr_b16 v[44:45], v4 offset:55296
  ds_read_b64_tr_b16 v[46:47], v4 offset:55808
  ds_read_b64_tr_b16 v[48:49], v5 offset:0
  ds_read_b128 v[192:195], v14 offset:40960
  v_add_f32 v16, 1.0, v16
  v_add_f32 v17, 1.0, v17
  v_mfma_f32_32x32x16_bf16 v[80:95], v[76:79], v[204:207], v[80:95]
  s_waitcnt lgkmcnt(10)
  ds_read_b64_tr_b16 v[50:51], v5 offset:512
  ds_read_b64_tr_b16 v[52:53], v5 offset:2048
  ds_read_b64_tr_b16 v[54:55], v5 offset:2560
  ds_read_b128 v[196:199], v14 offset:41984
  v_add_f32 v18, 1.0, v18
  v_add_f32 v19, 1.0, v19
  v_mfma_f32_32x32x16_bf16 v[80:95], v[32:35], v[208:211], v[80:95]
  s_waitcnt lgkmcnt(11)
  ds_read_b64_tr_b16 v[56:57], v5 offset:4096
  ds_read_b64_tr_b16 v[58:59], v5 offset:4608
  ds_read_b64_tr_b16 v[60:61], v5 offset:6144
  ds_read_b128 v[200:203], v14 offset:45056
  v_rcp_f32 v16, v16
  v_mfma_f32_32x32x16_bf16 v[80:95], v[36:39], v[212:215], v[80:95]
  s_waitcnt lgkmcnt(13)
  ds_read_b64_tr_b16 v[62:63], v5 offset:6656
  ds_read_b64_tr_b16 v[64:65], v5 offset:8192
  ds_read_b64_tr_b16 v[66:67], v5 offset:8704
  ds_read_b128 v[204:207], v14 offset:46080
  v_rcp_f32 v17, v17
  v_mfma_f32_32x32x16_bf16 v[80:95], v[40:43], v[216:219], v[80:95]
  s_waitcnt lgkmcnt(14)
  ds_read_b64_tr_b16 v[68:69], v5 offset:10240
  ds_read_b64_tr_b16 v[70:71], v5 offset:10752
  ds_read_b64_tr_b16 v[72:73], v5 offset:12288
  ds_read_b128 v[208:211], v14 offset:49152
  v_rcp_f32 v18, v18
  v_mfma_f32_32x32x16_bf16 v[80:95], v[44:47], v[220:223], v[80:95]
  s_waitcnt lgkmcnt(15)
  ds_read_b64_tr_b16 v[74:75], v5 offset:12800
  ds_read_b64_tr_b16 v[76:77], v5 offset:14336
  ds_read_b64_tr_b16 v[78:79], v5 offset:14848
  ds_read_b128 v[212:215], v14 offset:50176
  v_rcp_f32 v19, v19
  v_mul_f32 v16, v104, v16
  v_mfma_f32_32x32x16_bf16 v[80:95], v[48:51], v[224:227], v[80:95]
  s_waitcnt lgkmcnt(15)
  s_waitcnt lgkmcnt(1)
  s_barrier
  ds_read_b128 v[216:219], v14 offset:53248
  v_mul_f32 v17, v105, v17
  v_mul_f32 v18, v106, v18
  v_mul_f32 v19, v107, v19
  v_cvt_pk_bf16_f32 v24, v16, v17
  v_cvt_pk_bf16_f32 v25, v18, v19
  v_mfma_f32_32x32x16_bf16 v[80:95], v[52:55], v[228:231], v[80:95]
  ds_read_b128 v[220:223], v14 offset:54272
  ds_write_b128 v13, v[20:23] offset:0
  v_exp_f32 v16, -v108
  v_exp_f32 v17, -v109
  v_mfma_f32_32x32x16_bf16 v[80:95], v[56:59], v[232:235], v[80:95]
  v_exp_f32 v18, -v110
  v_exp_f32 v19, -v111
  v_add_f32 v16, 1.0, v16
  v_add_f32 v17, 1.0, v17
  v_mfma_f32_32x32x16_bf16 v[80:95], v[60:63], v[236:239], v[80:95]
  v_add_f32 v18, 1.0, v18
  v_add_f32 v19, 1.0, v19
  v_rcp_f32 v16, v16
  v_rcp_f32 v17, v17
  v_mfma_f32_32x32x16_bf16 v[80:95], v[64:67], v[240:243], v[80:95]
  ds_read_b64_tr_b16 v[32:33], v6 offset:0
  ds_read_b64_tr_b16 v[34:35], v6 offset:1024
  ds_read_b64_tr_b16 v[36:37], v6 offset:2048
  v_rcp_f32 v18, v18
  v_rcp_f32 v19, v19
  v_mfma_f32_32x32x16_bf16 v[80:95], v[68:71], v[244:247], v[80:95]
  ds_read_b64_tr_b16 v[38:39], v6 offset:3072
  ds_read_b64_tr_b16 v[40:41], v6 offset:4096
  ds_read_b64_tr_b16 v[42:43], v6 offset:5120
  v_mul_f32 v16, v108, v16
  v_mul_f32 v17, v109, v17
  v_mul_f32 v18, v110, v18
  v_mul_f32 v19, v111, v19
  v_cvt_pk_bf16_f32 v26, v16, v17
  v_cvt_pk_bf16_f32 v27, v18, v19
  v_mfma_f32_32x32x16_bf16 v[80:95], v[72:75], v[248:251], v[80:95]
  ds_read_b64_tr_b16 v[44:45], v6 offset:6144
  ds_read_b64_tr_b16 v[46:47], v6 offset:7168
  ds_read_b64_tr_b16 v[48:49], v6 offset:8192
  v_mfma_f32_32x32x16_bf16 v[80:95], v[76:79], v[252:255], v[80:95]
  s_waitcnt lgkmcnt(7)
  ds_read_b64_tr_b16 v[50:51], v6 offset:9216
  ds_read_b64_tr_b16 v[52:53], v6 offset:10240
  ds_read_b64_tr_b16 v[54:55], v6 offset:11264
  v_and_b32 v4, 31, v0
  s_lshl_b32 s79, s72, 5
  v_add_u32 v4, s79, v4
  v_bfe_u32 v5, v0, 5, 1
  v_lshlrev_b32 v5, 2, v5
  s_mul_i32 s79, s56, 36
  s_cmp_eq_u32 s56, 7
  s_cselect_b32 s64, 3, 0
  s_sub_u32 s79, s79, s64
  v_add_u32 v5, s79, v5
  v_cvt_f32_u32 v5, v5
  v_add_u32 v3, 147456, v14
  s_lshl_b32 s79, s73, 10
  v_subrev_u32 v3, s79, v3
  v_subrev_u32 v0, 49152, v6
  v_mfma_f32_32x32x16_bf16 v[96:111], v[32:35], v[112:115], 0
  s_waitcnt lgkmcnt(8)
  v_mfma_f32_32x32x16_bf16 v[96:111], v[36:39], v[116:119], v[96:111]
  s_waitcnt lgkmcnt(6)
  ds_read_b64_tr_b16 v[32:33], v6 offset:12288
  ds_read_b64_tr_b16 v[34:35], v6 offset:13312
  v_exp_f32 v16, -v80
  v_exp_f32 v17, -v81
  v_mfma_f32_32x32x16_bf16 v[96:111], v[40:43], v[120:123], v[96:111]
  s_waitcnt lgkmcnt(6)
  ds_read_b64_tr_b16 v[36:37], v6 offset:14336
  ds_read_b64_tr_b16 v[38:39], v6 offset:15360
  v_exp_f32 v18, -v82
  v_exp_f32 v19, -v83
  v_mfma_f32_32x32x16_bf16 v[96:111], v[44:47], v[124:127], v[96:111]
  s_waitcnt lgkmcnt(6)
  ds_read_b64_tr_b16 v[40:41], v6 offset:16384
  ds_read_b64_tr_b16 v[42:43], v6 offset:17408
  v_add_f32 v16, 1.0, v16
  v_add_f32 v17, 1.0, v17
  v_add_f32 v18, 1.0, v18
  v_add_f32 v19, 1.0, v19
  v_mfma_f32_32x32x16_bf16 v[96:111], v[48:51], v[128:131], v[96:111]
  s_waitcnt lgkmcnt(6)
  ds_read_b64_tr_b16 v[44:45], v6 offset:18432
  ds_read_b64_tr_b16 v[46:47], v6 offset:19456
  v_rcp_f32 v16, v16
  v_rcp_f32 v17, v17
  v_mfma_f32_32x32x16_bf16 v[96:111], v[52:55], v[132:135], v[96:111]
  s_waitcnt lgkmcnt(6)
  ds_read_b64_tr_b16 v[48:49], v6 offset:20480
  ds_read_b64_tr_b16 v[50:51], v6 offset:21504
  ds_write_b128 v13, v[24:27] offset:1024
  v_rcp_f32 v18, v18
  v_rcp_f32 v19, v19
  v_mul_f32 v16, v80, v16
  v_mfma_f32_32x32x16_bf16 v[96:111], v[32:35], v[136:139], v[96:111]
  s_waitcnt lgkmcnt(7)
  ds_read_b64_tr_b16 v[52:53], v6 offset:22528
  ds_read_b64_tr_b16 v[54:55], v6 offset:23552
  v_mul_f32 v17, v81, v17
  v_mul_f32 v18, v82, v18
  v_mul_f32 v19, v83, v19
  v_cvt_pk_bf16_f32 v20, v16, v17
  v_cvt_pk_bf16_f32 v21, v18, v19
  v_mfma_f32_32x32x16_bf16 v[96:111], v[36:39], v[140:143], v[96:111]
  s_waitcnt lgkmcnt(7)
  v_exp_f32 v16, -v84
  v_exp_f32 v17, -v85
  v_exp_f32 v18, -v86
  v_mfma_f32_32x32x16_bf16 v[96:111], v[40:43], v[144:147], v[96:111]
  s_waitcnt lgkmcnt(5)
  s_waitcnt lgkmcnt(0)
  s_barrier
  ds_read_b64_tr_b16 v[32:33], v6 offset:24576
  ds_read_b64_tr_b16 v[34:35], v6 offset:25600
  ds_read_b64_tr_b16 v[36:37], v6 offset:26624
  v_exp_f32 v19, -v87
  v_add_f32 v16, 1.0, v16
  v_add_f32 v17, 1.0, v17
  v_add_f32 v18, 1.0, v18
  v_mfma_f32_32x32x16_bf16 v[96:111], v[44:47], v[148:151], v[96:111]
  ds_read_b64_tr_b16 v[38:39], v6 offset:27648
  ds_read_b64_tr_b16 v[40:41], v6 offset:28672
  ds_read_b64_tr_b16 v[42:43], v6 offset:29696
  v_add_f32 v19, 1.0, v19
  v_rcp_f32 v16, v16
  v_rcp_f32 v17, v17
  v_mfma_f32_32x32x16_bf16 v[96:111], v[48:51], v[152:155], v[96:111]
  ds_read_b64_tr_b16 v[44:45], v6 offset:30720
  ds_read_b64_tr_b16 v[46:47], v6 offset:31744
  v_rcp_f32 v18, v18
  v_rcp_f32 v19, v19
  v_mul_f32 v16, v84, v16
  v_mul_f32 v17, v85, v17
  v_mfma_f32_32x32x16_bf16 v[96:111], v[52:55], v[156:159], v[96:111]
  s_waitcnt lgkmcnt(6)
  ds_read_b64_tr_b16 v[48:49], v6 offset:32768
  ds_read_b64_tr_b16 v[50:51], v6 offset:33792
  v_mul_f32 v18, v86, v18
  v_mul_f32 v19, v87, v19
  v_cvt_pk_bf16_f32 v22, v16, v17
  v_cvt_pk_bf16_f32 v23, v18, v19
  v_exp_f32 v16, -v88
  v_mfma_f32_32x32x16_bf16 v[96:111], v[32:35], v[160:163], v[96:111]
  s_waitcnt lgkmcnt(6)
  ds_read_b64_tr_b16 v[52:53], v6 offset:34816
  ds_read_b64_tr_b16 v[54:55], v6 offset:35840
  v_exp_f32 v17, -v89
  v_exp_f32 v18, -v90
  v_exp_f32 v19, -v91
  v_mfma_f32_32x32x16_bf16 v[96:111], v[36:39], v[164:167], v[96:111]
  s_waitcnt lgkmcnt(6)
  ds_read_b64_tr_b16 v[32:33], v6 offset:36864
  ds_read_b64_tr_b16 v[34:35], v6 offset:37888
  v_add_f32 v16, 1.0, v16
  v_add_f32 v17, 1.0, v17
  v_add_f32 v18, 1.0, v18
  v_add_f32 v19, 1.0, v19
  v_rcp_f32 v16, v16
  v_mfma_f32_32x32x16_bf16 v[96:111], v[40:43], v[168:171], v[96:111]
  s_waitcnt lgkmcnt(6)
  ds_read_b64_tr_b16 v[36:37], v6 offset:38912
  ds_read_b64_tr_b16 v[38:39], v6 offset:39936
  v_rcp_f32 v17, v17
  v_rcp_f32 v18, v18
  v_rcp_f32 v19, v19
  v_mul_f32 v16, v88, v16
  v_mul_f32 v17, v89, v17
  v_mfma_f32_32x32x16_bf16 v[96:111], v[44:47], v[172:175], v[96:111]
  s_waitcnt lgkmcnt(6)
  ds_read_b64_tr_b16 v[40:41], v6 offset:40960
  ds_read_b64_tr_b16 v[42:43], v6 offset:41984
  v_mul_f32 v18, v90, v18
  v_mul_f32 v19, v91, v19
  v_cvt_pk_bf16_f32 v24, v16, v17
  v_cvt_pk_bf16_f32 v25, v18, v19
  v_exp_f32 v16, -v92
  v_exp_f32 v17, -v93
  v_mfma_f32_32x32x16_bf16 v[96:111], v[48:51], v[176:179], v[96:111]
  s_waitcnt lgkmcnt(6)
  ds_read_b64_tr_b16 v[44:45], v6 offset:43008
  ds_read_b64_tr_b16 v[46:47], v6 offset:44032
  v_exp_f32 v18, -v94
  v_exp_f32 v19, -v95
  v_add_f32 v16, 1.0, v16
  v_add_f32 v17, 1.0, v17
  v_add_f32 v18, 1.0, v18
  v_add_f32 v19, 1.0, v19
  v_rcp_f32 v16, v16
  v_mfma_f32_32x32x16_bf16 v[96:111], v[52:55], v[180:183], v[96:111]
  s_waitcnt lgkmcnt(6)
  ds_read_b64_tr_b16 v[48:49], v6 offset:45056
  ds_read_b64_tr_b16 v[50:51], v6 offset:46080
  ds_write_b128 v13, v[20:23] offset:8192
  v_rcp_f32 v17, v17
  v_rcp_f32 v18, v18
  v_rcp_f32 v19, v19
  v_mul_f32 v16, v92, v16
  v_mul_f32 v17, v93, v17
  v_mul_f32 v18, v94, v18
  v_mul_f32 v19, v95, v19
  v_cvt_pk_bf16_f32 v26, v16, v17
  v_cvt_pk_bf16_f32 v27, v18, v19
  v_mfma_f32_32x32x16_bf16 v[96:111], v[32:35], v[184:187], v[96:111]
  s_waitcnt lgkmcnt(7)
  ds_read_b64_tr_b16 v[52:53], v6 offset:47104
  ds_read_b64_tr_b16 v[54:55], v6 offset:48128
  ds_write_b128 v13, v[24:27] offset:9216
  v_mfma_f32_32x32x16_bf16 v[96:111], v[36:39], v[188:191], v[96:111]
  s_waitcnt lgkmcnt(8)
  v_mfma_f32_32x32x16_bf16 v[96:111], v[40:43], v[192:195], v[96:111]
  s_waitcnt lgkmcnt(6)
  s_waitcnt lgkmcnt(0)
  s_barrier
  ds_read_b64_tr_b16 v[32:33], v6 offset:49152
  ds_read_b64_tr_b16 v[34:35], v6 offset:50176
  ds_read_b64_tr_b16 v[36:37], v6 offset:51200
  v_add_u32 v1, 512, v4
  v_cvt_f32_u32 v1, v1
  v_mul_f32 v1, 0x3ae38e39, v1
  v_cos_f32 v29, v1
  v_mul_f32 v2, v5, v1
  v_fract_f32 v2, v2
  v_mfma_f32_32x32x16_bf16 v[96:111], v[44:47], v[196:199], v[96:111]
  ds_read_b64_tr_b16 v[38:39], v6 offset:52224
  ds_read_b64_tr_b16 v[40:41], v6 offset:53248
  ds_read_b64_tr_b16 v[42:43], v6 offset:54272
  v_add_f32 v29, v29, v29
  v_fmamk_f32 v17, v1, 0x00000000, v2
  v_fmamk_f32 v19, v1, 0x3f800000, v2
  v_cos_f32 v16, v17
  v_sin_f32 v17, v17
  v_mfma_f32_32x32x16_bf16 v[96:111], v[48:51], v[200:203], v[96:111]
  ds_read_b64_tr_b16 v[44:45], v6 offset:55296
  ds_read_b64_tr_b16 v[46:47], v6 offset:56320
  ds_read_b128 v[224:227], v15 offset:0
  ds_read_b128 v[56:59], v3 offset:0
  v_cos_f32 v18, v19
  v_sin_f32 v19, v19
  v_cvt_pk_bf16_f32 v76, v16, -v17
  v_cvt_pk_bf16_f32 v77, v18, -v19
  v_mfma_f32_32x32x16_bf16 v[96:111], v[52:55], v[204:207], v[96:111]
  s_waitcnt lgkmcnt(8)
  ds_read_b64_tr_b16 v[48:49], v7 offset:0
  ds_read_b64_tr_b16 v[50:51], v7 offset:1024
  ds_read_b128 v[228:231], v15 offset:1024
  ds_read_b128 v[60:63], v3 offset:2048
  v_fma_f32 v16, v29, v18, -v16
  v_fma_f32 v17, v29, v19, -v17
  v_fma_f32 v18, v29, v16, -v18
  v_fma_f32 v19, v29, v17, -v19
  v_cvt_pk_bf16_f32 v78, v16, -v17
  v_cvt_pk_bf16_f32 v79, v18, -v19
  v_mfma_f32_32x32x16_bf16 v[96:111], v[32:35], v[208:211], v[96:111]
  s_waitcnt lgkmcnt(10)
  ds_read_b64_tr_b16 v[52:53], v7 offset:2048
  ds_read_b64_tr_b16 v[54:55], v7 offset:3072
  ds_read_b128 v[232:235], v15 offset:4096
  ds_read_b128 v[64:67], v3 offset:4096
  v_mfma_f32_32x32x16_bf16 v[96:111], v[36:39], v[212:215], v[96:111]
  s_waitcnt lgkmcnt(12)
  ds_read_b64_tr_b16 v[32:33], v7 offset:4096
  ds_read_b64_tr_b16 v[34:35], v7 offset:5120
  ds_read_b128 v[236:239], v15 offset:5120
  ds_read_b128 v[68:71], v3 offset:6144
  v_mfma_f32_32x32x16_bf16 v[96:111], v[40:43], v[216:219], v[96:111]
  s_waitcnt lgkmcnt(14)
  ds_read_b64_tr_b16 v[36:37], v7 offset:6144
  ds_read_b64_tr_b16 v[38:39], v7 offset:7168
  ds_read_b128 v[240:243], v15 offset:8192
  ds_read_b128 v[72:75], v3 offset:8192
  v_mfma_f32_32x32x16_bf16 v[96:111], v[44:47], v[220:223], v[96:111]
  s_waitcnt lgkmcnt(14)
  ds_read_b64_tr_b16 v[40:41], v7 offset:8192
  ds_read_b64_tr_b16 v[42:43], v7 offset:9216
  ds_read_b128 v[244:247], v15 offset:9216
  v_mfma_f32_32x32x16_bf16 v[96:111], v[48:51], v[224:227], v[96:111]
  s_waitcnt lgkmcnt(13)
  ds_read_b64_tr_b16 v[44:45], v7 offset:10240
  ds_read_b64_tr_b16 v[46:47], v7 offset:11264
  ds_read_b128 v[248:251], v15 offset:12288
  v_mfma_f32_32x32x16_bf16 v[96:111], v[76:79], v[56:59], v[96:111]
  v_fmamk_f32 v17, v1, 0x41000000, v2
  v_fmamk_f32 v19, v1, 0x41100000, v2
  v_cos_f32 v16, v17
  v_sin_f32 v17, v17
  v_cos_f32 v18, v19
  v_sin_f32 v19, v19
  v_mfma_f32_32x32x16_bf16 v[96:111], v[52:55], v[228:231], v[96:111]
  s_waitcnt lgkmcnt(12)
  ds_read_b64_tr_b16 v[48:49], v7 offset:12288
  ds_read_b64_tr_b16 v[50:51], v7 offset:13312
  ds_read_b128 v[252:255], v15 offset:13312
  v_cvt_pk_bf16_f32 v76, v16, -v17
  v_cvt_pk_bf16_f32 v77, v18, -v19
  v_fma_f32 v16, v29, v18, -v16
  v_fma_f32 v17, v29, v19, -v17
  v_fma_f32 v18, v29, v16, -v18
  v_fma_f32 v19, v29, v17, -v19
  v_cvt_pk_bf16_f32 v78, v16, -v17
  v_cvt_pk_bf16_f32 v79, v18, -v19
  s_nop 1
  v_mfma_f32_32x32x16_bf16 v[96:111], v[76:79], v[60:63], v[96:111]
  v_fmamk_f32 v17, v1, 0x41800000, v2
  v_fmamk_f32 v19, v1, 0x41880000, v2
  v_cos_f32 v16, v17
  v_mfma_f32_32x32x16_bf16 v[96:111], v[32:35], v[232:235], v[96:111]
  s_waitcnt lgkmcnt(11)
  ds_read_b64_tr_b16 v[52:53], v7 offset:14336
  ds_read_b64_tr_b16 v[54:55], v7 offset:15360
  v_sin_f32 v17, v17
  v_cos_f32 v18, v19
  v_sin_f32 v19, v19
  v_cvt_pk_bf16_f32 v76, v16, -v17
  v_cvt_pk_bf16_f32 v77, v18, -v19
  v_fma_f32 v16, v29, v18, -v16
  v_fma_f32 v17, v29, v19, -v17
  v_mfma_f32_32x32x16_bf16 v[96:111], v[36:39], v[236:239], v[96:111]
  s_waitcnt lgkmcnt(9)
  v_fma_f32 v18, v29, v16, -v18
  v_fma_f32 v19, v29, v17, -v19
  v_cvt_pk_bf16_f32 v78, v16, -v17
  v_cvt_pk_bf16_f32 v79, v18, -v19
  s_nop 1
  v_mfma_f32_32x32x16_bf16 v[96:111], v[76:79], v[64:67], v[96:111]
  v_fmamk_f32 v17, v1, 0x41c00000, v2
  v_fmamk_f32 v19, v1, 0x41c80000, v2
  v_cos_f32 v16, v17
  v_sin_f32 v17, v17
  v_mfma_f32_32x32x16_bf16 v[96:111], v[40:43], v[240:243], v[96:111]
  s_waitcnt lgkmcnt(6)
  s_waitcnt lgkmcnt(0)
  s_barrier
  ds_read_b64_tr_b16 v[32:33], v6 offset:0
  ds_read_b64_tr_b16 v[34:35], v6 offset:1024
  ds_read_b64_tr_b16 v[36:37], v6 offset:2048
  v_cos_f32 v18, v19
  v_sin_f32 v19, v19
  v_cvt_pk_bf16_f32 v76, v16, -v17
  v_cvt_pk_bf16_f32 v77, v18, -v19
  v_fma_f32 v16, v29, v18, -v16
  v_fma_f32 v17, v29, v19, -v17
  v_fma_f32 v18, v29, v16, -v18
  v_fma_f32 v19, v29, v17, -v19
  v_mfma_f32_32x32x16_bf16 v[96:111], v[44:47], v[244:247], v[96:111]
  ds_read_b64_tr_b16 v[38:39], v6 offset:3072
  ds_read_b64_tr_b16 v[40:41], v6 offset:4096
  ds_read_b64_tr_b16 v[42:43], v6 offset:5120
  v_cvt_pk_bf16_f32 v78, v16, -v17
  v_cvt_pk_bf16_f32 v79, v18, -v19
  s_nop 1
  v_mfma_f32_32x32x16_bf16 v[96:111], v[76:79], v[68:71], v[96:111]
  v_fmamk_f32 v17, v1, 0x42000000, v2
  v_fmamk_f32 v19, v1, 0x42040000, v2
  v_cos_f32 v16, v17
  v_sin_f32 v17, v17
  v_cos_f32 v18, v19
  v_mfma_f32_32x32x16_bf16 v[96:111], v[48:51], v[248:251], v[96:111]
  ds_read_b64_tr_b16 v[44:45], v6 offset:6144
  ds_read_b64_tr_b16 v[46:47], v6 offset:7168
  v_sin_f32 v19, v19
  v_cvt_pk_bf16_f32 v76, v16, -v17
  v_cvt_pk_bf16_f32 v77, v18, -v19
  v_fma_f32 v16, v29, v18, -v16
  v_fma_f32 v17, v29, v19, -v17
  v_fma_f32 v18, v29, v16, -v18
  v_fma_f32 v19, v29, v17, -v19
  v_cvt_pk_bf16_f32 v78, v16, -v17
  v_cvt_pk_bf16_f32 v79, v18, -v19
  s_nop 1
  v_mfma_f32_32x32x16_bf16 v[96:111], v[76:79], v[72:75], v[96:111]
  v_mfma_f32_32x32x16_bf16 v[96:111], v[52:55], v[252:255], v[96:111]
  s_waitcnt lgkmcnt(6)
  ds_read_b64_tr_b16 v[48:49], v6 offset:8192
  ds_read_b64_tr_b16 v[50:51], v6 offset:9216
  s_add_u32 s79, s58, 1
  s_and_b32 s79, s79, 7
  s_lshl_b32 s79, s79, 6
  v_mfma_f32_32x32x16_bf16 v[80:95], v[32:35], v[112:115], 0
  s_waitcnt lgkmcnt(6)
  s_add_u32 s62, s74, 65536
  ds_read_b64_tr_b16 v[52:53], v6 offset:10240
  ds_read_b64_tr_b16 v[54:55], v6 offset:11264
  v_mfma_f32_32x32x16_bf16 v[80:95], v[36:39], v[116:119], v[80:95]
  s_waitcnt lgkmcnt(6)
  ds_read_b64_tr_b16 v[32:33], v6 offset:12288
  ds_read_b64_tr_b16 v[34:35], v6 offset:13312
  v_cvt_pk_bf16_f32 v20, v96, v97
  v_cvt_pk_bf16_f32 v21, v98, v99
  v_cvt_pk_bf16_f32 v22, v100, v101
  v_cvt_pk_bf16_f32 v23, v102, v103
  v_mfma_f32_32x32x16_bf16 v[80:95], v[40:43], v[120:123], v[80:95]
  s_waitcnt lgkmcnt(6)
  ds_read_b64_tr_b16 v[36:37], v6 offset:14336
  ds_read_b64_tr_b16 v[38:39], v6 offset:15360
  v_cvt_pk_bf16_f32 v24, v104, v105
  v_cvt_pk_bf16_f32 v25, v106, v107
  v_cvt_pk_bf16_f32 v26, v108, v109
  v_cvt_pk_bf16_f32 v27, v110, v111
  v_mfma_f32_32x32x16_bf16 v[80:95], v[44:47], v[124:127], v[80:95]
  s_waitcnt lgkmcnt(6)
  ds_read_b64_tr_b16 v[40:41], v6 offset:16384
  ds_read_b64_tr_b16 v[42:43], v6 offset:17408
  v_mfma_f32_32x32x16_bf16 v[80:95], v[48:51], v[128:131], v[80:95]
  s_waitcnt lgkmcnt(6)
  ds_read_b64_tr_b16 v[44:45], v6 offset:18432
  ds_read_b64_tr_b16 v[46:47], v6 offset:19456
  v_add_u32 v1, s79, v4
  v_cvt_f32_u32 v1, v1
  v_mul_f32 v1, 0x3ae38e39, v1
  v_mfma_f32_32x32x16_bf16 v[80:95], v[52:55], v[132:135], v[80:95]
  s_waitcnt lgkmcnt(6)
  ds_read_b64_tr_b16 v[48:49], v6 offset:20480
  ds_read_b64_tr_b16 v[50:51], v6 offset:21504
  buffer_store_dwordx4 v[20:23], v28, s[36:39], s62 offen offset:0 sc1
  v_cos_f32 v29, v1
  v_mul_f32 v2, v5, v1
  v_mfma_f32_32x32x16_bf16 v[80:95], v[32:35], v[136:139], v[80:95]
  s_waitcnt lgkmcnt(6)
  ds_read_b64_tr_b16 v[52:53], v6 offset:22528
  ds_read_b64_tr_b16 v[54:55], v6 offset:23552
  v_fract_f32 v2, v2
  v_add_f32 v29, v29, v29
  v_fmamk_f32 v17, v1, 0x00000000, v2
  v_mfma_f32_32x32x16_bf16 v[80:95], v[36:39], v[140:143], v[80:95]
  s_waitcnt lgkmcnt(6)
  buffer_store_dwordx4 v[24:27], v28, s[36:39], s62 offen offset:1024 sc1
  v_fmamk_f32 v19, v1, 0x3f800000, v2
  v_cos_f32 v16, v17
  v_mfma_f32_32x32x16_bf16 v[80:95], v[40:43], v[144:147], v[80:95]
  s_waitcnt lgkmcnt(4)
  s_waitcnt lgkmcnt(0)
  s_barrier
  ds_read_b64_tr_b16 v[32:33], v6 offset:24576
  ds_read_b64_tr_b16 v[34:35], v6 offset:25600
  ds_read_b64_tr_b16 v[36:37], v6 offset:26624
  v_sin_f32 v17, v17
  v_cos_f32 v18, v19
  v_mfma_f32_32x32x16_bf16 v[80:95], v[44:47], v[148:151], v[80:95]
  ds_read_b64_tr_b16 v[38:39], v6 offset:27648
  ds_read_b64_tr_b16 v[40:41], v6 offset:28672
  ds_read_b64_tr_b16 v[42:43], v6 offset:29696
  v_sin_f32 v19, v19
  v_cvt_pk_bf16_f32 v76, v16, -v17
  v_mfma_f32_32x32x16_bf16 v[80:95], v[48:51], v[152:155], v[80:95]
  ds_read_b64_tr_b16 v[44:45], v6 offset:30720
  ds_read_b64_tr_b16 v[46:47], v6 offset:31744
  v_cvt_pk_bf16_f32 v77, v18, -v19
  v_fma_f32 v16, v29, v18, -v16
  v_fma_f32 v17, v29, v19, -v17
  v_mfma_f32_32x32x16_bf16 v[80:95], v[52:55], v[156:159], v[80:95]
  s_waitcnt lgkmcnt(6)
  ds_read_b64_tr_b16 v[48:49], v6 offset:32768
  ds_read_b64_tr_b16 v[50:51], v6 offset:33792
  v_fma_f32 v18, v29, v16, -v18
  v_fma_f32 v19, v29, v17, -v19
  v_cvt_pk_bf16_f32 v78, v16, -v17
  v_mfma_f32_32x32x16_bf16 v[80:95], v[32:35], v[160:163], v[80:95]
  s_waitcnt lgkmcnt(6)
  ds_read_b64_tr_b16 v[52:53], v6 offset:34816
  ds_read_b64_tr_b16 v[54:55], v6 offset:35840
  v_cvt_pk_bf16_f32 v79, v18, -v19
  s_nop 1
  v_mfma_f32_32x32x16_bf16 v[80:95], v[76:79], v[56:59], v[80:95]
  v_fmamk_f32 v17, v1, 0x41000000, v2
  v_fmamk_f32 v19, v1, 0x41100000, v2
  v_cos_f32 v16, v17
  v_mfma_f32_32x32x16_bf16 v[80:95], v[36:39], v[164:167], v[80:95]
  s_waitcnt lgkmcnt(6)
  ds_read_b64_tr_b16 v[32:33], v6 offset:36864
  ds_read_b64_tr_b16 v[34:35], v6 offset:37888
  v_sin_f32 v17, v17
  v_cos_f32 v18, v19
  v_mfma_f32_32x32x16_bf16 v[80:95], v[40:43], v[168:171], v[80:95]
  s_waitcnt lgkmcnt(6)
  ds_read_b64_tr_b16 v[36:37], v6 offset:38912
  ds_read_b64_tr_b16 v[38:39], v6 offset:39936
  v_sin_f32 v19, v19
  v_cvt_pk_bf16_f32 v76, v16, -v17
  v_mfma_f32_32x32x16_bf16 v[80:95], v[44:47], v[172:175], v[80:95]
  s_waitcnt lgkmcnt(6)
  ds_read_b64_tr_b16 v[40:41], v6 offset:40960
  ds_read_b64_tr_b16 v[42:43], v6 offset:41984
  v_cvt_pk_bf16_f32 v77, v18, -v19
  v_fma_f32 v16, v29, v18, -v16
  v_fma_f32 v17, v29, v19, -v17
  v_mfma_f32_32x32x16_bf16 v[80:95], v[48:51], v[176:179], v[80:95]
  s_waitcnt lgkmcnt(6)
  ds_read_b64_tr_b16 v[44:45], v6 offset:43008
  ds_read_b64_tr_b16 v[46:47], v6 offset:44032
  v_fma_f32 v18, v29, v16, -v18
  v_fma_f32 v19, v29, v17, -v19
  v_cvt_pk_bf16_f32 v78, v16, -v17
  v_mfma_f32_32x32x16_bf16 v[80:95], v[52:55], v[180:183], v[80:95]
  s_waitcnt lgkmcnt(6)
  ds_read_b64_tr_b16 v[48:49], v6 offset:45056
  ds_read_b64_tr_b16 v[50:51], v6 offset:46080
  v_cvt_pk_bf16_f32 v79, v18, -v19
  s_nop 1
  v_mfma_f32_32x32x16_bf16 v[80:95], v[76:79], v[60:63], v[80:95]
  v_fmamk_f32 v17, v1, 0x41800000, v2
  v_fmamk_f32 v19, v1, 0x41880000, v2
  v_cos_f32 v16, v17
  v_mfma_f32_32x32x16_bf16 v[80:95], v[32:35], v[184:187], v[80:95]
  s_waitcnt lgkmcnt(6)
  ds_read_b64_tr_b16 v[52:53], v6 offset:47104
  ds_read_b64_tr_b16 v[54:55], v6 offset:48128
  v_sin_f32 v17, v17
  v_mfma_f32_32x32x16_bf16 v[80:95], v[36:39], v[188:191], v[80:95]
  s_waitcnt lgkmcnt(6)
  v_cos_f32 v18, v19
  v_sin_f32 v19, v19
  v_cvt_pk_bf16_f32 v76, v16, -v17
  v_mfma_f32_32x32x16_bf16 v[80:95], v[40:43], v[192:195], v[80:95]
  s_waitcnt lgkmcnt(4)
  s_waitcnt lgkmcnt(0)
  s_barrier
  ds_read_b64_tr_b16 v[32:33], v6 offset:49152
  ds_read_b64_tr_b16 v[34:35], v6 offset:50176
  ds_read_b64_tr_b16 v[36:37], v6 offset:51200
  v_cvt_pk_bf16_f32 v77, v18, -v19
  v_fma_f32 v16, v29, v18, -v16
  v_fma_f32 v17, v29, v19, -v17
  v_mfma_f32_32x32x16_bf16 v[80:95], v[44:47], v[196:199], v[80:95]
  ds_read_b64_tr_b16 v[38:39], v6 offset:52224
  ds_read_b64_tr_b16 v[40:41], v6 offset:53248
  ds_read_b64_tr_b16 v[42:43], v6 offset:54272
  v_fma_f32 v18, v29, v16, -v18
  v_fma_f32 v19, v29, v17, -v19
  v_cvt_pk_bf16_f32 v78, v16, -v17
  v_mfma_f32_32x32x16_bf16 v[80:95], v[48:51], v[200:203], v[80:95]
  ds_read_b64_tr_b16 v[44:45], v6 offset:55296
  ds_read_b64_tr_b16 v[46:47], v6 offset:56320
  v_cvt_pk_bf16_f32 v79, v18, -v19
  s_nop 1
  v_mfma_f32_32x32x16_bf16 v[80:95], v[76:79], v[64:67], v[80:95]
  v_fmamk_f32 v17, v1, 0x41c00000, v2
  v_fmamk_f32 v19, v1, 0x41c80000, v2
  v_cos_f32 v16, v17
  v_mfma_f32_32x32x16_bf16 v[80:95], v[52:55], v[204:207], v[80:95]
  s_waitcnt lgkmcnt(6)
  ds_read_b64_tr_b16 v[48:49], v7 offset:0
  ds_read_b64_tr_b16 v[50:51], v7 offset:1024
  v_sin_f32 v17, v17
  v_mfma_f32_32x32x16_bf16 v[80:95], v[32:35], v[208:211], v[80:95]
  s_waitcnt lgkmcnt(6)
  ds_read_b64_tr_b16 v[52:53], v7 offset:2048
  ds_read_b64_tr_b16 v[54:55], v7 offset:3072
  v_cos_f32 v18, v19
  v_mfma_f32_32x32x16_bf16 v[80:95], v[36:39], v[212:215], v[80:95]
  s_waitcnt lgkmcnt(6)
  ds_read_b64_tr_b16 v[32:33], v7 offset:4096
  ds_read_b64_tr_b16 v[34:35], v7 offset:5120
  v_sin_f32 v19, v19
  v_cvt_pk_bf16_f32 v76, v16, -v17
  v_mfma_f32_32x32x16_bf16 v[80:95], v[40:43], v[216:219], v[80:95]
  s_waitcnt lgkmcnt(6)
  ds_read_b64_tr_b16 v[36:37], v7 offset:6144
  ds_read_b64_tr_b16 v[38:39], v7 offset:7168
  v_cvt_pk_bf16_f32 v77, v18, -v19
  v_fma_f32 v16, v29, v18, -v16
  v_fma_f32 v17, v29, v19, -v17
  v_mfma_f32_32x32x16_bf16 v[80:95], v[44:47], v[220:223], v[80:95]
  s_waitcnt lgkmcnt(6)
  ds_read_b64_tr_b16 v[40:41], v7 offset:8192
  ds_read_b64_tr_b16 v[42:43], v7 offset:9216
  v_fma_f32 v18, v29, v16, -v18
  v_fma_f32 v19, v29, v17, -v19
  v_cvt_pk_bf16_f32 v78, v16, -v17
  v_mfma_f32_32x32x16_bf16 v[80:95], v[48:51], v[224:227], v[80:95]
  s_waitcnt lgkmcnt(6)
  ds_read_b64_tr_b16 v[44:45], v7 offset:10240
  ds_read_b64_tr_b16 v[46:47], v7 offset:11264
  v_cvt_pk_bf16_f32 v79, v18, -v19
  s_nop 1
  v_mfma_f32_32x32x16_bf16 v[80:95], v[76:79], v[68:71], v[80:95]
  v_fmamk_f32 v17, v1, 0x42000000, v2
  v_fmamk_f32 v19, v1, 0x42040000, v2
  v_cos_f32 v16, v17
  v_mfma_f32_32x32x16_bf16 v[80:95], v[52:55], v[228:231], v[80:95]
  s_waitcnt lgkmcnt(6)
  ds_read_b64_tr_b16 v[48:49], v7 offset:12288
  ds_read_b64_tr_b16 v[50:51], v7 offset:13312
  v_sin_f32 v17, v17
  v_mfma_f32_32x32x16_bf16 v[80:95], v[32:35], v[232:235], v[80:95]
  s_waitcnt lgkmcnt(6)
  ds_read_b64_tr_b16 v[52:53], v7 offset:14336
  ds_read_b64_tr_b16 v[54:55], v7 offset:15360
  v_cos_f32 v18, v19
  v_mfma_f32_32x32x16_bf16 v[80:95], v[36:39], v[236:239], v[80:95]
  s_waitcnt lgkmcnt(6)
  v_sin_f32 v19, v19
  v_cvt_pk_bf16_f32 v76, v16, -v17
  v_cvt_pk_bf16_f32 v77, v18, -v19
  v_fma_f32 v16, v29, v18, -v16
  v_mfma_f32_32x32x16_bf16 v[80:95], v[40:43], v[240:243], v[80:95]
  s_waitcnt lgkmcnt(4)
  s_waitcnt lgkmcnt(0)
  s_waitcnt vmcnt(0)
  s_barrier
  ds_read_b64_tr_b16 v[32:33], v0 offset:0
  ds_read_b64_tr_b16 v[34:35], v0 offset:1024
  ds_read_b64_tr_b16 v[36:37], v0 offset:2048
  s_add_u32 s63, s77, 1024
  s_mov_b64 exec, s[78:79]
  buffer_store_dword v31, v30, s[36:39], s63 offen sc1
  s_mov_b64 exec, -1
  v_fma_f32 v17, v29, v19, -v17
  v_fma_f32 v18, v29, v16, -v18
  v_mfma_f32_32x32x16_bf16 v[80:95], v[44:47], v[244:247], v[80:95]
  ds_read_b64_tr_b16 v[38:39], v0 offset:3072
  ds_read_b64_tr_b16 v[40:41], v0 offset:4096
  ds_read_b64_tr_b16 v[42:43], v0 offset:5120
  v_fma_f32 v19, v29, v17, -v19
  v_cvt_pk_bf16_f32 v78, v16, -v17
  v_mfma_f32_32x32x16_bf16 v[80:95], v[48:51], v[248:251], v[80:95]
  ds_read_b64_tr_b16 v[44:45], v0 offset:6144
  ds_read_b64_tr_b16 v[46:47], v0 offset:7168
  v_cvt_pk_bf16_f32 v79, v18, -v19
  s_nop 1
  v_mfma_f32_32x32x16_bf16 v[80:95], v[76:79], v[72:75], v[80:95]
  v_mfma_f32_32x32x16_bf16 v[80:95], v[52:55], v[252:255], v[80:95]
  s_waitcnt lgkmcnt(6)
  ds_read_b64_tr_b16 v[48:49], v0 offset:8192
  ds_read_b64_tr_b16 v[50:51], v0 offset:9216
  s_add_u32 s79, s58, 2
  s_and_b32 s79, s79, 7
  s_lshl_b32 s79, s79, 6
  v_mfma_f32_32x32x16_bf16 v[96:111], v[32:35], v[112:115], 0
  s_waitcnt lgkmcnt(6)
  s_add_u32 s62, s58, 1
  s_and_b32 s62, s62, 7
  s_lshl_b32 s62, s62, 13
  s_add_u32 s62, s62, s74
  ds_read_b64_tr_b16 v[52:53], v0 offset:10240
  ds_read_b64_tr_b16 v[54:55], v0 offset:11264
  v_mfma_f32_32x32x16_bf16 v[96:111], v[36:39], v[116:119], v[96:111]
  s_waitcnt lgkmcnt(6)
  ds_read_b64_tr_b16 v[32:33], v0 offset:12288
  ds_read_b64_tr_b16 v[34:35], v0 offset:13312
  v_cvt_pk_bf16_f32 v20, v80, v81
  v_cvt_pk_bf16_f32 v21, v82, v83
  v_cvt_pk_bf16_f32 v22, v84, v85
  v_cvt_pk_bf16_f32 v23, v86, v87
  v_mfma_f32_32x32x16_bf16 v[96:111], v[40:43], v[120:123], v[96:111]
  s_waitcnt lgkmcnt(6)
  ds_read_b64_tr_b16 v[36:37], v0 offset:14336
  ds_read_b64_tr_b16 v[38:39], v0 offset:15360
  v_cvt_pk_bf16_f32 v24, v88, v89
  v_cvt_pk_bf16_f32 v25, v90, v91
  v_cvt_pk_bf16_f32 v26, v92, v93
  v_cvt_pk_bf16_f32 v27, v94, v95
  v_mfma_f32_32x32x16_bf16 v[96:111], v[44:47], v[124:127], v[96:111]
  s_waitcnt lgkmcnt(6)
  ds_read_b64_tr_b16 v[40:41], v0 offset:16384
  ds_read_b64_tr_b16 v[42:43], v0 offset:17408
  v_mfma_f32_32x32x16_bf16 v[96:111], v[48:51], v[128:131], v[96:111]
  s_waitcnt lgkmcnt(6)
  ds_read_b64_tr_b16 v[44:45], v0 offset:18432
  ds_read_b64_tr_b16 v[46:47], v0 offset:19456
  v_add_u32 v1, s79, v4
  v_cvt_f32_u32 v1, v1
  v_mul_f32 v1, 0x3ae38e39, v1
  v_mfma_f32_32x32x16_bf16 v[96:111], v[52:55], v[132:135], v[96:111]
  s_waitcnt lgkmcnt(6)
  ds_read_b64_tr_b16 v[48:49], v0 offset:20480
  ds_read_b64_tr_b16 v[50:51], v0 offset:21504
  buffer_store_dwordx4 v[20:23], v28, s[36:39], s62 offen offset:0 sc1
  v_cos_f32 v29, v1
  v_mul_f32 v2, v5, v1
  v_mfma_f32_32x32x16_bf16 v[96:111], v[32:35], v[136:139], v[96:111]
  s_waitcnt lgkmcnt(6)
  ds_read_b64_tr_b16 v[52:53], v0 offset:22528
  ds_read_b64_tr_b16 v[54:55], v0 offset:23552
  v_fract_f32 v2, v2
  v_add_f32 v29, v29, v29
  v_fmamk_f32 v17, v1, 0x00000000, v2
  v_mfma_f32_32x32x16_bf16 v[96:111], v[36:39], v[140:143], v[96:111]
  s_waitcnt lgkmcnt(6)
  buffer_store_dwordx4 v[24:27], v28, s[36:39], s62 offen offset:1024 sc1
  v_fmamk_f32 v19, v1, 0x3f800000, v2
  v_cos_f32 v16, v17
  v_mfma_f32_32x32x16_bf16 v[96:111], v[40:43], v[144:147], v[96:111]
  s_waitcnt lgkmcnt(4)
  s_waitcnt lgkmcnt(0)
  s_barrier
  ds_read_b64_tr_b16 v[32:33], v6 offset:0
  ds_read_b64_tr_b16 v[34:35], v6 offset:1024
  ds_read_b64_tr_b16 v[36:37], v6 offset:2048
  v_sin_f32 v17, v17
  v_cos_f32 v18, v19
  v_mfma_f32_32x32x16_bf16 v[96:111], v[44:47], v[148:151], v[96:111]
  ds_read_b64_tr_b16 v[38:39], v6 offset:3072
  ds_read_b64_tr_b16 v[40:41], v6 offset:4096
  ds_read_b64_tr_b16 v[42:43], v6 offset:5120
  v_sin_f32 v19, v19
  v_cvt_pk_bf16_f32 v76, v16, -v17
  v_mfma_f32_32x32x16_bf16 v[96:111], v[48:51], v[152:155], v[96:111]
  ds_read_b64_tr_b16 v[44:45], v6 offset:6144
  ds_read_b64_tr_b16 v[46:47], v6 offset:7168
  v_cvt_pk_bf16_f32 v77, v18, -v19
  v_fma_f32 v16, v29, v18, -v16
  v_fma_f32 v17, v29, v19, -v17
  v_mfma_f32_32x32x16_bf16 v[96:111], v[52:55], v[156:159], v[96:111]
  s_waitcnt lgkmcnt(6)
  ds_read_b64_tr_b16 v[48:49], v6 offset:8192
  ds_read_b64_tr_b16 v[50:51], v6 offset:9216
  v_fma_f32 v18, v29, v16, -v18
  v_fma_f32 v19, v29, v17, -v19
  v_cvt_pk_bf16_f32 v78, v16, -v17
  v_mfma_f32_32x32x16_bf16 v[96:111], v[32:35], v[160:163], v[96:111]
  s_waitcnt lgkmcnt(6)
  ds_read_b64_tr_b16 v[52:53], v6 offset:10240
  ds_read_b64_tr_b16 v[54:55], v6 offset:11264
  v_cvt_pk_bf16_f32 v79, v18, -v19
  s_nop 1
  v_mfma_f32_32x32x16_bf16 v[96:111], v[76:79], v[56:59], v[96:111]
  v_fmamk_f32 v17, v1, 0x41000000, v2
  v_fmamk_f32 v19, v1, 0x41100000, v2
  v_cos_f32 v16, v17
  v_mfma_f32_32x32x16_bf16 v[96:111], v[36:39], v[164:167], v[96:111]
  s_waitcnt lgkmcnt(6)
  ds_read_b64_tr_b16 v[32:33], v6 offset:12288
  ds_read_b64_tr_b16 v[34:35], v6 offset:13312
  v_sin_f32 v17, v17
  v_cos_f32 v18, v19
  v_mfma_f32_32x32x16_bf16 v[96:111], v[40:43], v[168:171], v[96:111]
  s_waitcnt lgkmcnt(6)
  ds_read_b64_tr_b16 v[36:37], v6 offset:14336
  ds_read_b64_tr_b16 v[38:39], v6 offset:15360
  v_sin_f32 v19, v19
  v_cvt_pk_bf16_f32 v76, v16, -v17
  v_mfma_f32_32x32x16_bf16 v[96:111], v[44:47], v[172:175], v[96:111]
  s_waitcnt lgkmcnt(6)
  ds_read_b64_tr_b16 v[40:41], v6 offset:16384
  ds_read_b64_tr_b16 v[42:43], v6 offset:17408
  v_cvt_pk_bf16_f32 v77, v18, -v19
  v_fma_f32 v16, v29, v18, -v16
  v_fma_f32 v17, v29, v19, -v17
  v_mfma_f32_32x32x16_bf16 v[96:111], v[48:51], v[176:179], v[96:111]
  s_waitcnt lgkmcnt(6)
  ds_read_b64_tr_b16 v[44:45], v6 offset:18432
  ds_read_b64_tr_b16 v[46:47], v6 offset:19456
  v_fma_f32 v18, v29, v16, -v18
  v_fma_f32 v19, v29, v17, -v19
  v_cvt_pk_bf16_f32 v78, v16, -v17
  v_mfma_f32_32x32x16_bf16 v[96:111], v[52:55], v[180:183], v[96:111]
  s_waitcnt lgkmcnt(6)
  ds_read_b64_tr_b16 v[48:49], v6 offset:20480
  ds_read_b64_tr_b16 v[50:51], v6 offset:21504
  v_cvt_pk_bf16_f32 v79, v18, -v19
  s_nop 1
  v_mfma_f32_32x32x16_bf16 v[96:111], v[76:79], v[60:63], v[96:111]
  v_fmamk_f32 v17, v1, 0x41800000, v2
  v_fmamk_f32 v19, v1, 0x41880000, v2
  v_cos_f32 v16, v17
  v_mfma_f32_32x32x16_bf16 v[96:111], v[32:35], v[184:187], v[96:111]
  s_waitcnt lgkmcnt(6)
  ds_read_b64_tr_b16 v[52:53], v6 offset:22528
  ds_read_b64_tr_b16 v[54:55], v6 offset:23552
  v_sin_f32 v17, v17
  v_mfma_f32_32x32x16_bf16 v[96:111], v[36:39], v[188:191], v[96:111]
  s_waitcnt lgkmcnt(6)
  v_cos_f32 v18, v19
  v_sin_f32 v19, v19
  v_cvt_pk_bf16_f32 v76, v16, -v17
  v_mfma_f32_32x32x16_bf16 v[96:111], v[40:43], v[192:195], v[96:111]
  s_waitcnt lgkmcnt(4)
  s_waitcnt lgkmcnt(0)
  s_barrier
  ds_read_b64_tr_b16 v[32:33], v6 offset:24576
  ds_read_b64_tr_b16 v[34:35], v6 offset:25600
  ds_read_b64_tr_b16 v[36:37], v6 offset:26624
  v_cvt_pk_bf16_f32 v77, v18, -v19
  v_fma_f32 v16, v29, v18, -v16
  v_fma_f32 v17, v29, v19, -v17
  v_mfma_f32_32x32x16_bf16 v[96:111], v[44:47], v[196:199], v[96:111]
  ds_read_b64_tr_b16 v[38:39], v6 offset:27648
  ds_read_b64_tr_b16 v[40:41], v6 offset:28672
  ds_read_b64_tr_b16 v[42:43], v6 offset:29696
  v_fma_f32 v18, v29, v16, -v18
  v_fma_f32 v19, v29, v17, -v19
  v_cvt_pk_bf16_f32 v78, v16, -v17
  v_mfma_f32_32x32x16_bf16 v[96:111], v[48:51], v[200:203], v[96:111]
  ds_read_b64_tr_b16 v[44:45], v6 offset:30720
  ds_read_b64_tr_b16 v[46:47], v6 offset:31744
  v_cvt_pk_bf16_f32 v79, v18, -v19
  s_nop 1
  v_mfma_f32_32x32x16_bf16 v[96:111], v[76:79], v[64:67], v[96:111]
  v_fmamk_f32 v17, v1, 0x41c00000, v2
  v_fmamk_f32 v19, v1, 0x41c80000, v2
  v_cos_f32 v16, v17
  v_mfma_f32_32x32x16_bf16 v[96:111], v[52:55], v[204:207], v[96:111]
  s_waitcnt lgkmcnt(6)
  ds_read_b64_tr_b16 v[48:49], v6 offset:32768
  ds_read_b64_tr_b16 v[50:51], v6 offset:33792
  v_sin_f32 v17, v17
  v_mfma_f32_32x32x16_bf16 v[96:111], v[32:35], v[208:211], v[96:111]
  s_waitcnt lgkmcnt(6)
  ds_read_b64_tr_b16 v[52:53], v6 offset:34816
  ds_read_b64_tr_b16 v[54:55], v6 offset:35840
  v_cos_f32 v18, v19
  v_mfma_f32_32x32x16_bf16 v[96:111], v[36:39], v[212:215], v[96:111]
  s_waitcnt lgkmcnt(6)
  ds_read_b64_tr_b16 v[32:33], v6 offset:36864
  ds_read_b64_tr_b16 v[34:35], v6 offset:37888
  v_sin_f32 v19, v19
  v_cvt_pk_bf16_f32 v76, v16, -v17
  v_mfma_f32_32x32x16_bf16 v[96:111], v[40:43], v[216:219], v[96:111]
  s_waitcnt lgkmcnt(6)
  ds_read_b64_tr_b16 v[36:37], v6 offset:38912
  ds_read_b64_tr_b16 v[38:39], v6 offset:39936
  v_cvt_pk_bf16_f32 v77, v18, -v19
  v_fma_f32 v16, v29, v18, -v16
  v_fma_f32 v17, v29, v19, -v17
  v_mfma_f32_32x32x16_bf16 v[96:111], v[44:47], v[220:223], v[96:111]
  s_waitcnt lgkmcnt(6)
  ds_read_b64_tr_b16 v[40:41], v6 offset:40960
  ds_read_b64_tr_b16 v[42:43], v6 offset:41984
  v_fma_f32 v18, v29, v16, -v18
  v_fma_f32 v19, v29, v17, -v19
  v_cvt_pk_bf16_f32 v78, v16, -v17
  v_mfma_f32_32x32x16_bf16 v[96:111], v[48:51], v[224:227], v[96:111]
  s_waitcnt lgkmcnt(6)
  ds_read_b64_tr_b16 v[44:45], v6 offset:43008
  ds_read_b64_tr_b16 v[46:47], v6 offset:44032
  v_cvt_pk_bf16_f32 v79, v18, -v19
  s_nop 1
  v_mfma_f32_32x32x16_bf16 v[96:111], v[76:79], v[68:71], v[96:111]
  v_fmamk_f32 v17, v1, 0x42000000, v2
  v_fmamk_f32 v19, v1, 0x42040000, v2
  v_cos_f32 v16, v17
  v_mfma_f32_32x32x16_bf16 v[96:111], v[52:55], v[228:231], v[96:111]
  s_waitcnt lgkmcnt(6)
  ds_read_b64_tr_b16 v[48:49], v6 offset:45056
  ds_read_b64_tr_b16 v[50:51], v6 offset:46080
  v_sin_f32 v17, v17
  v_mfma_f32_32x32x16_bf16 v[96:111], v[32:35], v[232:235], v[96:111]
  s_waitcnt lgkmcnt(6)
  ds_read_b64_tr_b16 v[52:53], v6 offset:47104
  ds_read_b64_tr_b16 v[54:55], v6 offset:48128
  v_cos_f32 v18, v19
  v_mfma_f32_32x32x16_bf16 v[96:111], v[36:39], v[236:239], v[96:111]
  s_waitcnt lgkmcnt(6)
  v_sin_f32 v19, v19
  v_cvt_pk_bf16_f32 v76, v16, -v17
  v_cvt_pk_bf16_f32 v77, v18, -v19
  v_fma_f32 v16, v29, v18, -v16
  v_mfma_f32_32x32x16_bf16 v[96:111], v[40:43], v[240:243], v[96:111]
  s_waitcnt lgkmcnt(4)
  s_waitcnt lgkmcnt(0)
  s_waitcnt vmcnt(0)
  s_barrier
  ds_read_b64_tr_b16 v[32:33], v6 offset:49152
  ds_read_b64_tr_b16 v[34:35], v6 offset:50176
  ds_read_b64_tr_b16 v[36:37], v6 offset:51200
  s_add_u32 s63, s58, 1
  s_and_b32 s63, s63, 7
  s_lshl_b32 s63, s63, 7
  s_add_u32 s63, s63, s77
  s_mov_b64 exec, s[78:79]
  buffer_store_dword v31, v30, s[36:39], s63 offen sc1
  s_mov_b64 exec, -1
  v_fma_f32 v17, v29, v19, -v17
  v_fma_f32 v18, v29, v16, -v18
  v_mfma_f32_32x32x16_bf16 v[96:111], v[44:47], v[244:247], v[96:111]
  ds_read_b64_tr_b16 v[38:39], v6 offset:52224
  ds_read_b64_tr_b16 v[40:41], v6 offset:53248
  ds_read_b64_tr_b16 v[42:43], v6 offset:54272
  v_fma_f32 v19, v29, v17, -v19
  v_cvt_pk_bf16_f32 v78, v16, -v17
  v_mfma_f32_32x32x16_bf16 v[96:111], v[48:51], v[248:251], v[96:111]
  ds_read_b64_tr_b16 v[44:45], v6 offset:55296
  ds_read_b64_tr_b16 v[46:47], v6 offset:56320
  v_cvt_pk_bf16_f32 v79, v18, -v19
  s_nop 1
  v_mfma_f32_32x32x16_bf16 v[96:111], v[76:79], v[72:75], v[96:111]
  v_mfma_f32_32x32x16_bf16 v[96:111], v[52:55], v[252:255], v[96:111]
  s_waitcnt lgkmcnt(6)
  ds_read_b64_tr_b16 v[48:49], v7 offset:0
  ds_read_b64_tr_b16 v[50:51], v7 offset:1024
  s_add_u32 s79, s58, 3
  s_and_b32 s79, s79, 7
  s_lshl_b32 s79, s79, 6
  v_mfma_f32_32x32x16_bf16 v[80:95], v[32:35], v[112:115], 0
  s_waitcnt lgkmcnt(6)
  s_add_u32 s62, s58, 2
  s_and_b32 s62, s62, 7
  s_lshl_b32 s62, s62, 13
  s_add_u32 s62, s62, s74
  ds_read_b64_tr_b16 v[52:53], v7 offset:2048
  ds_read_b64_tr_b16 v[54:55], v7 offset:3072
  v_mfma_f32_32x32x16_bf16 v[80:95], v[36:39], v[116:119], v[80:95]
  s_waitcnt lgkmcnt(6)
  ds_read_b64_tr_b16 v[32:33], v7 offset:4096
  ds_read_b64_tr_b16 v[34:35], v7 offset:5120
  v_cvt_pk_bf16_f32 v20, v96, v97
  v_cvt_pk_bf16_f32 v21, v98, v99
  v_cvt_pk_bf16_f32 v22, v100, v101
  v_cvt_pk_bf16_f32 v23, v102, v103
  v_mfma_f32_32x32x16_bf16 v[80:95], v[40:43], v[120:123], v[80:95]
  s_waitcnt lgkmcnt(6)
  ds_read_b64_tr_b16 v[36:37], v7 offset:6144
  ds_read_b64_tr_b16 v[38:39], v7 offset:7168
  v_cvt_pk_bf16_f32 v24, v104, v105
  v_cvt_pk_bf16_f32 v25, v106, v107
  v_cvt_pk_bf16_f32 v26, v108, v109
  v_cvt_pk_bf16_f32 v27, v110, v111
  v_mfma_f32_32x32x16_bf16 v[80:95], v[44:47], v[124:127], v[80:95]
  s_waitcnt lgkmcnt(6)
  ds_read_b64_tr_b16 v[40:41], v7 offset:8192
  ds_read_b64_tr_b16 v[42:43], v7 offset:9216
  v_mfma_f32_32x32x16_bf16 v[80:95], v[48:51], v[128:131], v[80:95]
  s_waitcnt lgkmcnt(6)
  ds_read_b64_tr_b16 v[44:45], v7 offset:10240
  ds_read_b64_tr_b16 v[46:47], v7 offset:11264
  v_add_u32 v1, s79, v4
  v_cvt_f32_u32 v1, v1
  v_mul_f32 v1, 0x3ae38e39, v1
  v_mfma_f32_32x32x16_bf16 v[80:95], v[52:55], v[132:135], v[80:95]
  s_waitcnt lgkmcnt(6)
  ds_read_b64_tr_b16 v[48:49], v7 offset:12288
  ds_read_b64_tr_b16 v[50:51], v7 offset:13312
  buffer_store_dwordx4 v[20:23], v28, s[36:39], s62 offen offset:0 sc1
  v_cos_f32 v29, v1
  v_mul_f32 v2, v5, v1
  v_mfma_f32_32x32x16_bf16 v[80:95], v[32:35], v[136:139], v[80:95]
  s_waitcnt lgkmcnt(6)
  ds_read_b64_tr_b16 v[52:53], v7 offset:14336
  ds_read_b64_tr_b16 v[54:55], v7 offset:15360
  v_fract_f32 v2, v2
  v_add_f32 v29, v29, v29
  v_fmamk_f32 v17, v1, 0x00000000, v2
  v_mfma_f32_32x32x16_bf16 v[80:95], v[36:39], v[140:143], v[80:95]
  s_waitcnt lgkmcnt(6)
  buffer_store_dwordx4 v[24:27], v28, s[36:39], s62 offen offset:1024 sc1
  v_fmamk_f32 v19, v1, 0x3f800000, v2
  v_cos_f32 v16, v17
  v_mfma_f32_32x32x16_bf16 v[80:95], v[40:43], v[144:147], v[80:95]
  s_waitcnt lgkmcnt(4)
  s_waitcnt lgkmcnt(0)
  s_barrier
  ds_read_b64_tr_b16 v[32:33], v0 offset:0
  ds_read_b64_tr_b16 v[34:35], v0 offset:1024
  ds_read_b64_tr_b16 v[36:37], v0 offset:2048
  v_sin_f32 v17, v17
  v_cos_f32 v18, v19
  v_mfma_f32_32x32x16_bf16 v[80:95], v[44:47], v[148:151], v[80:95]
  ds_read_b64_tr_b16 v[38:39], v0 offset:3072
  ds_read_b64_tr_b16 v[40:41], v0 offset:4096
  ds_read_b64_tr_b16 v[42:43], v0 offset:5120
  v_sin_f32 v19, v19
  v_cvt_pk_bf16_f32 v76, v16, -v17
  v_mfma_f32_32x32x16_bf16 v[80:95], v[48:51], v[152:155], v[80:95]
  ds_read_b64_tr_b16 v[44:45], v0 offset:6144
  ds_read_b64_tr_b16 v[46:47], v0 offset:7168
  v_cvt_pk_bf16_f32 v77, v18, -v19
  v_fma_f32 v16, v29, v18, -v16
  v_fma_f32 v17, v29, v19, -v17
  v_mfma_f32_32x32x16_bf16 v[80:95], v[52:55], v[156:159], v[80:95]
  s_waitcnt lgkmcnt(6)
  ds_read_b64_tr_b16 v[48:49], v0 offset:8192
  ds_read_b64_tr_b16 v[50:51], v0 offset:9216
  v_fma_f32 v18, v29, v16, -v18
  v_fma_f32 v19, v29, v17, -v19
  v_cvt_pk_bf16_f32 v78, v16, -v17
  v_mfma_f32_32x32x16_bf16 v[80:95], v[32:35], v[160:163], v[80:95]
  s_waitcnt lgkmcnt(6)
  ds_read_b64_tr_b16 v[52:53], v0 offset:10240
  ds_read_b64_tr_b16 v[54:55], v0 offset:11264
  v_cvt_pk_bf16_f32 v79, v18, -v19
  s_nop 1
  v_mfma_f32_32x32x16_bf16 v[80:95], v[76:79], v[56:59], v[80:95]
  v_fmamk_f32 v17, v1, 0x41000000, v2
  v_fmamk_f32 v19, v1, 0x41100000, v2
  v_cos_f32 v16, v17
  v_mfma_f32_32x32x16_bf16 v[80:95], v[36:39], v[164:167], v[80:95]
  s_waitcnt lgkmcnt(6)
  ds_read_b64_tr_b16 v[32:33], v0 offset:12288
  ds_read_b64_tr_b16 v[34:35], v0 offset:13312
  v_sin_f32 v17, v17
  v_cos_f32 v18, v19
  v_mfma_f32_32x32x16_bf16 v[80:95], v[40:43], v[168:171], v[80:95]
  s_waitcnt lgkmcnt(6)
  ds_read_b64_tr_b16 v[36:37], v0 offset:14336
  ds_read_b64_tr_b16 v[38:39], v0 offset:15360
  v_sin_f32 v19, v19
  v_cvt_pk_bf16_f32 v76, v16, -v17
  v_mfma_f32_32x32x16_bf16 v[80:95], v[44:47], v[172:175], v[80:95]
  s_waitcnt lgkmcnt(6)
  ds_read_b64_tr_b16 v[40:41], v0 offset:16384
  ds_read_b64_tr_b16 v[42:43], v0 offset:17408
  v_cvt_pk_bf16_f32 v77, v18, -v19
  v_fma_f32 v16, v29, v18, -v16
  v_fma_f32 v17, v29, v19, -v17
  v_mfma_f32_32x32x16_bf16 v[80:95], v[48:51], v[176:179], v[80:95]
  s_waitcnt lgkmcnt(6)
  ds_read_b64_tr_b16 v[44:45], v0 offset:18432
  ds_read_b64_tr_b16 v[46:47], v0 offset:19456
  v_fma_f32 v18, v29, v16, -v18
  v_fma_f32 v19, v29, v17, -v19
  v_cvt_pk_bf16_f32 v78, v16, -v17
  v_mfma_f32_32x32x16_bf16 v[80:95], v[52:55], v[180:183], v[80:95]
  s_waitcnt lgkmcnt(6)
  ds_read_b64_tr_b16 v[48:49], v0 offset:20480
  ds_read_b64_tr_b16 v[50:51], v0 offset:21504
  v_cvt_pk_bf16_f32 v79, v18, -v19
  s_nop 1
  v_mfma_f32_32x32x16_bf16 v[80:95], v[76:79], v[60:63], v[80:95]
  v_fmamk_f32 v17, v1, 0x41800000, v2
  v_fmamk_f32 v19, v1, 0x41880000, v2
  v_cos_f32 v16, v17
  v_mfma_f32_32x32x16_bf16 v[80:95], v[32:35], v[184:187], v[80:95]
  s_waitcnt lgkmcnt(6)
  ds_read_b64_tr_b16 v[52:53], v0 offset:22528
  ds_read_b64_tr_b16 v[54:55], v0 offset:23552
  v_sin_f32 v17, v17
  v_mfma_f32_32x32x16_bf16 v[80:95], v[36:39], v[188:191], v[80:95]
  s_waitcnt lgkmcnt(6)
  v_cos_f32 v18, v19
  v_sin_f32 v19, v19
  v_cvt_pk_bf16_f32 v76, v16, -v17
  v_mfma_f32_32x32x16_bf16 v[80:95], v[40:43], v[192:195], v[80:95]
  s_waitcnt lgkmcnt(4)
  s_waitcnt lgkmcnt(0)
  s_barrier
  ds_read_b64_tr_b16 v[32:33], v6 offset:0
  ds_read_b64_tr_b16 v[34:35], v6 offset:1024
  ds_read_b64_tr_b16 v[36:37], v6 offset:2048
  v_cvt_pk_bf16_f32 v77, v18, -v19
  v_fma_f32 v16, v29, v18, -v16
  v_fma_f32 v17, v29, v19, -v17
  v_mfma_f32_32x32x16_bf16 v[80:95], v[44:47], v[196:199], v[80:95]
  ds_read_b64_tr_b16 v[38:39], v6 offset:3072
  ds_read_b64_tr_b16 v[40:41], v6 offset:4096
  ds_read_b64_tr_b16 v[42:43], v6 offset:5120
  v_fma_f32 v18, v29, v16, -v18
  v_fma_f32 v19, v29, v17, -v19
  v_cvt_pk_bf16_f32 v78, v16, -v17
  v_mfma_f32_32x32x16_bf16 v[80:95], v[48:51], v[200:203], v[80:95]
  ds_read_b64_tr_b16 v[44:45], v6 offset:6144
  ds_read_b64_tr_b16 v[46:47], v6 offset:7168
  v_cvt_pk_bf16_f32 v79, v18, -v19
  s_nop 1
  v_mfma_f32_32x32x16_bf16 v[80:95], v[76:79], v[64:67], v[80:95]
  v_fmamk_f32 v17, v1, 0x41c00000, v2
  v_fmamk_f32 v19, v1, 0x41c80000, v2
  v_cos_f32 v16, v17
  v_mfma_f32_32x32x16_bf16 v[80:95], v[52:55], v[204:207], v[80:95]
  s_waitcnt lgkmcnt(6)
  ds_read_b64_tr_b16 v[48:49], v6 offset:8192
  ds_read_b64_tr_b16 v[50:51], v6 offset:9216
  v_sin_f32 v17, v17
  v_mfma_f32_32x32x16_bf16 v[80:95], v[32:35], v[208:211], v[80:95]
  s_waitcnt lgkmcnt(6)
  ds_read_b64_tr_b16 v[52:53], v6 offset:10240
  ds_read_b64_tr_b16 v[54:55], v6 offset:11264
  v_cos_f32 v18, v19
  v_mfma_f32_32x32x16_bf16 v[80:95], v[36:39], v[212:215], v[80:95]
  s_waitcnt lgkmcnt(6)
  ds_read_b64_tr_b16 v[32:33], v6 offset:12288
  ds_read_b64_tr_b16 v[34:35], v6 offset:13312
  v_sin_f32 v19, v19
  v_cvt_pk_bf16_f32 v76, v16, -v17
  v_mfma_f32_32x32x16_bf16 v[80:95], v[40:43], v[216:219], v[80:95]
  s_waitcnt lgkmcnt(6)
  ds_read_b64_tr_b16 v[36:37], v6 offset:14336
  ds_read_b64_tr_b16 v[38:39], v6 offset:15360
  v_cvt_pk_bf16_f32 v77, v18, -v19
  v_fma_f32 v16, v29, v18, -v16
  v_fma_f32 v17, v29, v19, -v17
  v_mfma_f32_32x32x16_bf16 v[80:95], v[44:47], v[220:223], v[80:95]
  s_waitcnt lgkmcnt(6)
  ds_read_b64_tr_b16 v[40:41], v6 offset:16384
  ds_read_b64_tr_b16 v[42:43], v6 offset:17408
  v_fma_f32 v18, v29, v16, -v18
  v_fma_f32 v19, v29, v17, -v19
  v_cvt_pk_bf16_f32 v78, v16, -v17
  v_mfma_f32_32x32x16_bf16 v[80:95], v[48:51], v[224:227], v[80:95]
  s_waitcnt lgkmcnt(6)
  ds_read_b64_tr_b16 v[44:45], v6 offset:18432
  ds_read_b64_tr_b16 v[46:47], v6 offset:19456
  v_cvt_pk_bf16_f32 v79, v18, -v19
  s_nop 1
  v_mfma_f32_32x32x16_bf16 v[80:95], v[76:79], v[68:71], v[80:95]
  v_fmamk_f32 v17, v1, 0x42000000, v2
  v_fmamk_f32 v19, v1, 0x42040000, v2
  v_cos_f32 v16, v17
  v_mfma_f32_32x32x16_bf16 v[80:95], v[52:55], v[228:231], v[80:95]
  s_waitcnt lgkmcnt(6)
  ds_read_b64_tr_b16 v[48:49], v6 offset:20480
  ds_read_b64_tr_b16 v[50:51], v6 offset:21504
  v_sin_f32 v17, v17
  v_mfma_f32_32x32x16_bf16 v[80:95], v[32:35], v[232:235], v[80:95]
  s_waitcnt lgkmcnt(6)
  ds_read_b64_tr_b16 v[52:53], v6 offset:22528
  ds_read_b64_tr_b16 v[54:55], v6 offset:23552
  v_cos_f32 v18, v19
  v_mfma_f32_32x32x16_bf16 v[80:95], v[36:39], v[236:239], v[80:95]
  s_waitcnt lgkmcnt(6)
  v_sin_f32 v19, v19
  v_cvt_pk_bf16_f32 v76, v16, -v17
  v_cvt_pk_bf16_f32 v77, v18, -v19
  v_fma_f32 v16, v29, v18, -v16
  v_mfma_f32_32x32x16_bf16 v[80:95], v[40:43], v[240:243], v[80:95]
  s_waitcnt lgkmcnt(4)
  s_waitcnt lgkmcnt(0)
  s_waitcnt vmcnt(0)
  s_barrier
  ds_read_b64_tr_b16 v[32:33], v6 offset:24576
  ds_read_b64_tr_b16 v[34:35], v6 offset:25600
  ds_read_b64_tr_b16 v[36:37], v6 offset:26624
  s_add_u32 s63, s58, 2
  s_and_b32 s63, s63, 7
  s_lshl_b32 s63, s63, 7
  s_add_u32 s63, s63, s77
  s_mov_b64 exec, s[78:79]
  buffer_store_dword v31, v30, s[36:39], s63 offen sc1
  s_mov_b64 exec, -1
  v_fma_f32 v17, v29, v19, -v17
  v_fma_f32 v18, v29, v16, -v18
  v_mfma_f32_32x32x16_bf16 v[80:95], v[44:47], v[244:247], v[80:95]
  ds_read_b64_tr_b16 v[38:39], v6 offset:27648
  ds_read_b64_tr_b16 v[40:41], v6 offset:28672
  ds_read_b64_tr_b16 v[42:43], v6 offset:29696
  v_fma_f32 v19, v29, v17, -v19
  v_cvt_pk_bf16_f32 v78, v16, -v17
  v_mfma_f32_32x32x16_bf16 v[80:95], v[48:51], v[248:251], v[80:95]
  ds_read_b64_tr_b16 v[44:45], v6 offset:30720
  ds_read_b64_tr_b16 v[46:47], v6 offset:31744
  v_cvt_pk_bf16_f32 v79, v18, -v19
  s_nop 1
  v_mfma_f32_32x32x16_bf16 v[80:95], v[76:79], v[72:75], v[80:95]
  v_mfma_f32_32x32x16_bf16 v[80:95], v[52:55], v[252:255], v[80:95]
  s_waitcnt lgkmcnt(6)
  ds_read_b64_tr_b16 v[48:49], v6 offset:32768
  ds_read_b64_tr_b16 v[50:51], v6 offset:33792
  s_add_u32 s79, s58, 4
  s_and_b32 s79, s79, 7
  s_lshl_b32 s79, s79, 6
  v_mfma_f32_32x32x16_bf16 v[96:111], v[32:35], v[112:115], 0
  s_waitcnt lgkmcnt(6)
  s_add_u32 s62, s58, 3
  s_and_b32 s62, s62, 7
  s_lshl_b32 s62, s62, 13
  s_add_u32 s62, s62, s74
  ds_read_b64_tr_b16 v[52:53], v6 offset:34816
  ds_read_b64_tr_b16 v[54:55], v6 offset:35840
  v_mfma_f32_32x32x16_bf16 v[96:111], v[36:39], v[116:119], v[96:111]
  s_waitcnt lgkmcnt(6)
  ds_read_b64_tr_b16 v[32:33], v6 offset:36864
  ds_read_b64_tr_b16 v[34:35], v6 offset:37888
  v_cvt_pk_bf16_f32 v20, v80, v81
  v_cvt_pk_bf16_f32 v21, v82, v83
  v_cvt_pk_bf16_f32 v22, v84, v85
  v_cvt_pk_bf16_f32 v23, v86, v87
  v_mfma_f32_32x32x16_bf16 v[96:111], v[40:43], v[120:123], v[96:111]
  s_waitcnt lgkmcnt(6)
  ds_read_b64_tr_b16 v[36:37], v6 offset:38912
  ds_read_b64_tr_b16 v[38:39], v6 offset:39936
  v_cvt_pk_bf16_f32 v24, v88, v89
  v_cvt_pk_bf16_f32 v25, v90, v91
  v_cvt_pk_bf16_f32 v26, v92, v93
  v_cvt_pk_bf16_f32 v27, v94, v95
  v_mfma_f32_32x32x16_bf16 v[96:111], v[44:47], v[124:127], v[96:111]
  s_waitcnt lgkmcnt(6)
  ds_read_b64_tr_b16 v[40:41], v6 offset:40960
  ds_read_b64_tr_b16 v[42:43], v6 offset:41984
  v_mfma_f32_32x32x16_bf16 v[96:111], v[48:51], v[128:131], v[96:111]
  s_waitcnt lgkmcnt(6)
  ds_read_b64_tr_b16 v[44:45], v6 offset:43008
  ds_read_b64_tr_b16 v[46:47], v6 offset:44032
  v_add_u32 v1, s79, v4
  v_cvt_f32_u32 v1, v1
  v_mul_f32 v1, 0x3ae38e39, v1
  v_mfma_f32_32x32x16_bf16 v[96:111], v[52:55], v[132:135], v[96:111]
  s_waitcnt lgkmcnt(6)
  ds_read_b64_tr_b16 v[48:49], v6 offset:45056
  ds_read_b64_tr_b16 v[50:51], v6 offset:46080
  buffer_store_dwordx4 v[20:23], v28, s[36:39], s62 offen offset:0 sc1
  v_cos_f32 v29, v1
  v_mul_f32 v2, v5, v1
  v_mfma_f32_32x32x16_bf16 v[96:111], v[32:35], v[136:139], v[96:111]
  s_waitcnt lgkmcnt(6)
  ds_read_b64_tr_b16 v[52:53], v6 offset:47104
  ds_read_b64_tr_b16 v[54:55], v6 offset:48128
  v_fract_f32 v2, v2
  v_add_f32 v29, v29, v29
  v_fmamk_f32 v17, v1, 0x00000000, v2
  v_mfma_f32_32x32x16_bf16 v[96:111], v[36:39], v[140:143], v[96:111]
  s_waitcnt lgkmcnt(6)
  buffer_store_dwordx4 v[24:27], v28, s[36:39], s62 offen offset:1024 sc1
  v_fmamk_f32 v19, v1, 0x3f800000, v2
  v_cos_f32 v16, v17
  v_mfma_f32_32x32x16_bf16 v[96:111], v[40:43], v[144:147], v[96:111]
  s_waitcnt lgkmcnt(4)
  s_waitcnt lgkmcnt(0)
  s_barrier
  ds_read_b64_tr_b16 v[32:33], v6 offset:49152
  ds_read_b64_tr_b16 v[34:35], v6 offset:50176
  ds_read_b64_tr_b16 v[36:37], v6 offset:51200
  v_sin_f32 v17, v17
  v_cos_f32 v18, v19
  v_mfma_f32_32x32x16_bf16 v[96:111], v[44:47], v[148:151], v[96:111]
  ds_read_b64_tr_b16 v[38:39], v6 offset:52224
  ds_read_b64_tr_b16 v[40:41], v6 offset:53248
  ds_read_b64_tr_b16 v[42:43], v6 offset:54272
  v_sin_f32 v19, v19
  v_cvt_pk_bf16_f32 v76, v16, -v17
  v_mfma_f32_32x32x16_bf16 v[96:111], v[48:51], v[152:155], v[96:111]
  ds_read_b64_tr_b16 v[44:45], v6 offset:55296
  ds_read_b64_tr_b16 v[46:47], v6 offset:56320
  v_cvt_pk_bf16_f32 v77, v18, -v19
  v_fma_f32 v16, v29, v18, -v16
  v_fma_f32 v17, v29, v19, -v17
  v_mfma_f32_32x32x16_bf16 v[96:111], v[52:55], v[156:159], v[96:111]
  s_waitcnt lgkmcnt(6)
  ds_read_b64_tr_b16 v[48:49], v7 offset:0
  ds_read_b64_tr_b16 v[50:51], v7 offset:1024
  v_fma_f32 v18, v29, v16, -v18
  v_fma_f32 v19, v29, v17, -v19
  v_cvt_pk_bf16_f32 v78, v16, -v17
  v_mfma_f32_32x32x16_bf16 v[96:111], v[32:35], v[160:163], v[96:111]
  s_waitcnt lgkmcnt(6)
  ds_read_b64_tr_b16 v[52:53], v7 offset:2048
  ds_read_b64_tr_b16 v[54:55], v7 offset:3072
  v_cvt_pk_bf16_f32 v79, v18, -v19
  s_nop 1
  v_mfma_f32_32x32x16_bf16 v[96:111], v[76:79], v[56:59], v[96:111]
  v_fmamk_f32 v17, v1, 0x41000000, v2
  v_fmamk_f32 v19, v1, 0x41100000, v2
  v_cos_f32 v16, v17
  v_mfma_f32_32x32x16_bf16 v[96:111], v[36:39], v[164:167], v[96:111]
  s_waitcnt lgkmcnt(6)
  ds_read_b64_tr_b16 v[32:33], v7 offset:4096
  ds_read_b64_tr_b16 v[34:35], v7 offset:5120
  v_sin_f32 v17, v17
  v_cos_f32 v18, v19
  v_mfma_f32_32x32x16_bf16 v[96:111], v[40:43], v[168:171], v[96:111]
  s_waitcnt lgkmcnt(6)
  ds_read_b64_tr_b16 v[36:37], v7 offset:6144
  ds_read_b64_tr_b16 v[38:39], v7 offset:7168
  v_sin_f32 v19, v19
  v_cvt_pk_bf16_f32 v76, v16, -v17
  v_mfma_f32_32x32x16_bf16 v[96:111], v[44:47], v[172:175], v[96:111]
  s_waitcnt lgkmcnt(6)
  ds_read_b64_tr_b16 v[40:41], v7 offset:8192
  ds_read_b64_tr_b16 v[42:43], v7 offset:9216
  v_cvt_pk_bf16_f32 v77, v18, -v19
  v_fma_f32 v16, v29, v18, -v16
  v_fma_f32 v17, v29, v19, -v17
  v_mfma_f32_32x32x16_bf16 v[96:111], v[48:51], v[176:179], v[96:111]
  s_waitcnt lgkmcnt(6)
  ds_read_b64_tr_b16 v[44:45], v7 offset:10240
  ds_read_b64_tr_b16 v[46:47], v7 offset:11264
  v_fma_f32 v18, v29, v16, -v18
  v_fma_f32 v19, v29, v17, -v19
  v_cvt_pk_bf16_f32 v78, v16, -v17
  v_mfma_f32_32x32x16_bf16 v[96:111], v[52:55], v[180:183], v[96:111]
  s_waitcnt lgkmcnt(6)
  ds_read_b64_tr_b16 v[48:49], v7 offset:12288
  ds_read_b64_tr_b16 v[50:51], v7 offset:13312
  v_cvt_pk_bf16_f32 v79, v18, -v19
  s_nop 1
  v_mfma_f32_32x32x16_bf16 v[96:111], v[76:79], v[60:63], v[96:111]
  v_fmamk_f32 v17, v1, 0x41800000, v2
  v_fmamk_f32 v19, v1, 0x41880000, v2
  v_cos_f32 v16, v17
  v_mfma_f32_32x32x16_bf16 v[96:111], v[32:35], v[184:187], v[96:111]
  s_waitcnt lgkmcnt(6)
  ds_read_b64_tr_b16 v[52:53], v7 offset:14336
  ds_read_b64_tr_b16 v[54:55], v7 offset:15360
  v_sin_f32 v17, v17
  v_mfma_f32_32x32x16_bf16 v[96:111], v[36:39], v[188:191], v[96:111]
  s_waitcnt lgkmcnt(6)
  v_cos_f32 v18, v19
  v_sin_f32 v19, v19
  v_cvt_pk_bf16_f32 v76, v16, -v17
  v_mfma_f32_32x32x16_bf16 v[96:111], v[40:43], v[192:195], v[96:111]
  s_waitcnt lgkmcnt(4)
  s_waitcnt lgkmcnt(0)
  s_barrier
  ds_read_b64_tr_b16 v[32:33], v0 offset:0
  ds_read_b64_tr_b16 v[34:35], v0 offset:1024
  ds_read_b64_tr_b16 v[36:37], v0 offset:2048
  v_cvt_pk_bf16_f32 v77, v18, -v19
  v_fma_f32 v16, v29, v18, -v16
  v_fma_f32 v17, v29, v19, -v17
  v_mfma_f32_32x32x16_bf16 v[96:111], v[44:47], v[196:199], v[96:111]
  ds_read_b64_tr_b16 v[38:39], v0 offset:3072
  ds_read_b64_tr_b16 v[40:41], v0 offset:4096
  ds_read_b64_tr_b16 v[42:43], v0 offset:5120
  v_fma_f32 v18, v29, v16, -v18
  v_fma_f32 v19, v29, v17, -v19
  v_cvt_pk_bf16_f32 v78, v16, -v17
  v_mfma_f32_32x32x16_bf16 v[96:111], v[48:51], v[200:203], v[96:111]
  ds_read_b64_tr_b16 v[44:45], v0 offset:6144
  ds_read_b64_tr_b16 v[46:47], v0 offset:7168
  v_cvt_pk_bf16_f32 v79, v18, -v19
  s_nop 1
  v_mfma_f32_32x32x16_bf16 v[96:111], v[76:79], v[64:67], v[96:111]
  v_fmamk_f32 v17, v1, 0x41c00000, v2
  v_fmamk_f32 v19, v1, 0x41c80000, v2
  v_cos_f32 v16, v17
  v_mfma_f32_32x32x16_bf16 v[96:111], v[52:55], v[204:207], v[96:111]
  s_waitcnt lgkmcnt(6)
  ds_read_b64_tr_b16 v[48:49], v0 offset:8192
  ds_read_b64_tr_b16 v[50:51], v0 offset:9216
  v_sin_f32 v17, v17
  v_mfma_f32_32x32x16_bf16 v[96:111], v[32:35], v[208:211], v[96:111]
  s_waitcnt lgkmcnt(6)
  ds_read_b64_tr_b16 v[52:53], v0 offset:10240
  ds_read_b64_tr_b16 v[54:55], v0 offset:11264
  v_cos_f32 v18, v19
  v_mfma_f32_32x32x16_bf16 v[96:111], v[36:39], v[212:215], v[96:111]
  s_waitcnt lgkmcnt(6)
  ds_read_b64_tr_b16 v[32:33], v0 offset:12288
  ds_read_b64_tr_b16 v[34:35], v0 offset:13312
  v_sin_f32 v19, v19
  v_cvt_pk_bf16_f32 v76, v16, -v17
  v_mfma_f32_32x32x16_bf16 v[96:111], v[40:43], v[216:219], v[96:111]
  s_waitcnt lgkmcnt(6)
  ds_read_b64_tr_b16 v[36:37], v0 offset:14336
  ds_read_b64_tr_b16 v[38:39], v0 offset:15360
  v_cvt_pk_bf16_f32 v77, v18, -v19
  v_fma_f32 v16, v29, v18, -v16
  v_fma_f32 v17, v29, v19, -v17
  v_mfma_f32_32x32x16_bf16 v[96:111], v[44:47], v[220:223], v[96:111]
  s_waitcnt lgkmcnt(6)
  ds_read_b64_tr_b16 v[40:41], v0 offset:16384
  ds_read_b64_tr_b16 v[42:43], v0 offset:17408
  v_fma_f32 v18, v29, v16, -v18
  v_fma_f32 v19, v29, v17, -v19
  v_cvt_pk_bf16_f32 v78, v16, -v17
  v_mfma_f32_32x32x16_bf16 v[96:111], v[48:51], v[224:227], v[96:111]
  s_waitcnt lgkmcnt(6)
  ds_read_b64_tr_b16 v[44:45], v0 offset:18432
  ds_read_b64_tr_b16 v[46:47], v0 offset:19456
  v_cvt_pk_bf16_f32 v79, v18, -v19
  s_nop 1
  v_mfma_f32_32x32x16_bf16 v[96:111], v[76:79], v[68:71], v[96:111]
  v_fmamk_f32 v17, v1, 0x42000000, v2
  v_fmamk_f32 v19, v1, 0x42040000, v2
  v_cos_f32 v16, v17
  v_mfma_f32_32x32x16_bf16 v[96:111], v[52:55], v[228:231], v[96:111]
  s_waitcnt lgkmcnt(6)
  ds_read_b64_tr_b16 v[48:49], v0 offset:20480
  ds_read_b64_tr_b16 v[50:51], v0 offset:21504
  v_sin_f32 v17, v17
  v_mfma_f32_32x32x16_bf16 v[96:111], v[32:35], v[232:235], v[96:111]
  s_waitcnt lgkmcnt(6)
  ds_read_b64_tr_b16 v[52:53], v0 offset:22528
  ds_read_b64_tr_b16 v[54:55], v0 offset:23552
  v_cos_f32 v18, v19
  v_mfma_f32_32x32x16_bf16 v[96:111], v[36:39], v[236:239], v[96:111]
  s_waitcnt lgkmcnt(6)
  v_sin_f32 v19, v19
  v_cvt_pk_bf16_f32 v76, v16, -v17
  v_cvt_pk_bf16_f32 v77, v18, -v19
  v_fma_f32 v16, v29, v18, -v16
  v_mfma_f32_32x32x16_bf16 v[96:111], v[40:43], v[240:243], v[96:111]
  s_waitcnt lgkmcnt(4)
  s_waitcnt lgkmcnt(0)
  s_waitcnt vmcnt(0)
  s_barrier
  ds_read_b64_tr_b16 v[32:33], v6 offset:0
  ds_read_b64_tr_b16 v[34:35], v6 offset:1024
  ds_read_b64_tr_b16 v[36:37], v6 offset:2048
  s_add_u32 s63, s58, 3
  s_and_b32 s63, s63, 7
  s_lshl_b32 s63, s63, 7
  s_add_u32 s63, s63, s77
  s_mov_b64 exec, s[78:79]
  buffer_store_dword v31, v30, s[36:39], s63 offen sc1
  s_mov_b64 exec, -1
  v_fma_f32 v17, v29, v19, -v17
  v_fma_f32 v18, v29, v16, -v18
  v_mfma_f32_32x32x16_bf16 v[96:111], v[44:47], v[244:247], v[96:111]
  ds_read_b64_tr_b16 v[38:39], v6 offset:3072
  ds_read_b64_tr_b16 v[40:41], v6 offset:4096
  ds_read_b64_tr_b16 v[42:43], v6 offset:5120
  v_fma_f32 v19, v29, v17, -v19
  v_cvt_pk_bf16_f32 v78, v16, -v17
  v_mfma_f32_32x32x16_bf16 v[96:111], v[48:51], v[248:251], v[96:111]
  ds_read_b64_tr_b16 v[44:45], v6 offset:6144
  ds_read_b64_tr_b16 v[46:47], v6 offset:7168
  v_cvt_pk_bf16_f32 v79, v18, -v19
  s_nop 1
  v_mfma_f32_32x32x16_bf16 v[96:111], v[76:79], v[72:75], v[96:111]
  v_mfma_f32_32x32x16_bf16 v[96:111], v[52:55], v[252:255], v[96:111]
  s_waitcnt lgkmcnt(6)
  ds_read_b64_tr_b16 v[48:49], v6 offset:8192
  ds_read_b64_tr_b16 v[50:51], v6 offset:9216
  s_add_u32 s79, s58, 5
  s_and_b32 s79, s79, 7
  s_lshl_b32 s79, s79, 6
  v_mfma_f32_32x32x16_bf16 v[80:95], v[32:35], v[112:115], 0
  s_waitcnt lgkmcnt(6)
  s_add_u32 s62, s58, 4
  s_and_b32 s62, s62, 7
  s_lshl_b32 s62, s62, 13
  s_add_u32 s62, s62, s74
  ds_read_b64_tr_b16 v[52:53], v6 offset:10240
  ds_read_b64_tr_b16 v[54:55], v6 offset:11264
  v_mfma_f32_32x32x16_bf16 v[80:95], v[36:39], v[116:119], v[80:95]
  s_waitcnt lgkmcnt(6)
  ds_read_b64_tr_b16 v[32:33], v6 offset:12288
  ds_read_b64_tr_b16 v[34:35], v6 offset:13312
  v_cvt_pk_bf16_f32 v20, v96, v97
  v_cvt_pk_bf16_f32 v21, v98, v99
  v_cvt_pk_bf16_f32 v22, v100, v101
  v_cvt_pk_bf16_f32 v23, v102, v103
  v_mfma_f32_32x32x16_bf16 v[80:95], v[40:43], v[120:123], v[80:95]
  s_waitcnt lgkmcnt(6)
  ds_read_b64_tr_b16 v[36:37], v6 offset:14336
  ds_read_b64_tr_b16 v[38:39], v6 offset:15360
  v_cvt_pk_bf16_f32 v24, v104, v105
  v_cvt_pk_bf16_f32 v25, v106, v107
  v_cvt_pk_bf16_f32 v26, v108, v109
  v_cvt_pk_bf16_f32 v27, v110, v111
  v_mfma_f32_32x32x16_bf16 v[80:95], v[44:47], v[124:127], v[80:95]
  s_waitcnt lgkmcnt(6)
  ds_read_b64_tr_b16 v[40:41], v6 offset:16384
  ds_read_b64_tr_b16 v[42:43], v6 offset:17408
  v_mfma_f32_32x32x16_bf16 v[80:95], v[48:51], v[128:131], v[80:95]
  s_waitcnt lgkmcnt(6)
  ds_read_b64_tr_b16 v[44:45], v6 offset:18432
  ds_read_b64_tr_b16 v[46:47], v6 offset:19456
  v_add_u32 v1, s79, v4
  v_cvt_f32_u32 v1, v1
  v_mul_f32 v1, 0x3ae38e39, v1
  v_mfma_f32_32x32x16_bf16 v[80:95], v[52:55], v[132:135], v[80:95]
  s_waitcnt lgkmcnt(6)
  ds_read_b64_tr_b16 v[48:49], v6 offset:20480
  ds_read_b64_tr_b16 v[50:51], v6 offset:21504
  buffer_store_dwordx4 v[20:23], v28, s[36:39], s62 offen offset:0 sc1
  v_cos_f32 v29, v1
  v_mul_f32 v2, v5, v1
  v_mfma_f32_32x32x16_bf16 v[80:95], v[32:35], v[136:139], v[80:95]
  s_waitcnt lgkmcnt(6)
  ds_read_b64_tr_b16 v[52:53], v6 offset:22528
  ds_read_b64_tr_b16 v[54:55], v6 offset:23552
  v_fract_f32 v2, v2
  v_add_f32 v29, v29, v29
  v_fmamk_f32 v17, v1, 0x00000000, v2
  v_mfma_f32_32x32x16_bf16 v[80:95], v[36:39], v[140:143], v[80:95]
  s_waitcnt lgkmcnt(6)
  buffer_store_dwordx4 v[24:27], v28, s[36:39], s62 offen offset:1024 sc1
  v_fmamk_f32 v19, v1, 0x3f800000, v2
  v_cos_f32 v16, v17
  v_mfma_f32_32x32x16_bf16 v[80:95], v[40:43], v[144:147], v[80:95]
  s_waitcnt lgkmcnt(4)
  s_waitcnt lgkmcnt(0)
  s_barrier
  ds_read_b64_tr_b16 v[32:33], v6 offset:24576
  ds_read_b64_tr_b16 v[34:35], v6 offset:25600
  ds_read_b64_tr_b16 v[36:37], v6 offset:26624
  v_sin_f32 v17, v17
  v_cos_f32 v18, v19
  v_mfma_f32_32x32x16_bf16 v[80:95], v[44:47], v[148:151], v[80:95]
  ds_read_b64_tr_b16 v[38:39], v6 offset:27648
  ds_read_b64_tr_b16 v[40:41], v6 offset:28672
  ds_read_b64_tr_b16 v[42:43], v6 offset:29696
  v_sin_f32 v19, v19
  v_cvt_pk_bf16_f32 v76, v16, -v17
  v_mfma_f32_32x32x16_bf16 v[80:95], v[48:51], v[152:155], v[80:95]
  ds_read_b64_tr_b16 v[44:45], v6 offset:30720
  ds_read_b64_tr_b16 v[46:47], v6 offset:31744
  v_cvt_pk_bf16_f32 v77, v18, -v19
  v_fma_f32 v16, v29, v18, -v16
  v_fma_f32 v17, v29, v19, -v17
  v_mfma_f32_32x32x16_bf16 v[80:95], v[52:55], v[156:159], v[80:95]
  s_waitcnt lgkmcnt(6)
  ds_read_b64_tr_b16 v[48:49], v6 offset:32768
  ds_read_b64_tr_b16 v[50:51], v6 offset:33792
  v_fma_f32 v18, v29, v16, -v18
  v_fma_f32 v19, v29, v17, -v19
  v_cvt_pk_bf16_f32 v78, v16, -v17
  v_mfma_f32_32x32x16_bf16 v[80:95], v[32:35], v[160:163], v[80:95]
  s_waitcnt lgkmcnt(6)
  ds_read_b64_tr_b16 v[52:53], v6 offset:34816
  ds_read_b64_tr_b16 v[54:55], v6 offset:35840
  v_cvt_pk_bf16_f32 v79, v18, -v19
  s_nop 1
  v_mfma_f32_32x32x16_bf16 v[80:95], v[76:79], v[56:59], v[80:95]
  v_fmamk_f32 v17, v1, 0x41000000, v2
  v_fmamk_f32 v19, v1, 0x41100000, v2
  v_cos_f32 v16, v17
  v_mfma_f32_32x32x16_bf16 v[80:95], v[36:39], v[164:167], v[80:95]
  s_waitcnt lgkmcnt(6)
  ds_read_b64_tr_b16 v[32:33], v6 offset:36864
  ds_read_b64_tr_b16 v[34:35], v6 offset:37888
  v_sin_f32 v17, v17
  v_cos_f32 v18, v19
  v_mfma_f32_32x32x16_bf16 v[80:95], v[40:43], v[168:171], v[80:95]
  s_waitcnt lgkmcnt(6)
  ds_read_b64_tr_b16 v[36:37], v6 offset:38912
  ds_read_b64_tr_b16 v[38:39], v6 offset:39936
  v_sin_f32 v19, v19
  v_cvt_pk_bf16_f32 v76, v16, -v17
  v_mfma_f32_32x32x16_bf16 v[80:95], v[44:47], v[172:175], v[80:95]
  s_waitcnt lgkmcnt(6)
  ds_read_b64_tr_b16 v[40:41], v6 offset:40960
  ds_read_b64_tr_b16 v[42:43], v6 offset:41984
  v_cvt_pk_bf16_f32 v77, v18, -v19
  v_fma_f32 v16, v29, v18, -v16
  v_fma_f32 v17, v29, v19, -v17
  v_mfma_f32_32x32x16_bf16 v[80:95], v[48:51], v[176:179], v[80:95]
  s_waitcnt lgkmcnt(6)
  ds_read_b64_tr_b16 v[44:45], v6 offset:43008
  ds_read_b64_tr_b16 v[46:47], v6 offset:44032
  v_fma_f32 v18, v29, v16, -v18
  v_fma_f32 v19, v29, v17, -v19
  v_cvt_pk_bf16_f32 v78, v16, -v17
  v_mfma_f32_32x32x16_bf16 v[80:95], v[52:55], v[180:183], v[80:95]
  s_waitcnt lgkmcnt(6)
  ds_read_b64_tr_b16 v[48:49], v6 offset:45056
  ds_read_b64_tr_b16 v[50:51], v6 offset:46080
  v_cvt_pk_bf16_f32 v79, v18, -v19
  s_nop 1
  v_mfma_f32_32x32x16_bf16 v[80:95], v[76:79], v[60:63], v[80:95]
  v_fmamk_f32 v17, v1, 0x41800000, v2
  v_fmamk_f32 v19, v1, 0x41880000, v2
  v_cos_f32 v16, v17
  v_mfma_f32_32x32x16_bf16 v[80:95], v[32:35], v[184:187], v[80:95]
  s_waitcnt lgkmcnt(6)
  ds_read_b64_tr_b16 v[52:53], v6 offset:47104
  ds_read_b64_tr_b16 v[54:55], v6 offset:48128
  v_sin_f32 v17, v17
  v_mfma_f32_32x32x16_bf16 v[80:95], v[36:39], v[188:191], v[80:95]
  s_waitcnt lgkmcnt(6)
  v_cos_f32 v18, v19
  v_sin_f32 v19, v19
  v_cvt_pk_bf16_f32 v76, v16, -v17
  v_mfma_f32_32x32x16_bf16 v[80:95], v[40:43], v[192:195], v[80:95]
  s_waitcnt lgkmcnt(4)
  s_waitcnt lgkmcnt(0)
  s_barrier
  ds_read_b64_tr_b16 v[32:33], v6 offset:49152
  ds_read_b64_tr_b16 v[34:35], v6 offset:50176
  ds_read_b64_tr_b16 v[36:37], v6 offset:51200
  v_cvt_pk_bf16_f32 v77, v18, -v19
  v_fma_f32 v16, v29, v18, -v16
  v_fma_f32 v17, v29, v19, -v17
  v_mfma_f32_32x32x16_bf16 v[80:95], v[44:47], v[196:199], v[80:95]
  ds_read_b64_tr_b16 v[38:39], v6 offset:52224
  ds_read_b64_tr_b16 v[40:41], v6 offset:53248
  ds_read_b64_tr_b16 v[42:43], v6 offset:54272
  v_fma_f32 v18, v29, v16, -v18
  v_fma_f32 v19, v29, v17, -v19
  v_cvt_pk_bf16_f32 v78, v16, -v17
  v_mfma_f32_32x32x16_bf16 v[80:95], v[48:51], v[200:203], v[80:95]
  ds_read_b64_tr_b16 v[44:45], v6 offset:55296
  ds_read_b64_tr_b16 v[46:47], v6 offset:56320
  v_cvt_pk_bf16_f32 v79, v18, -v19
  s_nop 1
  v_mfma_f32_32x32x16_bf16 v[80:95], v[76:79], v[64:67], v[80:95]
  v_fmamk_f32 v17, v1, 0x41c00000, v2
  v_fmamk_f32 v19, v1, 0x41c80000, v2
  v_cos_f32 v16, v17
  v_mfma_f32_32x32x16_bf16 v[80:95], v[52:55], v[204:207], v[80:95]
  s_waitcnt lgkmcnt(6)
  ds_read_b64_tr_b16 v[48:49], v7 offset:0
  ds_read_b64_tr_b16 v[50:51], v7 offset:1024
  v_sin_f32 v17, v17
  v_mfma_f32_32x32x16_bf16 v[80:95], v[32:35], v[208:211], v[80:95]
  s_waitcnt lgkmcnt(6)
  ds_read_b64_tr_b16 v[52:53], v7 offset:2048
  ds_read_b64_tr_b16 v[54:55], v7 offset:3072
  v_cos_f32 v18, v19
  v_mfma_f32_32x32x16_bf16 v[80:95], v[36:39], v[212:215], v[80:95]
  s_waitcnt lgkmcnt(6)
  ds_read_b64_tr_b16 v[32:33], v7 offset:4096
  ds_read_b64_tr_b16 v[34:35], v7 offset:5120
  v_sin_f32 v19, v19
  v_cvt_pk_bf16_f32 v76, v16, -v17
  v_mfma_f32_32x32x16_bf16 v[80:95], v[40:43], v[216:219], v[80:95]
  s_waitcnt lgkmcnt(6)
  ds_read_b64_tr_b16 v[36:37], v7 offset:6144
  ds_read_b64_tr_b16 v[38:39], v7 offset:7168
  v_cvt_pk_bf16_f32 v77, v18, -v19
  v_fma_f32 v16, v29, v18, -v16
  v_fma_f32 v17, v29, v19, -v17
  v_mfma_f32_32x32x16_bf16 v[80:95], v[44:47], v[220:223], v[80:95]
  s_waitcnt lgkmcnt(6)
  ds_read_b64_tr_b16 v[40:41], v7 offset:8192
  ds_read_b64_tr_b16 v[42:43], v7 offset:9216
  v_fma_f32 v18, v29, v16, -v18
  v_fma_f32 v19, v29, v17, -v19
  v_cvt_pk_bf16_f32 v78, v16, -v17
  v_mfma_f32_32x32x16_bf16 v[80:95], v[48:51], v[224:227], v[80:95]
  s_waitcnt lgkmcnt(6)
  ds_read_b64_tr_b16 v[44:45], v7 offset:10240
  ds_read_b64_tr_b16 v[46:47], v7 offset:11264
  v_cvt_pk_bf16_f32 v79, v18, -v19
  s_nop 1
  v_mfma_f32_32x32x16_bf16 v[80:95], v[76:79], v[68:71], v[80:95]
  v_fmamk_f32 v17, v1, 0x42000000, v2
  v_fmamk_f32 v19, v1, 0x42040000, v2
  v_cos_f32 v16, v17
  v_mfma_f32_32x32x16_bf16 v[80:95], v[52:55], v[228:231], v[80:95]
  s_waitcnt lgkmcnt(6)
  ds_read_b64_tr_b16 v[48:49], v7 offset:12288
  ds_read_b64_tr_b16 v[50:51], v7 offset:13312
  v_sin_f32 v17, v17
  v_mfma_f32_32x32x16_bf16 v[80:95], v[32:35], v[232:235], v[80:95]
  s_waitcnt lgkmcnt(6)
  ds_read_b64_tr_b16 v[52:53], v7 offset:14336
  ds_read_b64_tr_b16 v[54:55], v7 offset:15360
  v_cos_f32 v18, v19
  v_mfma_f32_32x32x16_bf16 v[80:95], v[36:39], v[236:239], v[80:95]
  s_waitcnt lgkmcnt(6)
  v_sin_f32 v19, v19
  v_cvt_pk_bf16_f32 v76, v16, -v17
  v_cvt_pk_bf16_f32 v77, v18, -v19
  v_fma_f32 v16, v29, v18, -v16
  v_mfma_f32_32x32x16_bf16 v[80:95], v[40:43], v[240:243], v[80:95]
  s_waitcnt lgkmcnt(4)
  s_waitcnt lgkmcnt(0)
  s_waitcnt vmcnt(0)
  s_barrier
  ds_read_b64_tr_b16 v[32:33], v0 offset:0
  ds_read_b64_tr_b16 v[34:35], v0 offset:1024
  ds_read_b64_tr_b16 v[36:37], v0 offset:2048
  s_add_u32 s63, s58, 4
  s_and_b32 s63, s63, 7
  s_lshl_b32 s63, s63, 7
  s_add_u32 s63, s63, s77
  s_mov_b64 exec, s[78:79]
  buffer_store_dword v31, v30, s[36:39], s63 offen sc1
  s_mov_b64 exec, -1
  v_fma_f32 v17, v29, v19, -v17
  v_fma_f32 v18, v29, v16, -v18
  v_mfma_f32_32x32x16_bf16 v[80:95], v[44:47], v[244:247], v[80:95]
  ds_read_b64_tr_b16 v[38:39], v0 offset:3072
  ds_read_b64_tr_b16 v[40:41], v0 offset:4096
  ds_read_b64_tr_b16 v[42:43], v0 offset:5120
  v_fma_f32 v19, v29, v17, -v19
  v_cvt_pk_bf16_f32 v78, v16, -v17
  v_mfma_f32_32x32x16_bf16 v[80:95], v[48:51], v[248:251], v[80:95]
  ds_read_b64_tr_b16 v[44:45], v0 offset:6144
  ds_read_b64_tr_b16 v[46:47], v0 offset:7168
  v_cvt_pk_bf16_f32 v79, v18, -v19
  s_nop 1
  v_mfma_f32_32x32x16_bf16 v[80:95], v[76:79], v[72:75], v[80:95]
  v_mfma_f32_32x32x16_bf16 v[80:95], v[52:55], v[252:255], v[80:95]
  s_waitcnt lgkmcnt(6)
  ds_read_b64_tr_b16 v[48:49], v0 offset:8192
  ds_read_b64_tr_b16 v[50:51], v0 offset:9216
  s_add_u32 s79, s58, 6
  s_and_b32 s79, s79, 7
  s_lshl_b32 s79, s79, 6
  v_mfma_f32_32x32x16_bf16 v[96:111], v[32:35], v[112:115], 0
  s_waitcnt lgkmcnt(6)
  s_add_u32 s62, s58, 5
  s_and_b32 s62, s62, 7
  s_lshl_b32 s62, s62, 13
  s_add_u32 s62, s62, s74
  ds_read_b64_tr_b16 v[52:53], v0 offset:10240
  ds_read_b64_tr_b16 v[54:55], v0 offset:11264
  v_mfma_f32_32x32x16_bf16 v[96:111], v[36:39], v[116:119], v[96:111]
  s_waitcnt lgkmcnt(6)
  ds_read_b64_tr_b16 v[32:33], v0 offset:12288
  ds_read_b64_tr_b16 v[34:35], v0 offset:13312
  v_cvt_pk_bf16_f32 v20, v80, v81
  v_cvt_pk_bf16_f32 v21, v82, v83
  v_cvt_pk_bf16_f32 v22, v84, v85
  v_cvt_pk_bf16_f32 v23, v86, v87
  v_mfma_f32_32x32x16_bf16 v[96:111], v[40:43], v[120:123], v[96:111]
  s_waitcnt lgkmcnt(6)
  ds_read_b64_tr_b16 v[36:37], v0 offset:14336
  ds_read_b64_tr_b16 v[38:39], v0 offset:15360
  v_cvt_pk_bf16_f32 v24, v88, v89
  v_cvt_pk_bf16_f32 v25, v90, v91
  v_cvt_pk_bf16_f32 v26, v92, v93
  v_cvt_pk_bf16_f32 v27, v94, v95
  v_mfma_f32_32x32x16_bf16 v[96:111], v[44:47], v[124:127], v[96:111]
  s_waitcnt lgkmcnt(6)
  ds_read_b64_tr_b16 v[40:41], v0 offset:16384
  ds_read_b64_tr_b16 v[42:43], v0 offset:17408
  v_mfma_f32_32x32x16_bf16 v[96:111], v[48:51], v[128:131], v[96:111]
  s_waitcnt lgkmcnt(6)
  ds_read_b64_tr_b16 v[44:45], v0 offset:18432
  ds_read_b64_tr_b16 v[46:47], v0 offset:19456
  v_add_u32 v1, s79, v4
  v_cvt_f32_u32 v1, v1
  v_mul_f32 v1, 0x3ae38e39, v1
  v_mfma_f32_32x32x16_bf16 v[96:111], v[52:55], v[132:135], v[96:111]
  s_waitcnt lgkmcnt(6)
  ds_read_b64_tr_b16 v[48:49], v0 offset:20480
  ds_read_b64_tr_b16 v[50:51], v0 offset:21504
  buffer_store_dwordx4 v[20:23], v28, s[36:39], s62 offen offset:0 sc1
  v_cos_f32 v29, v1
  v_mul_f32 v2, v5, v1
  v_mfma_f32_32x32x16_bf16 v[96:111], v[32:35], v[136:139], v[96:111]
  s_waitcnt lgkmcnt(6)
  ds_read_b64_tr_b16 v[52:53], v0 offset:22528
  ds_read_b64_tr_b16 v[54:55], v0 offset:23552
  v_fract_f32 v2, v2
  v_add_f32 v29, v29, v29
  v_fmamk_f32 v17, v1, 0x00000000, v2
  v_mfma_f32_32x32x16_bf16 v[96:111], v[36:39], v[140:143], v[96:111]
  s_waitcnt lgkmcnt(6)
  buffer_store_dwordx4 v[24:27], v28, s[36:39], s62 offen offset:1024 sc1
  v_fmamk_f32 v19, v1, 0x3f800000, v2
  v_cos_f32 v16, v17
  v_mfma_f32_32x32x16_bf16 v[96:111], v[40:43], v[144:147], v[96:111]
  s_waitcnt lgkmcnt(4)
  s_waitcnt lgkmcnt(0)
  s_barrier
  ds_read_b64_tr_b16 v[32:33], v6 offset:0
  ds_read_b64_tr_b16 v[34:35], v6 offset:1024
  ds_read_b64_tr_b16 v[36:37], v6 offset:2048
  v_sin_f32 v17, v17
  v_cos_f32 v18, v19
  v_mfma_f32_32x32x16_bf16 v[96:111], v[44:47], v[148:151], v[96:111]
  ds_read_b64_tr_b16 v[38:39], v6 offset:3072
  ds_read_b64_tr_b16 v[40:41], v6 offset:4096
  ds_read_b64_tr_b16 v[42:43], v6 offset:5120
  v_sin_f32 v19, v19
  v_cvt_pk_bf16_f32 v76, v16, -v17
  v_mfma_f32_32x32x16_bf16 v[96:111], v[48:51], v[152:155], v[96:111]
  ds_read_b64_tr_b16 v[44:45], v6 offset:6144
  ds_read_b64_tr_b16 v[46:47], v6 offset:7168
  v_cvt_pk_bf16_f32 v77, v18, -v19
  v_fma_f32 v16, v29, v18, -v16
  v_fma_f32 v17, v29, v19, -v17
  v_mfma_f32_32x32x16_bf16 v[96:111], v[52:55], v[156:159], v[96:111]
  s_waitcnt lgkmcnt(6)
  ds_read_b64_tr_b16 v[48:49], v6 offset:8192
  ds_read_b64_tr_b16 v[50:51], v6 offset:9216
  v_fma_f32 v18, v29, v16, -v18
  v_fma_f32 v19, v29, v17, -v19
  v_cvt_pk_bf16_f32 v78, v16, -v17
  v_mfma_f32_32x32x16_bf16 v[96:111], v[32:35], v[160:163], v[96:111]
  s_waitcnt lgkmcnt(6)
  ds_read_b64_tr_b16 v[52:53], v6 offset:10240
  ds_read_b64_tr_b16 v[54:55], v6 offset:11264
  v_cvt_pk_bf16_f32 v79, v18, -v19
  s_nop 1
  v_mfma_f32_32x32x16_bf16 v[96:111], v[76:79], v[56:59], v[96:111]
  v_fmamk_f32 v17, v1, 0x41000000, v2
  v_fmamk_f32 v19, v1, 0x41100000, v2
  v_cos_f32 v16, v17
  v_mfma_f32_32x32x16_bf16 v[96:111], v[36:39], v[164:167], v[96:111]
  s_waitcnt lgkmcnt(6)
  ds_read_b64_tr_b16 v[32:33], v6 offset:12288
  ds_read_b64_tr_b16 v[34:35], v6 offset:13312
  v_sin_f32 v17, v17
  v_cos_f32 v18, v19
  v_mfma_f32_32x32x16_bf16 v[96:111], v[40:43], v[168:171], v[96:111]
  s_waitcnt lgkmcnt(6)
  ds_read_b64_tr_b16 v[36:37], v6 offset:14336
  ds_read_b64_tr_b16 v[38:39], v6 offset:15360
  v_sin_f32 v19, v19
  v_cvt_pk_bf16_f32 v76, v16, -v17
  v_mfma_f32_32x32x16_bf16 v[96:111], v[44:47], v[172:175], v[96:111]
  s_waitcnt lgkmcnt(6)
  ds_read_b64_tr_b16 v[40:41], v6 offset:16384
  ds_read_b64_tr_b16 v[42:43], v6 offset:17408
  v_cvt_pk_bf16_f32 v77, v18, -v19
  v_fma_f32 v16, v29, v18, -v16
  v_fma_f32 v17, v29, v19, -v17
  v_mfma_f32_32x32x16_bf16 v[96:111], v[48:51], v[176:179], v[96:111]
  s_waitcnt lgkmcnt(6)
  ds_read_b64_tr_b16 v[44:45], v6 offset:18432
  ds_read_b64_tr_b16 v[46:47], v6 offset:19456
  v_fma_f32 v18, v29, v16, -v18
  v_fma_f32 v19, v29, v17, -v19
  v_cvt_pk_bf16_f32 v78, v16, -v17
  v_mfma_f32_32x32x16_bf16 v[96:111], v[52:55], v[180:183], v[96:111]
  s_waitcnt lgkmcnt(6)
  ds_read_b64_tr_b16 v[48:49], v6 offset:20480
  ds_read_b64_tr_b16 v[50:51], v6 offset:21504
  v_cvt_pk_bf16_f32 v79, v18, -v19
  s_nop 1
  v_mfma_f32_32x32x16_bf16 v[96:111], v[76:79], v[60:63], v[96:111]
  v_fmamk_f32 v17, v1, 0x41800000, v2
  v_fmamk_f32 v19, v1, 0x41880000, v2
  v_cos_f32 v16, v17
  v_mfma_f32_32x32x16_bf16 v[96:111], v[32:35], v[184:187], v[96:111]
  s_waitcnt lgkmcnt(6)
  ds_read_b64_tr_b16 v[52:53], v6 offset:22528
  ds_read_b64_tr_b16 v[54:55], v6 offset:23552
  v_sin_f32 v17, v17
  v_mfma_f32_32x32x16_bf16 v[96:111], v[36:39], v[188:191], v[96:111]
  s_waitcnt lgkmcnt(6)
  v_cos_f32 v18, v19
  v_sin_f32 v19, v19
  v_cvt_pk_bf16_f32 v76, v16, -v17
  v_mfma_f32_32x32x16_bf16 v[96:111], v[40:43], v[192:195], v[96:111]
  s_waitcnt lgkmcnt(4)
  s_waitcnt lgkmcnt(0)
  s_barrier
  ds_read_b64_tr_b16 v[32:33], v6 offset:24576
  ds_read_b64_tr_b16 v[34:35], v6 offset:25600
  ds_read_b64_tr_b16 v[36:37], v6 offset:26624
  v_cvt_pk_bf16_f32 v77, v18, -v19
  v_fma_f32 v16, v29, v18, -v16
  v_fma_f32 v17, v29, v19, -v17
  v_mfma_f32_32x32x16_bf16 v[96:111], v[44:47], v[196:199], v[96:111]
  ds_read_b64_tr_b16 v[38:39], v6 offset:27648
  ds_read_b64_tr_b16 v[40:41], v6 offset:28672
  ds_read_b64_tr_b16 v[42:43], v6 offset:29696
  v_fma_f32 v18, v29, v16, -v18
  v_fma_f32 v19, v29, v17, -v19
  v_cvt_pk_bf16_f32 v78, v16, -v17
  v_mfma_f32_32x32x16_bf16 v[96:111], v[48:51], v[200:203], v[96:111]
  ds_read_b64_tr_b16 v[44:45], v6 offset:30720
  ds_read_b64_tr_b16 v[46:47], v6 offset:31744
  v_cvt_pk_bf16_f32 v79, v18, -v19
  s_nop 1
  v_mfma_f32_32x32x16_bf16 v[96:111], v[76:79], v[64:67], v[96:111]
  v_fmamk_f32 v17, v1, 0x41c00000, v2
  v_fmamk_f32 v19, v1, 0x41c80000, v2
  v_cos_f32 v16, v17
  v_mfma_f32_32x32x16_bf16 v[96:111], v[52:55], v[204:207], v[96:111]
  s_waitcnt lgkmcnt(6)
  ds_read_b64_tr_b16 v[48:49], v6 offset:32768
  ds_read_b64_tr_b16 v[50:51], v6 offset:33792
  v_sin_f32 v17, v17
  v_mfma_f32_32x32x16_bf16 v[96:111], v[32:35], v[208:211], v[96:111]
  s_waitcnt lgkmcnt(6)
  ds_read_b64_tr_b16 v[52:53], v6 offset:34816
  ds_read_b64_tr_b16 v[54:55], v6 offset:35840
  v_cos_f32 v18, v19
  v_mfma_f32_32x32x16_bf16 v[96:111], v[36:39], v[212:215], v[96:111]
  s_waitcnt lgkmcnt(6)
  ds_read_b64_tr_b16 v[32:33], v6 offset:36864
  ds_read_b64_tr_b16 v[34:35], v6 offset:37888
  v_sin_f32 v19, v19
  v_cvt_pk_bf16_f32 v76, v16, -v17
  v_mfma_f32_32x32x16_bf16 v[96:111], v[40:43], v[216:219], v[96:111]
  s_waitcnt lgkmcnt(6)
  ds_read_b64_tr_b16 v[36:37], v6 offset:38912
  ds_read_b64_tr_b16 v[38:39], v6 offset:39936
  v_cvt_pk_bf16_f32 v77, v18, -v19
  v_fma_f32 v16, v29, v18, -v16
  v_fma_f32 v17, v29, v19, -v17
  v_mfma_f32_32x32x16_bf16 v[96:111], v[44:47], v[220:223], v[96:111]
  s_waitcnt lgkmcnt(6)
  ds_read_b64_tr_b16 v[40:41], v6 offset:40960
  ds_read_b64_tr_b16 v[42:43], v6 offset:41984
  v_fma_f32 v18, v29, v16, -v18
  v_fma_f32 v19, v29, v17, -v19
  v_cvt_pk_bf16_f32 v78, v16, -v17
  v_mfma_f32_32x32x16_bf16 v[96:111], v[48:51], v[224:227], v[96:111]
  s_waitcnt lgkmcnt(6)
  ds_read_b64_tr_b16 v[44:45], v6 offset:43008
  ds_read_b64_tr_b16 v[46:47], v6 offset:44032
  v_cvt_pk_bf16_f32 v79, v18, -v19
  s_nop 1
  v_mfma_f32_32x32x16_bf16 v[96:111], v[76:79], v[68:71], v[96:111]
  v_fmamk_f32 v17, v1, 0x42000000, v2
  v_fmamk_f32 v19, v1, 0x42040000, v2
  v_cos_f32 v16, v17
  v_mfma_f32_32x32x16_bf16 v[96:111], v[52:55], v[228:231], v[96:111]
  s_waitcnt lgkmcnt(6)
  ds_read_b64_tr_b16 v[48:49], v6 offset:45056
  ds_read_b64_tr_b16 v[50:51], v6 offset:46080
  v_sin_f32 v17, v17
  v_mfma_f32_32x32x16_bf16 v[96:111], v[32:35], v[232:235], v[96:111]
  s_waitcnt lgkmcnt(6)
  ds_read_b64_tr_b16 v[52:53], v6 offset:47104
  ds_read_b64_tr_b16 v[54:55], v6 offset:48128
  v_cos_f32 v18, v19
  v_mfma_f32_32x32x16_bf16 v[96:111], v[36:39], v[236:239], v[96:111]
  s_waitcnt lgkmcnt(6)
  v_sin_f32 v19, v19
  v_cvt_pk_bf16_f32 v76, v16, -v17
  v_cvt_pk_bf16_f32 v77, v18, -v19
  v_fma_f32 v16, v29, v18, -v16
  v_mfma_f32_32x32x16_bf16 v[96:111], v[40:43], v[240:243], v[96:111]
  s_waitcnt lgkmcnt(4)
  s_waitcnt lgkmcnt(0)
  s_waitcnt vmcnt(0)
  s_barrier
  ds_read_b64_tr_b16 v[32:33], v6 offset:49152
  ds_read_b64_tr_b16 v[34:35], v6 offset:50176
  ds_read_b64_tr_b16 v[36:37], v6 offset:51200
  s_add_u32 s63, s58, 5
  s_and_b32 s63, s63, 7
  s_lshl_b32 s63, s63, 7
  s_add_u32 s63, s63, s77
  s_mov_b64 exec, s[78:79]
  buffer_store_dword v31, v30, s[36:39], s63 offen sc1
  s_mov_b64 exec, -1
  v_fma_f32 v17, v29, v19, -v17
  v_fma_f32 v18, v29, v16, -v18
  v_mfma_f32_32x32x16_bf16 v[96:111], v[44:47], v[244:247], v[96:111]
  ds_read_b64_tr_b16 v[38:39], v6 offset:52224
  ds_read_b64_tr_b16 v[40:41], v6 offset:53248
  ds_read_b64_tr_b16 v[42:43], v6 offset:54272
  v_fma_f32 v19, v29, v17, -v19
  v_cvt_pk_bf16_f32 v78, v16, -v17
  v_mfma_f32_32x32x16_bf16 v[96:111], v[48:51], v[248:251], v[96:111]
  ds_read_b64_tr_b16 v[44:45], v6 offset:55296
  ds_read_b64_tr_b16 v[46:47], v6 offset:56320
  v_cvt_pk_bf16_f32 v79, v18, -v19
  s_nop 1
  v_mfma_f32_32x32x16_bf16 v[96:111], v[76:79], v[72:75], v[96:111]
  v_mfma_f32_32x32x16_bf16 v[96:111], v[52:55], v[252:255], v[96:111]
  s_waitcnt lgkmcnt(6)
  ds_read_b64_tr_b16 v[48:49], v7 offset:0
  ds_read_b64_tr_b16 v[50:51], v7 offset:1024
  s_add_u32 s79, s58, 7
  s_and_b32 s79, s79, 7
  s_lshl_b32 s79, s79, 6
  v_mfma_f32_32x32x16_bf16 v[80:95], v[32:35], v[112:115], 0
  s_waitcnt lgkmcnt(6)
  s_add_u32 s62, s58, 6
  s_and_b32 s62, s62, 7
  s_lshl_b32 s62, s62, 13
  s_add_u32 s62, s62, s74
  ds_read_b64_tr_b16 v[52:53], v7 offset:2048
  ds_read_b64_tr_b16 v[54:55], v7 offset:3072
  v_mfma_f32_32x32x16_bf16 v[80:95], v[36:39], v[116:119], v[80:95]
  s_waitcnt lgkmcnt(6)
  ds_read_b64_tr_b16 v[32:33], v7 offset:4096
  ds_read_b64_tr_b16 v[34:35], v7 offset:5120
  v_cvt_pk_bf16_f32 v20, v96, v97
  v_cvt_pk_bf16_f32 v21, v98, v99
  v_cvt_pk_bf16_f32 v22, v100, v101
  v_cvt_pk_bf16_f32 v23, v102, v103
  v_mfma_f32_32x32x16_bf16 v[80:95], v[40:43], v[120:123], v[80:95]
  s_waitcnt lgkmcnt(6)
  ds_read_b64_tr_b16 v[36:37], v7 offset:6144
  ds_read_b64_tr_b16 v[38:39], v7 offset:7168
  v_cvt_pk_bf16_f32 v24, v104, v105
  v_cvt_pk_bf16_f32 v25, v106, v107
  v_cvt_pk_bf16_f32 v26, v108, v109
  v_cvt_pk_bf16_f32 v27, v110, v111
  v_mfma_f32_32x32x16_bf16 v[80:95], v[44:47], v[124:127], v[80:95]
  s_waitcnt lgkmcnt(6)
  ds_read_b64_tr_b16 v[40:41], v7 offset:8192
  ds_read_b64_tr_b16 v[42:43], v7 offset:9216
  v_mfma_f32_32x32x16_bf16 v[80:95], v[48:51], v[128:131], v[80:95]
  s_waitcnt lgkmcnt(6)
  ds_read_b64_tr_b16 v[44:45], v7 offset:10240
  ds_read_b64_tr_b16 v[46:47], v7 offset:11264
  v_add_u32 v1, s79, v4
  v_cvt_f32_u32 v1, v1
  v_mul_f32 v1, 0x3ae38e39, v1
  v_mfma_f32_32x32x16_bf16 v[80:95], v[52:55], v[132:135], v[80:95]
  s_waitcnt lgkmcnt(6)
  ds_read_b64_tr_b16 v[48:49], v7 offset:12288
  ds_read_b64_tr_b16 v[50:51], v7 offset:13312
  buffer_store_dwordx4 v[20:23], v28, s[36:39], s62 offen offset:0 sc1
  v_cos_f32 v29, v1
  v_mul_f32 v2, v5, v1
  v_mfma_f32_32x32x16_bf16 v[80:95], v[32:35], v[136:139], v[80:95]
  s_waitcnt lgkmcnt(6)
  ds_read_b64_tr_b16 v[52:53], v7 offset:14336
  ds_read_b64_tr_b16 v[54:55], v7 offset:15360
  v_fract_f32 v2, v2
  v_add_f32 v29, v29, v29
  v_fmamk_f32 v17, v1, 0x00000000, v2
  v_mfma_f32_32x32x16_bf16 v[80:95], v[36:39], v[140:143], v[80:95]
  s_waitcnt lgkmcnt(6)
  buffer_store_dwordx4 v[24:27], v28, s[36:39], s62 offen offset:1024 sc1
  v_fmamk_f32 v19, v1, 0x3f800000, v2
  v_cos_f32 v16, v17
  v_mfma_f32_32x32x16_bf16 v[80:95], v[40:43], v[144:147], v[80:95]
  s_waitcnt lgkmcnt(4)
  s_waitcnt lgkmcnt(0)
  s_barrier
  ds_read_b64_tr_b16 v[32:33], v0 offset:0
  ds_read_b64_tr_b16 v[34:35], v0 offset:1024
  ds_read_b64_tr_b16 v[36:37], v0 offset:2048
  v_sin_f32 v17, v17
  v_cos_f32 v18, v19
  v_mfma_f32_32x32x16_bf16 v[80:95], v[44:47], v[148:151], v[80:95]
  ds_read_b64_tr_b16 v[38:39], v0 offset:3072
  ds_read_b64_tr_b16 v[40:41], v0 offset:4096
  ds_read_b64_tr_b16 v[42:43], v0 offset:5120
  v_sin_f32 v19, v19
  v_cvt_pk_bf16_f32 v76, v16, -v17
  v_mfma_f32_32x32x16_bf16 v[80:95], v[48:51], v[152:155], v[80:95]
  ds_read_b64_tr_b16 v[44:45], v0 offset:6144
  ds_read_b64_tr_b16 v[46:47], v0 offset:7168
  v_cvt_pk_bf16_f32 v77, v18, -v19
  v_fma_f32 v16, v29, v18, -v16
  v_fma_f32 v17, v29, v19, -v17
  v_mfma_f32_32x32x16_bf16 v[80:95], v[52:55], v[156:159], v[80:95]
  s_waitcnt lgkmcnt(6)
  ds_read_b64_tr_b16 v[48:49], v0 offset:8192
  ds_read_b64_tr_b16 v[50:51], v0 offset:9216
  v_fma_f32 v18, v29, v16, -v18
  v_fma_f32 v19, v29, v17, -v19
  v_cvt_pk_bf16_f32 v78, v16, -v17
  v_mfma_f32_32x32x16_bf16 v[80:95], v[32:35], v[160:163], v[80:95]
  s_waitcnt lgkmcnt(6)
  ds_read_b64_tr_b16 v[52:53], v0 offset:10240
  ds_read_b64_tr_b16 v[54:55], v0 offset:11264
  v_cvt_pk_bf16_f32 v79, v18, -v19
  s_nop 1
  v_mfma_f32_32x32x16_bf16 v[80:95], v[76:79], v[56:59], v[80:95]
  v_fmamk_f32 v17, v1, 0x41000000, v2
  v_fmamk_f32 v19, v1, 0x41100000, v2
  v_cos_f32 v16, v17
  v_mfma_f32_32x32x16_bf16 v[80:95], v[36:39], v[164:167], v[80:95]
  s_waitcnt lgkmcnt(6)
  ds_read_b64_tr_b16 v[32:33], v0 offset:12288
  ds_read_b64_tr_b16 v[34:35], v0 offset:13312
  v_sin_f32 v17, v17
  v_cos_f32 v18, v19
  v_mfma_f32_32x32x16_bf16 v[80:95], v[40:43], v[168:171], v[80:95]
  s_waitcnt lgkmcnt(6)
  ds_read_b64_tr_b16 v[36:37], v0 offset:14336
  ds_read_b64_tr_b16 v[38:39], v0 offset:15360
  v_sin_f32 v19, v19
  v_cvt_pk_bf16_f32 v76, v16, -v17
  v_mfma_f32_32x32x16_bf16 v[80:95], v[44:47], v[172:175], v[80:95]
  s_waitcnt lgkmcnt(6)
  ds_read_b64_tr_b16 v[40:41], v0 offset:16384
  ds_read_b64_tr_b16 v[42:43], v0 offset:17408
  v_cvt_pk_bf16_f32 v77, v18, -v19
  v_fma_f32 v16, v29, v18, -v16
  v_fma_f32 v17, v29, v19, -v17
  v_mfma_f32_32x32x16_bf16 v[80:95], v[48:51], v[176:179], v[80:95]
  s_waitcnt lgkmcnt(6)
  ds_read_b64_tr_b16 v[44:45], v0 offset:18432
  ds_read_b64_tr_b16 v[46:47], v0 offset:19456
  v_fma_f32 v18, v29, v16, -v18
  v_fma_f32 v19, v29, v17, -v19
  v_cvt_pk_bf16_f32 v78, v16, -v17
  v_mfma_f32_32x32x16_bf16 v[80:95], v[52:55], v[180:183], v[80:95]
  s_waitcnt lgkmcnt(6)
  ds_read_b64_tr_b16 v[48:49], v0 offset:20480
  ds_read_b64_tr_b16 v[50:51], v0 offset:21504
  v_cvt_pk_bf16_f32 v79, v18, -v19
  s_nop 1
  v_mfma_f32_32x32x16_bf16 v[80:95], v[76:79], v[60:63], v[80:95]
  v_fmamk_f32 v17, v1, 0x41800000, v2
  v_fmamk_f32 v19, v1, 0x41880000, v2
  v_cos_f32 v16, v17
  v_mfma_f32_32x32x16_bf16 v[80:95], v[32:35], v[184:187], v[80:95]
  s_waitcnt lgkmcnt(6)
  ds_read_b64_tr_b16 v[52:53], v0 offset:22528
  ds_read_b64_tr_b16 v[54:55], v0 offset:23552
  v_sin_f32 v17, v17
  v_mfma_f32_32x32x16_bf16 v[80:95], v[36:39], v[188:191], v[80:95]
  s_waitcnt lgkmcnt(6)
  v_cos_f32 v18, v19
  v_sin_f32 v19, v19
  v_cvt_pk_bf16_f32 v76, v16, -v17
  v_mfma_f32_32x32x16_bf16 v[80:95], v[40:43], v[192:195], v[80:95]
  s_waitcnt lgkmcnt(4)
  s_waitcnt lgkmcnt(0)
  s_barrier
  ds_read_b64_tr_b16 v[32:33], v6 offset:0
  ds_read_b64_tr_b16 v[34:35], v6 offset:1024
  ds_read_b64_tr_b16 v[36:37], v6 offset:2048
  v_cvt_pk_bf16_f32 v77, v18, -v19
  v_fma_f32 v16, v29, v18, -v16
  v_fma_f32 v17, v29, v19, -v17
  v_mfma_f32_32x32x16_bf16 v[80:95], v[44:47], v[196:199], v[80:95]
  ds_read_b64_tr_b16 v[38:39], v6 offset:3072
  ds_read_b64_tr_b16 v[40:41], v6 offset:4096
  ds_read_b64_tr_b16 v[42:43], v6 offset:5120
  v_fma_f32 v18, v29, v16, -v18
  v_fma_f32 v19, v29, v17, -v19
  v_cvt_pk_bf16_f32 v78, v16, -v17
  v_mfma_f32_32x32x16_bf16 v[80:95], v[48:51], v[200:203], v[80:95]
  ds_read_b64_tr_b16 v[44:45], v6 offset:6144
  ds_read_b64_tr_b16 v[46:47], v6 offset:7168
  v_cvt_pk_bf16_f32 v79, v18, -v19
  s_nop 1
  v_mfma_f32_32x32x16_bf16 v[80:95], v[76:79], v[64:67], v[80:95]
  v_fmamk_f32 v17, v1, 0x41c00000, v2
  v_fmamk_f32 v19, v1, 0x41c80000, v2
  v_cos_f32 v16, v17
  v_mfma_f32_32x32x16_bf16 v[80:95], v[52:55], v[204:207], v[80:95]
  s_waitcnt lgkmcnt(6)
  ds_read_b64_tr_b16 v[48:49], v6 offset:8192
  ds_read_b64_tr_b16 v[50:51], v6 offset:9216
  v_sin_f32 v17, v17
  v_mfma_f32_32x32x16_bf16 v[80:95], v[32:35], v[208:211], v[80:95]
  s_waitcnt lgkmcnt(6)
  ds_read_b64_tr_b16 v[52:53], v6 offset:10240
  ds_read_b64_tr_b16 v[54:55], v6 offset:11264
  v_cos_f32 v18, v19
  v_mfma_f32_32x32x16_bf16 v[80:95], v[36:39], v[212:215], v[80:95]
  s_waitcnt lgkmcnt(6)
  ds_read_b64_tr_b16 v[32:33], v6 offset:12288
  ds_read_b64_tr_b16 v[34:35], v6 offset:13312
  v_sin_f32 v19, v19
  v_cvt_pk_bf16_f32 v76, v16, -v17
  v_mfma_f32_32x32x16_bf16 v[80:95], v[40:43], v[216:219], v[80:95]
  s_waitcnt lgkmcnt(6)
  ds_read_b64_tr_b16 v[36:37], v6 offset:14336
  ds_read_b64_tr_b16 v[38:39], v6 offset:15360
  v_cvt_pk_bf16_f32 v77, v18, -v19
  v_fma_f32 v16, v29, v18, -v16
  v_fma_f32 v17, v29, v19, -v17
  v_mfma_f32_32x32x16_bf16 v[80:95], v[44:47], v[220:223], v[80:95]
  s_waitcnt lgkmcnt(6)
  ds_read_b64_tr_b16 v[40:41], v6 offset:16384
  ds_read_b64_tr_b16 v[42:43], v6 offset:17408
  v_fma_f32 v18, v29, v16, -v18
  v_fma_f32 v19, v29, v17, -v19
  v_cvt_pk_bf16_f32 v78, v16, -v17
  v_mfma_f32_32x32x16_bf16 v[80:95], v[48:51], v[224:227], v[80:95]
  s_waitcnt lgkmcnt(6)
  ds_read_b64_tr_b16 v[44:45], v6 offset:18432
  ds_read_b64_tr_b16 v[46:47], v6 offset:19456
  v_cvt_pk_bf16_f32 v79, v18, -v19
  s_nop 1
  v_mfma_f32_32x32x16_bf16 v[80:95], v[76:79], v[68:71], v[80:95]
  v_fmamk_f32 v17, v1, 0x42000000, v2
  v_fmamk_f32 v19, v1, 0x42040000, v2
  v_cos_f32 v16, v17
  v_mfma_f32_32x32x16_bf16 v[80:95], v[52:55], v[228:231], v[80:95]
  s_waitcnt lgkmcnt(6)
  ds_read_b64_tr_b16 v[48:49], v6 offset:20480
  ds_read_b64_tr_b16 v[50:51], v6 offset:21504
  v_sin_f32 v17, v17
  v_mfma_f32_32x32x16_bf16 v[80:95], v[32:35], v[232:235], v[80:95]
  s_waitcnt lgkmcnt(6)
  ds_read_b64_tr_b16 v[52:53], v6 offset:22528
  ds_read_b64_tr_b16 v[54:55], v6 offset:23552
  v_cos_f32 v18, v19
  v_mfma_f32_32x32x16_bf16 v[80:95], v[36:39], v[236:239], v[80:95]
  s_waitcnt lgkmcnt(6)
  v_sin_f32 v19, v19
  v_cvt_pk_bf16_f32 v76, v16, -v17
  v_cvt_pk_bf16_f32 v77, v18, -v19
  v_fma_f32 v16, v29, v18, -v16
  v_mfma_f32_32x32x16_bf16 v[80:95], v[40:43], v[240:243], v[80:95]
  s_waitcnt lgkmcnt(4)
  s_waitcnt lgkmcnt(0)
  s_waitcnt vmcnt(0)
  s_barrier
  ds_read_b64_tr_b16 v[32:33], v6 offset:24576
  ds_read_b64_tr_b16 v[34:35], v6 offset:25600
  ds_read_b64_tr_b16 v[36:37], v6 offset:26624
  s_add_u32 s63, s58, 6
  s_and_b32 s63, s63, 7
  s_lshl_b32 s63, s63, 7
  s_add_u32 s63, s63, s77
  s_mov_b64 exec, s[78:79]
  buffer_store_dword v31, v30, s[36:39], s63 offen sc1
  s_mov_b64 exec, -1
  v_fma_f32 v17, v29, v19, -v17
  v_fma_f32 v18, v29, v16, -v18
  v_mfma_f32_32x32x16_bf16 v[80:95], v[44:47], v[244:247], v[80:95]
  ds_read_b64_tr_b16 v[38:39], v6 offset:27648
  ds_read_b64_tr_b16 v[40:41], v6 offset:28672
  ds_read_b64_tr_b16 v[42:43], v6 offset:29696
  v_fma_f32 v19, v29, v17, -v19
  v_cvt_pk_bf16_f32 v78, v16, -v17
  v_mfma_f32_32x32x16_bf16 v[80:95], v[48:51], v[248:251], v[80:95]
  ds_read_b64_tr_b16 v[44:45], v6 offset:30720
  ds_read_b64_tr_b16 v[46:47], v6 offset:31744
  v_cvt_pk_bf16_f32 v79, v18, -v19
  s_nop 1
  v_mfma_f32_32x32x16_bf16 v[80:95], v[76:79], v[72:75], v[80:95]
  v_mfma_f32_32x32x16_bf16 v[80:95], v[52:55], v[252:255], v[80:95]
  s_waitcnt lgkmcnt(6)
  ds_read_b64_tr_b16 v[48:49], v6 offset:32768
  ds_read_b64_tr_b16 v[50:51], v6 offset:33792
  s_add_u32 s79, s58, 8
  s_and_b32 s79, s79, 7
  s_lshl_b32 s79, s79, 6
  v_mfma_f32_32x32x16_bf16 v[96:111], v[32:35], v[112:115], 0
  s_waitcnt lgkmcnt(6)
  s_add_u32 s62, s58, 7
  s_and_b32 s62, s62, 7
  s_lshl_b32 s62, s62, 13
  s_add_u32 s62, s62, s74
  ds_read_b64_tr_b16 v[52:53], v6 offset:34816
  ds_read_b64_tr_b16 v[54:55], v6 offset:35840
  v_mfma_f32_32x32x16_bf16 v[96:111], v[36:39], v[116:119], v[96:111]
  s_waitcnt lgkmcnt(6)
  ds_read_b64_tr_b16 v[32:33], v6 offset:36864
  ds_read_b64_tr_b16 v[34:35], v6 offset:37888
  v_cvt_pk_bf16_f32 v20, v80, v81
  v_cvt_pk_bf16_f32 v21, v82, v83
  v_cvt_pk_bf16_f32 v22, v84, v85
  v_cvt_pk_bf16_f32 v23, v86, v87
  v_mfma_f32_32x32x16_bf16 v[96:111], v[40:43], v[120:123], v[96:111]
  s_waitcnt lgkmcnt(6)
  ds_read_b64_tr_b16 v[36:37], v6 offset:38912
  ds_read_b64_tr_b16 v[38:39], v6 offset:39936
  buffer_store_dwordx4 v[20:23], v28, s[36:39], s62 offen offset:0 sc1
  v_cvt_pk_bf16_f32 v24, v88, v89
  v_cvt_pk_bf16_f32 v25, v90, v91
  v_cvt_pk_bf16_f32 v26, v92, v93
  v_mfma_f32_32x32x16_bf16 v[96:111], v[44:47], v[124:127], v[96:111]
  s_waitcnt lgkmcnt(6)
  ds_read_b64_tr_b16 v[40:41], v6 offset:40960
  ds_read_b64_tr_b16 v[42:43], v6 offset:41984
  v_cvt_pk_bf16_f32 v27, v94, v95
  v_mfma_f32_32x32x16_bf16 v[96:111], v[48:51], v[128:131], v[96:111]
  s_waitcnt lgkmcnt(6)
  ds_read_b64_tr_b16 v[44:45], v6 offset:43008
  ds_read_b64_tr_b16 v[46:47], v6 offset:44032
  buffer_store_dwordx4 v[24:27], v28, s[36:39], s62 offen offset:1024 sc1
  v_add_u32 v1, s79, v4
  v_cvt_f32_u32 v1, v1
  v_mul_f32 v1, 0x3ae38e39, v1
  v_mfma_f32_32x32x16_bf16 v[96:111], v[52:55], v[132:135], v[96:111]
  s_waitcnt lgkmcnt(6)
  ds_read_b64_tr_b16 v[48:49], v6 offset:45056
  ds_read_b64_tr_b16 v[50:51], v6 offset:46080
  v_cos_f32 v29, v1
  v_mul_f32 v2, v5, v1
  v_mfma_f32_32x32x16_bf16 v[96:111], v[32:35], v[136:139], v[96:111]
  s_waitcnt lgkmcnt(6)
  ds_read_b64_tr_b16 v[52:53], v6 offset:47104
  ds_read_b64_tr_b16 v[54:55], v6 offset:48128
  v_fract_f32 v2, v2
  v_add_f32 v29, v29, v29
  v_fmamk_f32 v17, v1, 0x00000000, v2
  v_mfma_f32_32x32x16_bf16 v[96:111], v[36:39], v[140:143], v[96:111]
  s_waitcnt lgkmcnt(6)
  v_fmamk_f32 v19, v1, 0x3f800000, v2
  v_cos_f32 v16, v17
  v_sin_f32 v17, v17
  v_mfma_f32_32x32x16_bf16 v[96:111], v[40:43], v[144:147], v[96:111]
  s_waitcnt lgkmcnt(4)
  s_waitcnt lgkmcnt(0)
  s_barrier
  ds_read_b64_tr_b16 v[32:33], v6 offset:49152
  ds_read_b64_tr_b16 v[34:35], v6 offset:50176
  ds_read_b64_tr_b16 v[36:37], v6 offset:51200
  v_cos_f32 v18, v19
  v_sin_f32 v19, v19
  v_mfma_f32_32x32x16_bf16 v[96:111], v[44:47], v[148:151], v[96:111]
  ds_read_b64_tr_b16 v[38:39], v6 offset:52224
  ds_read_b64_tr_b16 v[40:41], v6 offset:53248
  ds_read_b64_tr_b16 v[42:43], v6 offset:54272
  v_cvt_pk_bf16_f32 v76, v16, -v17
  v_cvt_pk_bf16_f32 v77, v18, -v19
  v_fma_f32 v16, v29, v18, -v16
  v_mfma_f32_32x32x16_bf16 v[96:111], v[48:51], v[152:155], v[96:111]
  ds_read_b64_tr_b16 v[44:45], v6 offset:55296
  ds_read_b64_tr_b16 v[46:47], v6 offset:56320
  v_fma_f32 v17, v29, v19, -v17
  v_fma_f32 v18, v29, v16, -v18
  v_fma_f32 v19, v29, v17, -v19
  v_mfma_f32_32x32x16_bf16 v[96:111], v[52:55], v[156:159], v[96:111]
  s_waitcnt lgkmcnt(6)
  ds_read_b64_tr_b16 v[48:49], v7 offset:0
  ds_read_b64_tr_b16 v[50:51], v7 offset:1024
  v_cvt_pk_bf16_f32 v78, v16, -v17
  v_cvt_pk_bf16_f32 v79, v18, -v19
  s_nop 1
  v_mfma_f32_32x32x16_bf16 v[96:111], v[76:79], v[56:59], v[96:111]
  v_fmamk_f32 v17, v1, 0x41000000, v2
  v_fmamk_f32 v19, v1, 0x41100000, v2
  v_cos_f32 v16, v17
  v_mfma_f32_32x32x16_bf16 v[96:111], v[32:35], v[160:163], v[96:111]
  s_waitcnt lgkmcnt(6)
  ds_read_b64_tr_b16 v[52:53], v7 offset:2048
  ds_read_b64_tr_b16 v[54:55], v7 offset:3072
  v_sin_f32 v17, v17
  v_mfma_f32_32x32x16_bf16 v[96:111], v[36:39], v[164:167], v[96:111]
  s_waitcnt lgkmcnt(6)
  ds_read_b64_tr_b16 v[32:33], v7 offset:4096
  ds_read_b64_tr_b16 v[34:35], v7 offset:5120
  v_cos_f32 v18, v19
  v_sin_f32 v19, v19
  v_mfma_f32_32x32x16_bf16 v[96:111], v[40:43], v[168:171], v[96:111]
  s_waitcnt lgkmcnt(6)
  ds_read_b64_tr_b16 v[36:37], v7 offset:6144
  ds_read_b64_tr_b16 v[38:39], v7 offset:7168
  v_cvt_pk_bf16_f32 v76, v16, -v17
  v_cvt_pk_bf16_f32 v77, v18, -v19
  v_fma_f32 v16, v29, v18, -v16
  v_mfma_f32_32x32x16_bf16 v[96:111], v[44:47], v[172:175], v[96:111]
  s_waitcnt lgkmcnt(6)
  ds_read_b64_tr_b16 v[40:41], v7 offset:8192
  ds_read_b64_tr_b16 v[42:43], v7 offset:9216
  v_fma_f32 v17, v29, v19, -v17
  v_fma_f32 v18, v29, v16, -v18
  v_fma_f32 v19, v29, v17, -v19
  v_mfma_f32_32x32x16_bf16 v[96:111], v[48:51], v[176:179], v[96:111]
  s_waitcnt lgkmcnt(6)
  ds_read_b64_tr_b16 v[44:45], v7 offset:10240
  ds_read_b64_tr_b16 v[46:47], v7 offset:11264
  v_cvt_pk_bf16_f32 v78, v16, -v17
  v_cvt_pk_bf16_f32 v79, v18, -v19
  s_nop 1
  v_mfma_f32_32x32x16_bf16 v[96:111], v[76:79], v[60:63], v[96:111]
  v_fmamk_f32 v17, v1, 0x41800000, v2
  v_fmamk_f32 v19, v1, 0x41880000, v2
  v_cos_f32 v16, v17
  v_mfma_f32_32x32x16_bf16 v[96:111], v[52:55], v[180:183], v[96:111]
  s_waitcnt lgkmcnt(6)
  ds_read_b64_tr_b16 v[48:49], v7 offset:12288
  ds_read_b64_tr_b16 v[50:51], v7 offset:13312
  v_sin_f32 v17, v17
  v_mfma_f32_32x32x16_bf16 v[96:111], v[32:35], v[184:187], v[96:111]
  s_waitcnt lgkmcnt(6)
  ds_read_b64_tr_b16 v[52:53], v7 offset:14336
  ds_read_b64_tr_b16 v[54:55], v7 offset:15360
  v_cos_f32 v18, v19
  v_mfma_f32_32x32x16_bf16 v[96:111], v[36:39], v[188:191], v[96:111]
  s_waitcnt lgkmcnt(6)
  v_sin_f32 v19, v19
  v_cvt_pk_bf16_f32 v76, v16, -v17
  v_cvt_pk_bf16_f32 v77, v18, -v19
  v_fma_f32 v16, v29, v18, -v16
  v_mfma_f32_32x32x16_bf16 v[96:111], v[40:43], v[192:195], v[96:111]
  s_waitcnt lgkmcnt(4)
  s_waitcnt lgkmcnt(0)
  s_waitcnt vmcnt(0)
  s_barrier
  ds_read_b64_tr_b16 v[32:33], v0 offset:0
  ds_read_b64_tr_b16 v[34:35], v0 offset:1024
  ds_read_b64_tr_b16 v[36:37], v0 offset:2048
  s_add_u32 s63, s58, 7
  s_and_b32 s63, s63, 7
  s_lshl_b32 s63, s63, 7
  s_add_u32 s63, s63, s77
  s_mov_b64 exec, s[78:79]
  buffer_store_dword v31, v30, s[36:39], s63 offen sc1
  s_mov_b64 exec, -1
  v_fma_f32 v17, v29, v19, -v17
  v_fma_f32 v18, v29, v16, -v18
  v_fma_f32 v19, v29, v17, -v19
  v_mfma_f32_32x32x16_bf16 v[96:111], v[44:47], v[196:199], v[96:111]
  ds_read_b64_tr_b16 v[38:39], v0 offset:3072
  ds_read_b64_tr_b16 v[40:41], v0 offset:4096
  ds_read_b64_tr_b16 v[42:43], v0 offset:5120
  v_cvt_pk_bf16_f32 v78, v16, -v17
  v_cvt_pk_bf16_f32 v79, v18, -v19
  s_nop 1
  v_mfma_f32_32x32x16_bf16 v[96:111], v[76:79], v[64:67], v[96:111]
  v_fmamk_f32 v17, v1, 0x41c00000, v2
  v_fmamk_f32 v19, v1, 0x41c80000, v2
  v_cos_f32 v16, v17
  v_mfma_f32_32x32x16_bf16 v[96:111], v[48:51], v[200:203], v[96:111]
  ds_read_b64_tr_b16 v[44:45], v0 offset:6144
  ds_read_b64_tr_b16 v[46:47], v0 offset:7168
  v_sin_f32 v17, v17
  v_mfma_f32_32x32x16_bf16 v[96:111], v[52:55], v[204:207], v[96:111]
  s_waitcnt lgkmcnt(6)
  ds_read_b64_tr_b16 v[48:49], v0 offset:8192
  ds_read_b64_tr_b16 v[50:51], v0 offset:9216
  v_cos_f32 v18, v19
  v_mfma_f32_32x32x16_bf16 v[96:111], v[32:35], v[208:211], v[96:111]
  s_waitcnt lgkmcnt(6)
  ds_read_b64_tr_b16 v[52:53], v0 offset:10240
  ds_read_b64_tr_b16 v[54:55], v0 offset:11264
  v_sin_f32 v19, v19
  v_cvt_pk_bf16_f32 v76, v16, -v17
  v_mfma_f32_32x32x16_bf16 v[96:111], v[36:39], v[212:215], v[96:111]
  s_waitcnt lgkmcnt(6)
  ds_read_b64_tr_b16 v[32:33], v0 offset:12288
  ds_read_b64_tr_b16 v[34:35], v0 offset:13312
  v_cvt_pk_bf16_f32 v77, v18, -v19
  v_fma_f32 v16, v29, v18, -v16
  v_fma_f32 v17, v29, v19, -v17
  v_mfma_f32_32x32x16_bf16 v[96:111], v[40:43], v[216:219], v[96:111]
  s_waitcnt lgkmcnt(6)
  ds_read_b64_tr_b16 v[36:37], v0 offset:14336
  ds_read_b64_tr_b16 v[38:39], v0 offset:15360
  v_fma_f32 v18, v29, v16, -v18
  v_fma_f32 v19, v29, v17, -v19
  v_cvt_pk_bf16_f32 v78, v16, -v17
  v_mfma_f32_32x32x16_bf16 v[96:111], v[44:47], v[220:223], v[96:111]
  s_waitcnt lgkmcnt(6)
  ds_read_b64_tr_b16 v[40:41], v0 offset:16384
  ds_read_b64_tr_b16 v[42:43], v0 offset:17408
  v_cvt_pk_bf16_f32 v79, v18, -v19
  s_nop 1
  v_mfma_f32_32x32x16_bf16 v[96:111], v[76:79], v[68:71], v[96:111]
  v_fmamk_f32 v17, v1, 0x42000000, v2
  v_fmamk_f32 v19, v1, 0x42040000, v2
  v_cos_f32 v16, v17
  v_mfma_f32_32x32x16_bf16 v[96:111], v[48:51], v[224:227], v[96:111]
  s_waitcnt lgkmcnt(6)
  ds_read_b64_tr_b16 v[44:45], v0 offset:18432
  ds_read_b64_tr_b16 v[46:47], v0 offset:19456
  v_sin_f32 v17, v17
  v_mfma_f32_32x32x16_bf16 v[96:111], v[52:55], v[228:231], v[96:111]
  s_waitcnt lgkmcnt(6)
  ds_read_b64_tr_b16 v[48:49], v0 offset:20480
  ds_read_b64_tr_b16 v[50:51], v0 offset:21504
  v_cos_f32 v18, v19
  v_mfma_f32_32x32x16_bf16 v[96:111], v[32:35], v[232:235], v[96:111]
  s_waitcnt lgkmcnt(6)
  ds_read_b64_tr_b16 v[52:53], v0 offset:22528
  ds_read_b64_tr_b16 v[54:55], v0 offset:23552
  v_sin_f32 v19, v19
  v_cvt_pk_bf16_f32 v76, v16, -v17
  v_mfma_f32_32x32x16_bf16 v[96:111], v[36:39], v[236:239], v[96:111]
  s_waitcnt lgkmcnt(6)
  v_cvt_pk_bf16_f32 v77, v18, -v19
  v_fma_f32 v16, v29, v18, -v16
  v_fma_f32 v17, v29, v19, -v17
  v_fma_f32 v18, v29, v16, -v18
  v_fma_f32 v19, v29, v17, -v19
  v_mfma_f32_32x32x16_bf16 v[96:111], v[40:43], v[240:243], v[96:111]
  s_waitcnt lgkmcnt(4)
  v_cvt_pk_bf16_f32 v78, v16, -v17
  v_cvt_pk_bf16_f32 v79, v18, -v19
  s_nop 1
  v_mfma_f32_32x32x16_bf16 v[96:111], v[76:79], v[72:75], v[96:111]
  v_mfma_f32_32x32x16_bf16 v[96:111], v[44:47], v[244:247], v[96:111]
  s_waitcnt lgkmcnt(2)
  v_mfma_f32_32x32x16_bf16 v[96:111], v[48:51], v[248:251], v[96:111]
  s_waitcnt lgkmcnt(0)
  v_mfma_f32_32x32x16_bf16 v[96:111], v[52:55], v[252:255], v[96:111]
  s_nop 11
  v_cvt_pk_bf16_f32 v20, v96, v97
  v_cvt_pk_bf16_f32 v21, v98, v99
  v_cvt_pk_bf16_f32 v22, v100, v101
  v_cvt_pk_bf16_f32 v23, v102, v103
  ds_write_b128 v28, v[20:23] offset:0
  v_cvt_pk_bf16_f32 v24, v104, v105
  v_cvt_pk_bf16_f32 v25, v106, v107
  v_cvt_pk_bf16_f32 v26, v108, v109
  v_cvt_pk_bf16_f32 v27, v110, v111
  ds_write_b128 v28, v[24:27] offset:1024
  s_waitcnt lgkmcnt(0)
  s_barrier
  s_endpgm
L_helper:
  s_cmp_eq_u32 s60, 1
  s_cselect_b64 s[10:11], -1, 0
  s_mul_i32 s62, s57, 7282
  s_lshr_b32 s62, s62, 16
  s_mul_i32 s62, s62, 9
  s_sub_u32 s61, s57, s62
  v_lshlrev_b32 v9, 1, v6
  v_and_b32 v9, 4, v9
  v_xor_b32 v9, v9, v7
  v_lshlrev_b32 v9, 4, v9
  v_mul_u32_u24 v10, 9216, v6
  v_add_u32 v16, v9, v10
  v_mul_u32_u24 v10, 1152, v6
  v_add_u32 v18, v9, v10
  v_add_u32 v19, 36864, v18
  s_lshl_b32 s80, s60, 10
  s_mul_i32 s81, s60, 73728
  s_mul_i32 s62, s56, 1152
  s_add_u32 s81, s81, s62
  v_and_b32 v22, 63, v0
  v_and_b32 v20, 15, v0
  v_lshrrev_b32 v21, 4, v22
  s_mul_i32 s4, s56, 36
  s_cmp_eq_u32 s56, 7
  s_cselect_b32 s62, 3, 0
  s_sub_u32 s4, s4, s62
  s_lshl_b32 s62, s56, 5
  s_add_u32 s62, s62, s57
  s_mul_i32 s62, s62, 10240
  s_add_u32 s5, s62, 65536
  s_add_u32 s6, s62, 2686976
  v_lshlrev_b32 v27, 3, v21
  v_cvt_f32_u32 v27, v27
  s_mov_b32 s65, 0x42000000
  v_and_b32 v26, 7, v20
  v_add_u32 v26, 32, v26
  v_add_u32 v23, s4, v26
  s_cmp_eq_u32 s56, 7
  s_cselect_b32 s62, 3, 0
  s_cselect_b32 s63, 37, 36
  v_mov_b32 v8, 0x35e38e39
  v_mov_b32 v9, 0x35638e39
  v_cmp_eq_u32 vcc, 0, v23
  s_nop 1
  v_cndmask_b32 v8, v8, v9, vcc
  v_cmp_eq_u32 vcc, 0x120, v23
  s_nop 1
  v_cndmask_b32 v8, v8, v9, vcc
  v_subrev_u32 v9, s62, v26
  v_cmp_gt_u32 vcc, s63, v9
  s_nop 1
  v_cndmask_b32 v8, 0, v8, vcc
  v_lshrrev_b32 v26, 3, v20
  v_cvt_f32_u32 v26, v26
  v_lshlrev_b32 v25, 31, v23
  v_cvt_f32_u32 v23, v23
  v_or_b32 v25, 1.0, v25
  v_mul_f32 v26, 0x3e800000, v26
  v_mul_f32 v23, 0x3ae38e39, v23
  v_mul_f32 v30, 0x42000000, v23
  v_cos_f32 v30, v30
  v_fma_f32 v26, v23, v27, v26
  v_add_f32 v30, v30, v30
  v_cos_f32 v28, v23
  v_add_f32 v33, v26, v23
  v_fma_f32 v40, v23, s65, v26
  v_add_f32 v41, v40, v23
  v_add_f32 v28, v28, v28
  v_cos_f32 v32, v26
  v_cos_f32 v33, v33
  v_cos_f32 v40, v40
  v_cos_f32 v41, v41
  v_mul_f32 v32, v8, v32
  v_mul_f32 v33, v8, v33
  v_mul_f32 v40, v8, v40
  v_mul_f32 v41, v8, v41
  v_fma_f32 v34, v28, v33, -v32
  v_fma_f32 v42, v28, v41, -v40
  v_fma_f32 v35, v28, v34, -v33
  v_fma_f32 v43, v28, v42, -v41
  v_fma_f32 v36, v28, v35, -v34
  v_fma_f32 v44, v28, v43, -v42
  v_fma_f32 v37, v28, v36, -v35
  v_fma_f32 v45, v28, v44, -v43
  v_fma_f32 v38, v28, v37, -v36
  v_fma_f32 v46, v28, v45, -v44
  v_fma_f32 v39, v28, v38, -v37
  v_fma_f32 v47, v28, v46, -v45
  v_sub_f32 v31, 0, v30
  v_cvt_pk_bf16_f32 v220, v32, v33
  v_cvt_pk_bf16_f32 v221, v34, v35
  v_cvt_pk_bf16_f32 v222, v36, v37
  v_cvt_pk_bf16_f32 v223, v38, v39
  v_cvt_pk_bf16_f32 v224, v40, v41
  v_cvt_pk_bf16_f32 v225, v42, v43
  v_cvt_pk_bf16_f32 v226, v44, v45
  v_cvt_pk_bf16_f32 v227, v46, v47
  v_fmac_f32 v32, v31, v40
  v_fmac_f32 v33, v31, v41
  v_fmac_f32 v34, v31, v42
  v_fmac_f32 v35, v31, v43
  v_fmac_f32 v36, v31, v44
  v_fmac_f32 v37, v31, v45
  v_fmac_f32 v38, v31, v46
  v_fmac_f32 v39, v31, v47
  v_cvt_pk_bf16_f32 v228, -v32, -v33
  v_cvt_pk_bf16_f32 v229, -v34, -v35
  v_cvt_pk_bf16_f32 v230, -v36, -v37
  v_cvt_pk_bf16_f32 v231, -v38, -v39
  v_fmac_f32 v40, v30, v32
  v_fmac_f32 v41, v30, v33
  v_fmac_f32 v42, v30, v34
  v_fmac_f32 v43, v30, v35
  v_fmac_f32 v44, v30, v36
  v_fmac_f32 v45, v30, v37
  v_fmac_f32 v46, v30, v38
  v_fmac_f32 v47, v30, v39
  v_cvt_pk_bf16_f32 v232, -v40, -v41
  v_cvt_pk_bf16_f32 v233, -v42, -v43
  v_cvt_pk_bf16_f32 v234, -v44, -v45
  v_cvt_pk_bf16_f32 v235, -v46, -v47
  v_fmac_f32 v32, v31, v40
  v_fmac_f32 v33, v31, v41
  v_fmac_f32 v34, v31, v42
  v_fmac_f32 v35, v31, v43
  v_fmac_f32 v36, v31, v44
  v_fmac_f32 v37, v31, v45
  v_fmac_f32 v38, v31, v46
  v_fmac_f32 v39, v31, v47
  v_cvt_pk_bf16_f32 v236, v32, v33
  v_cvt_pk_bf16_f32 v237, v34, v35
  v_cvt_pk_bf16_f32 v238, v36, v37
  v_cvt_pk_bf16_f32 v239, v38, v39
  v_fmac_f32 v40, v30, v32
  v_fmac_f32 v41, v30, v33
  v_fmac_f32 v42, v30, v34
  v_fmac_f32 v43, v30, v35
  v_fmac_f32 v44, v30, v36
  v_fmac_f32 v45, v30, v37
  v_fmac_f32 v46, v30, v38
  v_fmac_f32 v47, v30, v39
  v_cvt_pk_bf16_f32 v240, v40, v41
  v_cvt_pk_bf16_f32 v241, v42, v43
  v_cvt_pk_bf16_f32 v242, v44, v45
  v_cvt_pk_bf16_f32 v243, v46, v47
  v_fmac_f32 v32, v31, v40
  v_fmac_f32 v33, v31, v41
  v_fmac_f32 v34, v31, v42
  v_fmac_f32 v35, v31, v43
  v_fmac_f32 v36, v31, v44
  v_fmac_f32 v37, v31, v45
  v_fmac_f32 v38, v31, v46
  v_fmac_f32 v39, v31, v47
  v_cvt_pk_bf16_f32 v244, -v32, -v33
  v_cvt_pk_bf16_f32 v245, -v34, -v35
  v_cvt_pk_bf16_f32 v246, -v36, -v37
  v_cvt_pk_bf16_f32 v247, -v38, -v39
  v_fmac_f32 v40, v30, v32
  v_fmac_f32 v41, v30, v33
  v_fmac_f32 v42, v30, v34
  v_fmac_f32 v43, v30, v35
  v_fmac_f32 v44, v30, v36
  v_fmac_f32 v45, v30, v37
  v_fmac_f32 v46, v30, v38
  v_fmac_f32 v47, v30, v39
  v_cvt_pk_bf16_f32 v248, -v40, -v41
  v_cvt_pk_bf16_f32 v249, -v42, -v43
  v_cvt_pk_bf16_f32 v250, -v44, -v45
  v_cvt_pk_bf16_f32 v251, -v46, -v47
  v_fmac_f32 v32, v31, v40
  v_fmac_f32 v33, v31, v41
  v_fmac_f32 v34, v31, v42
  v_fmac_f32 v35, v31, v43
  v_fmac_f32 v36, v31, v44
  v_fmac_f32 v37, v31, v45
  v_fmac_f32 v38, v31, v46
  v_fmac_f32 v39, v31, v47
  v_cvt_pk_bf16_f32 v252, v32, v33
  v_cvt_pk_bf16_f32 v253, v34, v35
  v_cvt_pk_bf16_f32 v254, v36, v37
  v_cvt_pk_bf16_f32 v255, v38, v39
  s_lshr_b32 s62, s60, 1
  s_lshl_b32 s62, s62, 11
  s_and_b32 s63, s60, 1
  s_lshl_b32 s63, s63, 8
  s_add_u32 s62, s62, s63
  v_add_u32 v23, 0, v21
  v_xor_b32 v23, v23, v20
  v_lshlrev_b32 v23, 4, v23
  v_lshl_add_u32 v28, v21, 9, v23
  v_add_u32 v28, s62, v28
  v_add_u32 v30, 57344, v28
  v_add_u32 v23, 4, v21
  v_xor_b32 v23, v23, v20
  v_lshlrev_b32 v23, 4, v23
  v_lshl_add_u32 v29, v21, 9, v23
  v_add_u32 v29, s62, v29
  v_add_u32 v31, 57344, v29
  v_lshrrev_b32 v4, 3, v22
  v_mul_u32_u24 v26, 36992, v4
  v_bfe_u32 v4, v22, 2, 1
  v_mul_u32_u24 v4, 578, v4
  v_add_u32 v26, v26, v4
  v_and_b32 v4, 3, v22
  v_lshl_add_u32 v26, v4, 4, v26
  v_lshrrev_b32 v4, 1, v22
  v_mul_u32_u24 v27, 36992, v4
  v_and_b32 v4, 1, v22
  v_mul_u32_u24 v4, 578, v4
  v_add3_u32 v27, v27, v4, 64
  s_mul_i32 s14, s56, 72
  s_cmp_eq_u32 s56, 7
  s_cselect_b32 s62, 6, 0
  s_sub_u32 s14, s14, s62
  s_mul_i32 s62, s57, 1156
  s_add_u32 s14, s14, s62
  s_mul_i32 s62, s60, 295936
  s_add_u32 s14, s14, s62
  s_lshl_b32 s15, s60, 8
  s_lshl_b32 s12, s57, 2
  s_add_u32 s12, s12, s60
  s_mul_i32 s12, s12, 5184
  s_mul_i32 s62, s56, 663552
  s_add_u32 s12, s12, s62
  s_lshr_b32 s62, s59, 2
  s_lshl_b32 s62, s62, 11
  s_lshl_b32 s63, s60, 7
  s_add_u32 s62, s62, s63
  v_xor_b32 v158, v6, v7
  v_lshlrev_b32 v158, 4, v158
  v_and_b32 v150, 3, v7
  v_lshl_add_u32 v158, v150, 9, v158
  v_lshrrev_b32 v150, 2, v7
  v_lshl_add_u32 v158, v150, 12, v158
  v_add_u32 v158, s62, v158
  v_add_u32 v159, 8192, v158
  s_waitcnt vmcnt(8)
  v_dot2_f32_bf16 v148, v112, s70, 0
  v_dot2_f32_bf16 v149, v112, v112, 0
  v_dot2_f32_bf16 v148, v113, s70, v148
  v_dot2_f32_bf16 v149, v113, v113, v149
  v_dot2_f32_bf16 v148, v114, s70, v148
  v_dot2_f32_bf16 v149, v114, v114, v149
  v_dot2_f32_bf16 v148, v115, s70, v148
  v_dot2_f32_bf16 v149, v115, v115, v149
  s_waitcnt vmcnt(7)
  v_dot2_f32_bf16 v148, v116, s70, v148
  v_dot2_f32_bf16 v149, v116, v116, v149
  v_dot2_f32_bf16 v148, v117, s70, v148
  v_dot2_f32_bf16 v149, v117, v117, v149
  v_dot2_f32_bf16 v148, v118, s70, v148
  v_dot2_f32_bf16 v149, v118, v118, v149
  v_dot2_f32_bf16 v148, v119, s70, v148
  v_dot2_f32_bf16 v149, v119, v119, v149
  s_waitcnt vmcnt(6)
  v_dot2_f32_bf16 v148, v120, s70, v148
  v_dot2_f32_bf16 v149, v120, v120, v149
  v_dot2_f32_bf16 v148, v121, s70, v148
  v_dot2_f32_bf16 v149, v121, v121, v149
  v_dot2_f32_bf16 v148, v122, s70, v148
  v_dot2_f32_bf16 v149, v122, v122, v149
  v_dot2_f32_bf16 v148, v123, s70, v148
  v_dot2_f32_bf16 v149, v123, v123, v149
  s_waitcnt vmcnt(5)
  v_dot2_f32_bf16 v148, v124, s70, v148
  v_dot2_f32_bf16 v149, v124, v124, v149
  v_dot2_f32_bf16 v148, v125, s70, v148
  v_dot2_f32_bf16 v149, v125, v125, v149
  v_dot2_f32_bf16 v148, v126, s70, v148
  v_dot2_f32_bf16 v149, v126, v126, v149
  v_dot2_f32_bf16 v148, v127, s70, v148
  v_dot2_f32_bf16 v149, v127, v127, v149
  s_waitcnt vmcnt(4)
  v_dot2_f32_bf16 v148, v128, s70, v148
  v_dot2_f32_bf16 v149, v128, v128, v149
  v_dot2_f32_bf16 v148, v129, s70, v148
  v_dot2_f32_bf16 v149, v129, v129, v149
  v_dot2_f32_bf16 v148, v130, s70, v148
  v_dot2_f32_bf16 v149, v130, v130, v149
  v_dot2_f32_bf16 v148, v131, s70, v148
  v_dot2_f32_bf16 v149, v131, v131, v149
  s_waitcnt vmcnt(3)
  v_dot2_f32_bf16 v148, v132, s70, v148
  v_dot2_f32_bf16 v149, v132, v132, v149
  v_dot2_f32_bf16 v148, v133, s70, v148
  v_dot2_f32_bf16 v149, v133, v133, v149
  v_dot2_f32_bf16 v148, v134, s70, v148
  v_dot2_f32_bf16 v149, v134, v134, v149
  v_dot2_f32_bf16 v148, v135, s70, v148
  v_dot2_f32_bf16 v149, v135, v135, v149
  s_waitcnt vmcnt(2)
  v_dot2_f32_bf16 v148, v136, s70, v148
  v_dot2_f32_bf16 v149, v136, v136, v149
  v_dot2_f32_bf16 v148, v137, s70, v148
  v_dot2_f32_bf16 v149, v137, v137, v149
  v_dot2_f32_bf16 v148, v138, s70, v148
  v_dot2_f32_bf16 v149, v138, v138, v149
  v_dot2_f32_bf16 v148, v139, s70, v148
  v_dot2_f32_bf16 v149, v139, v139, v149
  s_waitcnt vmcnt(1)
  v_dot2_f32_bf16 v148, v140, s70, v148
  v_dot2_f32_bf16 v149, v140, v140, v149
  v_dot2_f32_bf16 v148, v141, s70, v148
  v_dot2_f32_bf16 v149, v141, v141, v149
  v_dot2_f32_bf16 v148, v142, s70, v148
  v_dot2_f32_bf16 v149, v142, v142, v149
  v_dot2_f32_bf16 v148, v143, s70, v148
  v_dot2_f32_bf16 v149, v143, v143, v149
  s_waitcnt vmcnt(0)
  v_dot2_f32_bf16 v148, v144, s70, v148
  v_dot2_f32_bf16 v149, v144, v144, v149
  v_dot2_f32_bf16 v148, v145, s70, v148
  v_dot2_f32_bf16 v149, v145, v145, v149
  v_dot2_f32_bf16 v148, v146, s70, v148
  v_dot2_f32_bf16 v149, v146, v146, v149
  v_dot2_f32_bf16 v148, v147, s70, v148
  v_dot2_f32_bf16 v149, v147, v147, v149
  s_add_u32 s82, s61, 0
  s_cmp_ge_u32 s82, 9
  s_cselect_b32 s7, 9, 0
  s_sub_u32 s82, s82, s7
  s_lshl_b32 s82, s82, 7
  s_add_u32 s82, s82, s81
  s_add_u32 m0, s80, 73728
  s_add_u32 s7, s82, 0
  buffer_load_dwordx4 v16, s[28:31], s7 offen lds
  s_add_u32 m0, s80, 77824
  s_add_u32 s7, s82, 294912
  buffer_load_dwordx4 v16, s[28:31], s7 offen lds
  s_add_u32 m0, s80, 81920
  s_add_u32 s7, s82, 589824
  buffer_load_dwordx4 v16, s[28:31], s7 offen lds
  s_add_u32 m0, s80, 86016
  s_add_u32 s7, s82, 884736
  buffer_load_dwordx4 v16, s[28:31], s7 offen lds
  s_add_u32 m0, s80, 90112
  s_add_u32 s7, s82, 1179648
  buffer_load_dwordx4 v16, s[28:31], s7 offen lds
  s_add_u32 m0, s80, 94208
  s_add_u32 s7, s82, 1474560
  buffer_load_dwordx4 v16, s[28:31], s7 offen lds
  v_add_f32_dpp v148, v148, v148 quad_perm:[1,0,3,2] row_mask:0xf bank_mask:0xf
  v_add_f32_dpp v149, v149, v149 quad_perm:[1,0,3,2] row_mask:0xf bank_mask:0xf
  s_nop 0
  v_add_f32_dpp v148, v148, v148 quad_perm:[2,3,0,1] row_mask:0xf bank_mask:0xf
  v_add_f32_dpp v149, v149, v149 quad_perm:[2,3,0,1] row_mask:0xf bank_mask:0xf
  s_nop 0
  v_add_f32_dpp v148, v148, v148 row_half_mirror row_mask:0xf bank_mask:0xf
  v_add_f32_dpp v149, v149, v149 row_half_mirror row_mask:0xf bank_mask:0xf
  v_mul_f32 v148, 0x3ae38e39, v148
  v_mul_f32 v149, 0x3ae38e39, v149
  v_fma_f32 v149, -v148, v148, v149
  v_max_f32 v149, 0, v149
  v_add_f32 v149, 0x3727c5ac, v149
  v_rsq_f32 v149, v149
  s_nop 0
  v_mul_f32 v149, 0x3fb8aa3b, v149
  v_cvt_pk_bf16_f32 v149, v149, 0
  v_lshlrev_b32 v160, 16, v149
  v_mul_f32 v148, -v148, v160
  v_dot2_f32_bf16 v150, v112, v149, v148
  v_dot2_f32_bf16 v151, v112, v160, v148
  v_dot2_f32_bf16 v152, v113, v149, v148
  v_dot2_f32_bf16 v153, v113, v160, v148
  v_dot2_f32_bf16 v154, v114, v149, v148
  v_dot2_f32_bf16 v155, v114, v160, v148
  v_dot2_f32_bf16 v156, v115, v149, v148
  v_dot2_f32_bf16 v157, v115, v160, v148
  v_cvt_pk_bf16_f32 v112, v150, v151
  v_cvt_pk_bf16_f32 v113, v152, v153
  v_cvt_pk_bf16_f32 v114, v154, v155
  v_cvt_pk_bf16_f32 v115, v156, v157
  ds_write_b128 v158, v[112:115] offset:0
  v_dot2_f32_bf16 v150, v116, v149, v148
  v_dot2_f32_bf16 v151, v116, v160, v148
  v_dot2_f32_bf16 v152, v117, v149, v148
  v_dot2_f32_bf16 v153, v117, v160, v148
  v_dot2_f32_bf16 v154, v118, v149, v148
  v_dot2_f32_bf16 v155, v118, v160, v148
  v_dot2_f32_bf16 v156, v119, v149, v148
  v_dot2_f32_bf16 v157, v119, v160, v148
  v_cvt_pk_bf16_f32 v116, v150, v151
  v_cvt_pk_bf16_f32 v117, v152, v153
  v_cvt_pk_bf16_f32 v118, v154, v155
  v_cvt_pk_bf16_f32 v119, v156, v157
  ds_write_b128 v158, v[116:119] offset:8192
  v_dot2_f32_bf16 v150, v120, v149, v148
  v_dot2_f32_bf16 v151, v120, v160, v148
  v_dot2_f32_bf16 v152, v121, v149, v148
  v_dot2_f32_bf16 v153, v121, v160, v148
  v_dot2_f32_bf16 v154, v122, v149, v148
  v_dot2_f32_bf16 v155, v122, v160, v148
  v_dot2_f32_bf16 v156, v123, v149, v148
  v_dot2_f32_bf16 v157, v123, v160, v148
  v_cvt_pk_bf16_f32 v120, v150, v151
  v_cvt_pk_bf16_f32 v121, v152, v153
  v_cvt_pk_bf16_f32 v122, v154, v155
  v_cvt_pk_bf16_f32 v123, v156, v157
  ds_write_b128 v158, v[120:123] offset:16384
  v_dot2_f32_bf16 v150, v124, v149, v148
  v_dot2_f32_bf16 v151, v124, v160, v148
  v_dot2_f32_bf16 v152, v125, v149, v148
  v_dot2_f32_bf16 v153, v125, v160, v148
  v_dot2_f32_bf16 v154, v126, v149, v148
  v_dot2_f32_bf16 v155, v126, v160, v148
  v_dot2_f32_bf16 v156, v127, v149, v148
  v_dot2_f32_bf16 v157, v127, v160, v148
  v_cvt_pk_bf16_f32 v124, v150, v151
  v_cvt_pk_bf16_f32 v125, v152, v153
  v_cvt_pk_bf16_f32 v126, v154, v155
  v_cvt_pk_bf16_f32 v127, v156, v157
  ds_write_b128 v158, v[124:127] offset:24576
  v_dot2_f32_bf16 v150, v128, v149, v148
  v_dot2_f32_bf16 v151, v128, v160, v148
  v_dot2_f32_bf16 v152, v129, v149, v148
  v_dot2_f32_bf16 v153, v129, v160, v148
  v_dot2_f32_bf16 v154, v130, v149, v148
  v_dot2_f32_bf16 v155, v130, v160, v148
  v_dot2_f32_bf16 v156, v131, v149, v148
  v_dot2_f32_bf16 v157, v131, v160, v148
  v_cvt_pk_bf16_f32 v128, v150, v151
  v_cvt_pk_bf16_f32 v129, v152, v153
  v_cvt_pk_bf16_f32 v130, v154, v155
  v_cvt_pk_bf16_f32 v131, v156, v157
  ds_write_b128 v158, v[128:131] offset:32768
  v_dot2_f32_bf16 v150, v132, v149, v148
  v_dot2_f32_bf16 v151, v132, v160, v148
  v_dot2_f32_bf16 v152, v133, v149, v148
  v_dot2_f32_bf16 v153, v133, v160, v148
  v_dot2_f32_bf16 v154, v134, v149, v148
  v_dot2_f32_bf16 v155, v134, v160, v148
  v_dot2_f32_bf16 v156, v135, v149, v148
  v_dot2_f32_bf16 v157, v135, v160, v148
  v_cvt_pk_bf16_f32 v132, v150, v151
  v_cvt_pk_bf16_f32 v133, v152, v153
  v_cvt_pk_bf16_f32 v134, v154, v155
  v_cvt_pk_bf16_f32 v135, v156, v157
  ds_write_b128 v158, v[132:135] offset:40960
  v_dot2_f32_bf16 v150, v136, v149, v148
  v_dot2_f32_bf16 v151, v136, v160, v148
  v_dot2_f32_bf16 v152, v137, v149, v148
  v_dot2_f32_bf16 v153, v137, v160, v148
  v_dot2_f32_bf16 v154, v138, v149, v148
  v_dot2_f32_bf16 v155, v138, v160, v148
  v_dot2_f32_bf16 v156, v139, v149, v148
  v_dot2_f32_bf16 v157, v139, v160, v148
  v_cvt_pk_bf16_f32 v136, v150, v151
  v_cvt_pk_bf16_f32 v137, v152, v153
  v_cvt_pk_bf16_f32 v138, v154, v155
  v_cvt_pk_bf16_f32 v139, v156, v157
  ds_write_b128 v158, v[136:139] offset:49152
  v_dot2_f32_bf16 v150, v140, v149, v148
  v_dot2_f32_bf16 v151, v140, v160, v148
  v_dot2_f32_bf16 v152, v141, v149, v148
  v_dot2_f32_bf16 v153, v141, v160, v148
  v_dot2_f32_bf16 v154, v142, v149, v148
  v_dot2_f32_bf16 v155, v142, v160, v148
  v_dot2_f32_bf16 v156, v143, v149, v148
  v_dot2_f32_bf16 v157, v143, v160, v148
  v_cvt_pk_bf16_f32 v140, v150, v151
  v_cvt_pk_bf16_f32 v141, v152, v153
  v_cvt_pk_bf16_f32 v142, v154, v155
  v_cvt_pk_bf16_f32 v143, v156, v157
  ds_write_b128 v158, v[140:143] offset:57344
  v_dot2_f32_bf16 v150, v144, v149, v148
  v_dot2_f32_bf16 v151, v144, v160, v148
  v_dot2_f32_bf16 v152, v145, v149, v148
  v_dot2_f32_bf16 v153, v145, v160, v148
  v_dot2_f32_bf16 v154, v146, v149, v148
  v_dot2_f32_bf16 v155, v146, v160, v148
  v_dot2_f32_bf16 v156, v147, v149, v148
  v_dot2_f32_bf16 v157, v147, v160, v148
  v_cvt_pk_bf16_f32 v144, v150, v151
  v_cvt_pk_bf16_f32 v145, v152, v153
  v_cvt_pk_bf16_f32 v146, v154, v155
  v_cvt_pk_bf16_f32 v147, v156, v157
  ds_write_b128 v159, v[144:147] offset:57344
  s_setprio 1
  s_waitcnt lgkmcnt(0)
  s_barrier
  ds_read_b128 v[32:35], v28 offset:0
  ds_read_b128 v[36:39], v29 offset:4096
  ds_read_b128 v[40:43], v28 offset:8192
  ds_read_b128 v[44:47], v29 offset:12288
  ds_read_b128 v[48:51], v28 offset:16384
  v_lshlrev_b32 v23, 4, v22
  s_lshr_b32 s62, s60, 1
  s_lshl_b32 s62, s62, 10
  s_and_b32 s63, s60, 1
  s_lshl_b32 s63, s63, 3
  s_add_u32 s62, s62, s63
  s_add_u32 s62, s62, 155648
  v_add_u32 v23, s62, v23
  s_waitcnt lgkmcnt(4)
  v_mfma_f32_16x16x32_bf16 v[56:59], v[32:35], v[220:223], 0
  ds_read_b128 v[52:55], v29 offset:20480
  s_waitcnt lgkmcnt(4)
  v_mfma_f32_16x16x32_bf16 v[56:59], v[36:39], v[224:227], v[56:59]
  ds_read_b128 v[32:35], v28 offset:24576
  s_waitcnt lgkmcnt(4)
  v_mfma_f32_16x16x32_bf16 v[56:59], v[40:43], v[228:231], v[56:59]
  ds_read_b128 v[36:39], v29 offset:28672
  s_waitcnt lgkmcnt(4)
  v_mfma_f32_16x16x32_bf16 v[56:59], v[44:47], v[232:235], v[56:59]
  ds_read_b128 v[40:43], v28 offset:32768
  s_waitcnt lgkmcnt(4)
  v_mfma_f32_16x16x32_bf16 v[56:59], v[48:51], v[236:239], v[56:59]
  ds_read_b128 v[44:47], v29 offset:36864
  s_waitcnt lgkmcnt(4)
  v_mfma_f32_16x16x32_bf16 v[56:59], v[52:55], v[240:243], v[56:59]
  ds_read_b128 v[48:51], v28 offset:40960
  s_waitcnt lgkmcnt(4)
  v_mfma_f32_16x16x32_bf16 v[56:59], v[32:35], v[244:247], v[56:59]
  ds_read_b128 v[52:55], v29 offset:45056
  s_waitcnt lgkmcnt(4)
  v_mfma_f32_16x16x32_bf16 v[56:59], v[36:39], v[248:251], v[56:59]
  ds_read_b128 v[32:35], v28 offset:49152
  s_waitcnt lgkmcnt(4)
  v_mfma_f32_16x16x32_bf16 v[56:59], v[40:43], v[252:255], v[56:59]
  ds_read_b128 v[36:39], v29 offset:53248
  s_waitcnt lgkmcnt(4)
  v_mfma_f32_16x16x32_bf16 v[60:63], v[44:47], v[220:223], 0
  ds_read_b128 v[40:43], v30 offset:0
  s_waitcnt lgkmcnt(4)
  v_mfma_f32_16x16x32_bf16 v[60:63], v[48:51], v[224:227], v[60:63]
  ds_read_b128 v[44:47], v31 offset:4096
  s_waitcnt lgkmcnt(4)
  v_mfma_f32_16x16x32_bf16 v[60:63], v[52:55], v[228:231], v[60:63]
  ds_read_b128 v[48:51], v30 offset:8192
  s_waitcnt lgkmcnt(4)
  v_mfma_f32_16x16x32_bf16 v[60:63], v[32:35], v[232:235], v[60:63]
  ds_read_b128 v[52:55], v31 offset:12288
  s_waitcnt lgkmcnt(4)
  v_mfma_f32_16x16x32_bf16 v[60:63], v[36:39], v[236:239], v[60:63]
  s_waitcnt lgkmcnt(3)
  v_mfma_f32_16x16x32_bf16 v[60:63], v[40:43], v[240:243], v[60:63]
  s_waitcnt lgkmcnt(2)
  v_mfma_f32_16x16x32_bf16 v[60:63], v[44:47], v[244:247], v[60:63]
  s_waitcnt lgkmcnt(1)
  v_mfma_f32_16x16x32_bf16 v[60:63], v[48:51], v[248:251], v[60:63]
  s_waitcnt lgkmcnt(0)
  v_mfma_f32_16x16x32_bf16 v[60:63], v[52:55], v[252:255], v[60:63]
  s_nop 7
  v_fmac_f32 v56, v25, v60
  v_fmac_f32 v57, v25, v61
  v_fmac_f32 v58, v25, v62
  v_fmac_f32 v59, v25, v63
  v_cvt_pk_bf16_f32 v32, v56, v57
  v_cvt_pk_bf16_f32 v33, v58, v59
  ds_write_b64 v23, v[32:33]
  s_lshl_b32 s62, s60, 4
  v_add_u32 v23, s62, v20
  v_cvt_f32_u32 v23, v23
  v_lshlrev_b32 v24, 7, v21
  v_add_u32 v24, s57, v24
  v_cvt_f32_u32 v24, v24
  v_mul_f32 v24, v24, v23
  v_mul_f32 v24, 0x3a000000, v24
  v_mul_f32 v25, 0x3c800000, v23
  v_fmamk_f32 v52, v25, 0x00000000, v24
  v_fmamk_f32 v53, v25, 0x3f800000, v24
  v_cos_f32 v56, v52
  v_cos_f32 v57, v53
  v_sin_f32 v58, v52
  v_sin_f32 v59, v53
  v_cvt_pk_bf16_f32 v28, v56, v57
  v_cvt_pk_bf16_f32 v36, v58, v59
  v_xor_b32 v44, 0x80008000, v36
  v_fmamk_f32 v52, v25, 0x40000000, v24
  v_fmamk_f32 v53, v25, 0x40400000, v24
  v_cos_f32 v56, v52
  v_cos_f32 v57, v53
  v_sin_f32 v58, v52
  v_sin_f32 v59, v53
  v_cvt_pk_bf16_f32 v29, v56, v57
  v_cvt_pk_bf16_f32 v37, v58, v59
  v_xor_b32 v45, 0x80008000, v37
  v_fmamk_f32 v52, v25, 0x41800000, v24
  v_fmamk_f32 v53, v25, 0x41880000, v24
  v_cos_f32 v56, v52
  v_cos_f32 v57, v53
  v_sin_f32 v58, v52
  v_sin_f32 v59, v53
  v_cvt_pk_bf16_f32 v30, v56, v57
  v_cvt_pk_bf16_f32 v38, v58, v59
  v_xor_b32 v46, 0x80008000, v38
  v_fmamk_f32 v52, v25, 0x41900000, v24
  v_fmamk_f32 v53, v25, 0x41980000, v24
  v_cos_f32 v56, v52
  v_cos_f32 v57, v53
  v_sin_f32 v58, v52
  v_sin_f32 v59, v53
  v_cvt_pk_bf16_f32 v31, v56, v57
  v_cvt_pk_bf16_f32 v39, v58, v59
  v_xor_b32 v47, 0x80008000, v39
  v_fmamk_f32 v52, v25, 0x42000000, v24
  v_fmamk_f32 v53, v25, 0x42040000, v24
  v_cos_f32 v56, v52
  v_cos_f32 v57, v53
  v_sin_f32 v58, v52
  v_sin_f32 v59, v53
  v_cvt_pk_bf16_f32 v32, v56, v57
  v_cvt_pk_bf16_f32 v40, v58, v59
  v_xor_b32 v48, 0x80008000, v40
  v_fmamk_f32 v52, v25, 0x42080000, v24
  v_fmamk_f32 v53, v25, 0x420c0000, v24
  v_cos_f32 v56, v52
  v_cos_f32 v57, v53
  v_sin_f32 v58, v52
  v_sin_f32 v59, v53
  v_cvt_pk_bf16_f32 v33, v56, v57
  v_cvt_pk_bf16_f32 v41, v58, v59
  v_xor_b32 v49, 0x80008000, v41
  v_fmamk_f32 v52, v25, 0x42400000, v24
  v_fmamk_f32 v53, v25, 0x42440000, v24
  v_cos_f32 v56, v52
  v_cos_f32 v57, v53
  v_sin_f32 v58, v52
  v_sin_f32 v59, v53
  v_cvt_pk_bf16_f32 v34, v56, v57
  v_cvt_pk_bf16_f32 v42, v58, v59
  v_xor_b32 v50, 0x80008000, v42
  v_fmamk_f32 v52, v25, 0x42480000, v24
  v_fmamk_f32 v53, v25, 0x424c0000, v24
  v_cos_f32 v56, v52
  v_cos_f32 v57, v53
  v_sin_f32 v58, v52
  v_sin_f32 v59, v53
  v_cvt_pk_bf16_f32 v35, v56, v57
  v_cvt_pk_bf16_f32 v43, v58, v59
  v_xor_b32 v51, 0x80008000, v43
  s_add_u32 m0, s80, 98304
  s_add_u32 s7, s82, 1769472
  buffer_load_dwordx4 v16, s[28:31], s7 offen lds
  s_add_u32 m0, s80, 102400
  s_add_u32 s7, s82, 2064384
  buffer_load_dwordx4 v16, s[28:31], s7 offen lds
  s_add_u32 m0, s80, 106496
  s_add_u32 s7, s82, 2359296
  buffer_load_dwordx4 v16, s[28:31], s7 offen lds
  s_add_u32 m0, s80, 110592
  s_add_u32 s7, s82, 2654208
  buffer_load_dwordx4 v16, s[28:31], s7 offen lds
  s_add_u32 m0, s80, 114688
  s_add_u32 s7, s82, 2949120
  buffer_load_dwordx4 v16, s[28:31], s7 offen lds
  s_add_u32 m0, s80, 118784
  s_add_u32 s7, s82, 3244032
  buffer_load_dwordx4 v16, s[28:31], s7 offen lds
  s_add_u32 m0, s80, 122880
  s_add_u32 s7, s82, 3538944
  buffer_load_dwordx4 v16, s[28:31], s7 offen lds
  s_add_u32 m0, s80, 126976
  s_add_u32 s7, s82, 3833856
  buffer_load_dwordx4 v16, s[28:31], s7 offen lds
  s_add_u32 m0, s80, 131072
  s_add_u32 s7, s82, 4128768
  buffer_load_dwordx4 v16, s[28:31], s7 offen lds
  s_add_u32 m0, s80, 135168
  s_add_u32 s7, s82, 4423680
  buffer_load_dwordx4 v16, s[28:31], s7 offen lds
  s_add_u32 m0, s80, 139264
  s_add_u32 s7, s82, 4718592
  buffer_load_dwordx4 v16, s[28:31], s7 offen lds
  s_add_u32 m0, s80, 143360
  s_add_u32 s7, s82, 5013504
  buffer_load_dwordx4 v16, s[28:31], s7 offen lds
  s_waitcnt lgkmcnt(0)
  s_waitcnt vmcnt(12)
  s_barrier
  v_lshlrev_b32 v24, 4, v22
  v_add_u32 v24, 147456, v24
  v_xor_b32 v25, 128, v24
  v_and_b32 v23, 8, v22
  v_mul_u32_u24 v23, 0x1000, v23
  v_lshl_add_u32 v23, v23, 16, v23
  ds_read_b128 v[52:55], v24 offset:0
  ds_read_b128 v[56:59], v24 offset:1024
  ds_read_b128 v[60:63], v24 offset:2048
  ds_read_b128 v[64:67], v24 offset:3072
  ds_read_b128 v[68:71], v24 offset:4096
  ds_read_b128 v[72:75], v24 offset:5120
  ds_read_b128 v[76:79], v24 offset:6144
  ds_read_b128 v[80:83], v24 offset:7168
  ds_read_b128 v[84:87], v24 offset:8192
  ds_read_b128 v[88:91], v24 offset:9216
  ds_read_b128 v[92:95], v25 offset:8192
  ds_read_b128 v[96:99], v25 offset:9216
  s_waitcnt lgkmcnt(8)
  v_mfma_f32_16x16x32_bf16 v[100:103], v[52:55], v[28:31], 0
  v_mfma_f32_16x16x32_bf16 v[104:107], v[60:63], v[28:31], 0
  v_mfma_f32_16x16x32_bf16 v[100:103], v[60:63], v[36:39], v[100:103]
  v_mfma_f32_16x16x32_bf16 v[104:107], v[52:55], v[44:47], v[104:107]
  v_mfma_f32_16x16x32_bf16 v[100:103], v[56:59], v[32:35], v[100:103]
  v_mfma_f32_16x16x32_bf16 v[104:107], v[64:67], v[32:35], v[104:107]
  v_mfma_f32_16x16x32_bf16 v[100:103], v[64:67], v[40:43], v[100:103]
  v_mfma_f32_16x16x32_bf16 v[104:107], v[56:59], v[48:51], v[104:107]
  s_waitcnt lgkmcnt(4)
  v_mfma_f32_16x16x32_bf16 v[108:111], v[68:71], v[28:31], 0
  v_mfma_f32_16x16x32_bf16 v[112:115], v[76:79], v[28:31], 0
  v_mfma_f32_16x16x32_bf16 v[108:111], v[76:79], v[36:39], v[108:111]
  v_mfma_f32_16x16x32_bf16 v[112:115], v[68:71], v[44:47], v[112:115]
  v_mfma_f32_16x16x32_bf16 v[108:111], v[72:75], v[32:35], v[108:111]
  v_mfma_f32_16x16x32_bf16 v[112:115], v[80:83], v[32:35], v[112:115]
  v_mfma_f32_16x16x32_bf16 v[108:111], v[80:83], v[40:43], v[108:111]
  v_mfma_f32_16x16x32_bf16 v[112:115], v[72:75], v[48:51], v[112:115]
  s_waitcnt lgkmcnt(0)
  v_xor_b32 v92, v23, v92
  v_xor_b32 v93, v23, v93
  v_xor_b32 v94, v23, v94
  v_xor_b32 v95, v23, v95
  v_xor_b32 v96, v23, v96
  v_xor_b32 v97, v23, v97
  v_xor_b32 v98, v23, v98
  v_xor_b32 v99, v23, v99
  v_mfma_f32_16x16x32_bf16 v[116:119], v[84:87], v[28:31], 0
  v_mfma_f32_16x16x32_bf16 v[116:119], v[92:95], v[36:39], v[116:119]
  v_mfma_f32_16x16x32_bf16 v[116:119], v[88:91], v[32:35], v[116:119]
  v_mfma_f32_16x16x32_bf16 v[116:119], v[96:99], v[40:43], v[116:119]
  v_lshlrev_b32 v24, 6, v20
  v_lshl_add_u32 v24, v21, 4, v24
  v_lshrrev_b32 v25, 1, v24
  s_lshl_b32 s62, s60, 10
  s_add_u32 s62, s62, s5
  s_add_u32 s63, s62, 4096
  s_lshl_b32 s64, s60, 9
  s_add_u32 s64, s64, s5
  s_add_u32 s64, s64, 8192
  v_cvt_pk_bf16_f32 v52, v100, v101
  v_cvt_pk_bf16_f32 v53, v102, v103
  v_cvt_pk_bf16_f32 v54, v104, v105
  v_cvt_pk_bf16_f32 v55, v106, v107
  v_cvt_pk_bf16_f32 v56, v108, v109
  v_cvt_pk_bf16_f32 v57, v110, v111
  v_cvt_pk_bf16_f32 v58, v112, v113
  v_cvt_pk_bf16_f32 v59, v114, v115
  v_cvt_pk_bf16_f32 v60, v116, v117
  v_cvt_pk_bf16_f32 v61, v118, v119
  buffer_store_dwordx4 v[52:55], v24, s[36:39], s62 offen sc1
  buffer_store_dwordx4 v[56:59], v24, s[36:39], s63 offen sc1
  buffer_store_dwordx2 v[60:61], v25, s[36:39], s64 offen sc1
  s_nop 1
  s_waitcnt vmcnt(9)
  s_barrier
  s_add_u32 s82, s61, 1
  s_cmp_ge_u32 s82, 9
  s_cselect_b32 s7, 9, 0
  s_sub_u32 s82, s82, s7
  s_lshl_b32 s82, s82, 7
  s_add_u32 s82, s82, s81
  s_add_u32 m0, s80, 73728
  s_add_u32 s7, s82, 0
  buffer_load_dwordx4 v16, s[28:31], s7 offen lds
  v_lshrrev_b32 v4, 3, v22
  v_mul_u32_u24 v4, 10240, v4
  v_and_b32 v5, 7, v22
  v_lshl_add_u32 v24, v5, 4, v4
  v_lshrrev_b32 v4, 2, v22
  v_mul_u32_u24 v4, 10240, v4
  v_and_b32 v5, 3, v22
  v_lshl_add_u32 v25, v5, 4, v4
  v_cvt_f32_u32 v28, v20
  v_mul_f32 v28, 0x3d000000, v28
  s_add_u32 m0, s80, 77824
  s_add_u32 s7, s82, 294912
  buffer_load_dwordx4 v16, s[28:31], s7 offen lds
  v_lshlrev_b32 v23, 2, v21
  v_cvt_f32_u32 v23, v23
  v_mul_f32 v23, v23, v28
  v_fmamk_f32 v30, v28, 0x00000000, v23
  v_fmamk_f32 v31, v28, 0x3f800000, v23
  v_cos_f32 v44, v30
  v_cos_f32 v45, v31
  v_sin_f32 v46, v30
  s_add_u32 m0, s80, 81920
  s_add_u32 s7, s82, 589824
  buffer_load_dwordx4 v16, s[28:31], s7 offen lds
  v_sin_f32 v47, v31
  v_cvt_pk_bf16_f32 v32, v44, v45
  v_cvt_pk_bf16_f32 v36, v46, v47
  v_xor_b32 v40, 0x80008000, v36
  v_fmamk_f32 v30, v28, 0x40000000, v23
  v_fmamk_f32 v31, v28, 0x40400000, v23
  v_cos_f32 v44, v30
  s_add_u32 m0, s80, 86016
  s_add_u32 s7, s82, 884736
  buffer_load_dwordx4 v16, s[28:31], s7 offen lds
  v_cos_f32 v45, v31
  v_sin_f32 v46, v30
  v_sin_f32 v47, v31
  v_cvt_pk_bf16_f32 v33, v44, v45
  v_cvt_pk_bf16_f32 v37, v46, v47
  v_xor_b32 v41, 0x80008000, v37
  v_fmamk_f32 v30, v28, 0x41800000, v23
  s_add_u32 m0, s80, 90112
  s_add_u32 s7, s82, 1179648
  buffer_load_dwordx4 v16, s[28:31], s7 offen lds
  v_fmamk_f32 v31, v28, 0x41880000, v23
  v_cos_f32 v44, v30
  v_cos_f32 v45, v31
  v_sin_f32 v46, v30
  v_sin_f32 v47, v31
  v_cvt_pk_bf16_f32 v34, v44, v45
  s_add_u32 m0, s80, 94208
  s_add_u32 s7, s82, 1474560
  buffer_load_dwordx4 v16, s[28:31], s7 offen lds
  v_cvt_pk_bf16_f32 v38, v46, v47
  v_xor_b32 v42, 0x80008000, v38
  v_fmamk_f32 v30, v28, 0x41900000, v23
  v_fmamk_f32 v31, v28, 0x41980000, v23
  v_cos_f32 v44, v30
  v_cos_f32 v45, v31
  v_sin_f32 v46, v30
  v_sin_f32 v47, v31
  v_cvt_pk_bf16_f32 v35, v44, v45
  v_cvt_pk_bf16_f32 v39, v46, v47
  v_xor_b32 v43, 0x80008000, v39
  v_xor_b32 v44, 0x80000000, v32
  v_xor_b32 v45, 0x80000000, v33
  v_xor_b32 v46, 0x80000000, v34
  v_xor_b32 v47, 0x80000000, v35
  v_xor_b32 v48, 0x80000000, v36
  v_xor_b32 v49, 0x80000000, v37
  v_xor_b32 v50, 0x80000000, v38
  v_xor_b32 v51, 0x80000000, v39
  v_xor_b32 v52, 0x80000000, v40
  v_xor_b32 v53, 0x80000000, v41
  s_waitcnt vmcnt(9)
  s_barrier
  s_add_u32 m0, s80, 98304
  s_add_u32 s7, s82, 1769472
  buffer_load_dwordx4 v16, s[28:31], s7 offen lds
  v_xor_b32 v54, 0x80000000, v42
  v_xor_b32 v55, 0x80000000, v43
  s_mul_i32 s63, s56, 576
  s_lshl_b32 s64, s60, 3
  s_add_u32 s63, s63, s64
  s_mul_i32 s63, s63, 1152
  s_add_u32 s83, s61, 0
  s_cmp_ge_u32 s83, 9
  s_cselect_b32 s62, 9, 0
  s_sub_u32 s83, s83, s62
  s_add_u32 m0, s80, 102400
  s_add_u32 s7, s82, 2064384
  buffer_load_dwordx4 v16, s[28:31], s7 offen lds
  s_mul_i32 s83, s83, 73728
  s_add_u32 s83, s83, s63
  s_add_u32 s84, s61, 1
  s_cmp_ge_u32 s84, 9
  s_cselect_b32 s62, 9, 0
  s_sub_u32 s84, s84, s62
  s_mul_i32 s84, s84, 73728
  s_add_u32 s84, s84, s63
  s_add_u32 s85, s61, 2
  s_cmp_ge_u32 s85, 9
  s_cselect_b32 s62, 9, 0
  s_add_u32 m0, s80, 106496
  s_add_u32 s7, s82, 2359296
  buffer_load_dwordx4 v16, s[28:31], s7 offen lds
  s_sub_u32 s85, s85, s62
  s_mul_i32 s85, s85, 73728
  s_add_u32 s85, s85, s63
  s_add_u32 s86, s61, 3
  s_cmp_ge_u32 s86, 9
  s_cselect_b32 s62, 9, 0
  s_sub_u32 s86, s86, s62
  s_mul_i32 s86, s86, 73728
  s_add_u32 s86, s86, s63
  s_add_u32 m0, s80, 110592
  s_add_u32 s7, s82, 2654208
  buffer_load_dwordx4 v16, s[28:31], s7 offen lds
  s_add_u32 s87, s61, 4
  s_cmp_ge_u32 s87, 9
  s_cselect_b32 s62, 9, 0
  s_sub_u32 s87, s87, s62
  s_mul_i32 s87, s87, 73728
  s_add_u32 s87, s87, s63
  s_add_u32 s88, s61, 5
  s_cmp_ge_u32 s88, 9
  s_cselect_b32 s62, 9, 0
  s_sub_u32 s88, s88, s62
  s_add_u32 m0, s80, 114688
  s_add_u32 s7, s82, 2949120
  buffer_load_dwordx4 v16, s[28:31], s7 offen lds
  s_mul_i32 s88, s88, 73728
  s_add_u32 s88, s88, s63
  s_add_u32 s89, s61, 6
  s_cmp_ge_u32 s89, 9
  s_cselect_b32 s62, 9, 0
  s_sub_u32 s89, s89, s62
  s_mul_i32 s89, s89, 73728
  s_add_u32 s89, s89, s63
  s_add_u32 s90, s61, 7
  s_cmp_ge_u32 s90, 9
  s_cselect_b32 s62, 9, 0
  s_add_u32 m0, s80, 118784
  s_add_u32 s7, s82, 3244032
  buffer_load_dwordx4 v16, s[28:31], s7 offen lds
  s_sub_u32 s90, s90, s62
  s_mul_i32 s90, s90, 73728
  s_add_u32 s90, s90, s63
  s_add_u32 s91, s61, 8
  s_cmp_ge_u32 s91, 9
  s_cselect_b32 s62, 9, 0
  s_sub_u32 s91, s91, s62
  s_mul_i32 s91, s91, 73728
  s_add_u32 s91, s91, s63
  s_waitcnt vmcnt(12)
  s_waitcnt vmcnt(6)
  s_barrier
  s_add_u32 m0, s80, 122880
  s_add_u32 s7, s82, 3538944
  buffer_load_dwordx4 v16, s[28:31], s7 offen lds
  s_add_u32 m0, s80, 126976
  s_add_u32 s7, s82, 3833856
  buffer_load_dwordx4 v16, s[28:31], s7 offen lds
  s_add_u32 m0, s80, 131072
  s_add_u32 s7, s82, 4128768
  buffer_load_dwordx4 v16, s[28:31], s7 offen lds
  s_add_u32 m0, s80, 135168
  s_add_u32 s7, s82, 4423680
  buffer_load_dwordx4 v16, s[28:31], s7 offen lds
  s_add_u32 m0, s80, 139264
  s_add_u32 s7, s82, 4718592
  buffer_load_dwordx4 v16, s[28:31], s7 offen lds
  s_add_u32 m0, s80, 143360
  s_add_u32 s7, s82, 5013504
  buffer_load_dwordx4 v16, s[28:31], s7 offen lds
  s_lshl_b32 s72, s15, 2
  s_add_u32 m0, s72, 57344
  s_nop 0
  buffer_load_dwordx4 v26, s[44:47], s14 offen lds
  s_lshl_b32 s72, s15, 2
  s_add_u32 m0, s72, 61440
  s_nop 0
  buffer_load_dwordx4 v26, s[48:51], s14 offen lds
  s_add_u32 m0, s15, 65536
  s_mov_b64 exec, 0xffff
  buffer_load_dwordx4 v27, s[44:47], s14 offen lds
  s_mov_b64 exec, -1
  s_add_u32 m0, s15, 66560
  s_mov_b64 exec, 0xffff
  buffer_load_dwordx4 v27, s[48:51], s14 offen lds
  s_mov_b64 exec, -1
  v_and_b32 v23, 7, v0
  v_lshlrev_b32 v23, 5, v23
  s_mov_b64 exec, s[10:11]
  buffer_load_dword v28, v23, s[52:55], 0 offen sc1
  s_mov_b64 exec, -1
  s_waitcnt vmcnt(11)
  s_barrier
  s_add_u32 s82, s61, 2
  s_cmp_ge_u32 s82, 9
  s_cselect_b32 s7, 9, 0
  s_sub_u32 s82, s82, s7
  s_lshl_b32 s82, s82, 7
  s_add_u32 s82, s82, s81
  s_add_u32 m0, s80, 73728
  s_add_u32 s7, s82, 0
  buffer_load_dwordx4 v16, s[28:31], s7 offen lds
  s_add_u32 m0, s80, 77824
  s_add_u32 s7, s82, 294912
  buffer_load_dwordx4 v16, s[28:31], s7 offen lds
  s_add_u32 m0, s80, 81920
  s_add_u32 s7, s82, 589824
  buffer_load_dwordx4 v16, s[28:31], s7 offen lds
  s_add_u32 m0, s80, 86016
  s_add_u32 s7, s82, 884736
  buffer_load_dwordx4 v16, s[28:31], s7 offen lds
  s_add_u32 m0, s80, 90112
  s_add_u32 s7, s82, 1179648
  buffer_load_dwordx4 v16, s[28:31], s7 offen lds
  s_add_u32 m0, s80, 94208
  s_add_u32 s7, s82, 1474560
  buffer_load_dwordx4 v16, s[28:31], s7 offen lds
  s_waitcnt vmcnt(11)
  s_barrier
  s_add_u32 m0, s80, 98304
  s_add_u32 s7, s82, 1769472
  buffer_load_dwordx4 v16, s[28:31], s7 offen lds
  s_add_u32 m0, s80, 102400
  s_add_u32 s7, s82, 2064384
  buffer_load_dwordx4 v16, s[28:31], s7 offen lds
  s_add_u32 m0, s80, 106496
  s_add_u32 s7, s82, 2359296
  buffer_load_dwordx4 v16, s[28:31], s7 offen lds
  s_add_u32 m0, s80, 110592
  s_add_u32 s7, s82, 2654208
  buffer_load_dwordx4 v16, s[28:31], s7 offen lds
  s_add_u32 m0, s80, 114688
  s_add_u32 s7, s82, 2949120
  buffer_load_dwordx4 v16, s[28:31], s7 offen lds
  s_add_u32 m0, s80, 118784
  s_add_u32 s7, s82, 3244032
  buffer_load_dwordx4 v16, s[28:31], s7 offen lds
  s_waitcnt vmcnt(13)
  s_waitcnt vmcnt(6)
  s_barrier
  s_add_u32 m0, s80, 122880
  s_add_u32 s7, s82, 3538944
  buffer_load_dwordx4 v16, s[28:31], s7 offen lds
  s_add_u32 m0, s80, 126976
  s_add_u32 s7, s82, 3833856
  buffer_load_dwordx4 v16, s[28:31], s7 offen lds
  s_add_u32 m0, s80, 131072
  s_add_u32 s7, s82, 4128768
  buffer_load_dwordx4 v16, s[28:31], s7 offen lds
  s_add_u32 m0, s80, 135168
  s_add_u32 s7, s82, 4423680
  buffer_load_dwordx4 v16, s[28:31], s7 offen lds
  s_add_u32 m0, s80, 139264
  s_add_u32 s7, s82, 4718592
  buffer_load_dwordx4 v16, s[28:31], s7 offen lds
  s_add_u32 m0, s80, 143360
  s_add_u32 s7, s82, 5013504
  buffer_load_dwordx4 v16, s[28:31], s7 offen lds
  s_waitcnt vmcnt(6)
  s_barrier
  s_add_u32 s82, s61, 3
  s_cmp_ge_u32 s82, 9
  s_cselect_b32 s7, 9, 0
  s_sub_u32 s82, s82, s7
  s_lshl_b32 s82, s82, 7
  s_add_u32 s82, s82, s81
  s_add_u32 m0, s80, 73728
  s_add_u32 s7, s82, 0
  buffer_load_dwordx4 v16, s[28:31], s7 offen lds
  s_add_u32 m0, s80, 77824
  s_add_u32 s7, s82, 294912
  buffer_load_dwordx4 v16, s[28:31], s7 offen lds
  s_add_u32 m0, s80, 81920
  s_add_u32 s7, s82, 589824
  buffer_load_dwordx4 v16, s[28:31], s7 offen lds
  s_add_u32 m0, s80, 86016
  s_add_u32 s7, s82, 884736
  buffer_load_dwordx4 v16, s[28:31], s7 offen lds
  s_add_u32 m0, s80, 90112
  s_add_u32 s7, s82, 1179648
  buffer_load_dwordx4 v16, s[28:31], s7 offen lds
  s_add_u32 m0, s80, 94208
  s_add_u32 s7, s82, 1474560
  buffer_load_dwordx4 v16, s[28:31], s7 offen lds
  s_and_b64 s[64:65], exec, s[10:11]
  s_mov_b32 s66, 0
L_init:
  v_cmp_le_u32 vcc, 32, v28
  s_nop 1
  s_andn2_b64 s[68:69], s[64:65], vcc
  s_cbranch_scc0 L_init_ok
  s_add_u32 s66, s66, 1
  s_cmp_lt_u32 s66, 32768
  s_cbranch_scc0 L_init_ok
  s_sleep 8
  buffer_load_dword v28, v23, s[52:55], 0 offen sc1
  s_waitcnt vmcnt(0)
  s_branch L_init
L_init_ok:
  v_and_b32 v23, 31, v0
  v_lshlrev_b32 v23, 2, v23
  s_lshl_b32 s16, s56, 7
  s_add_u32 s16, s16, 0
  s_mov_b64 exec, s[10:11]
  buffer_load_dword v28, v23, s[36:39], s16 offen sc1
  s_mov_b64 exec, -1
  s_waitcnt vmcnt(7)
  s_barrier
  s_add_u32 m0, s80, 98304
  s_add_u32 s7, s82, 1769472
  buffer_load_dwordx4 v16, s[28:31], s7 offen lds
  s_lshl_b32 s19, s56, 2
  s_add_u32 s19, s19, s60
  s_mul_i32 s19, s19, 81920
  s_add_u32 s19, s19, 65536
  s_lshl_b32 s20, s60, 9
  s_add_u32 m0, s80, 102400
  s_add_u32 s7, s82, 2064384
  buffer_load_dwordx4 v16, s[28:31], s7 offen lds
  s_add_u32 m0, s80, 106496
  s_add_u32 s7, s82, 2359296
  buffer_load_dwordx4 v16, s[28:31], s7 offen lds
  s_add_u32 m0, s80, 110592
  s_add_u32 s7, s82, 2654208
  buffer_load_dwordx4 v16, s[28:31], s7 offen lds
  s_add_u32 m0, s80, 114688
  s_add_u32 s7, s82, 2949120
  buffer_load_dwordx4 v16, s[28:31], s7 offen lds
  s_add_u32 m0, s80, 118784
  s_add_u32 s7, s82, 3244032
  buffer_load_dwordx4 v16, s[28:31], s7 offen lds
  s_waitcnt vmcnt(6)
  s_and_b64 s[64:65], exec, s[10:11]
  s_mov_b32 s66, 0
L_ugp:
  v_cmp_ne_u32 vcc, 0, v28
  s_nop 1
  s_andn2_b64 s[68:69], s[64:65], vcc
  s_cbranch_scc0 L_ugp_ok
  s_add_u32 s66, s66, 1
  s_cmp_lt_u32 s66, 32768
  s_cbranch_scc0 L_ugp_ok
  s_sleep 8
  buffer_load_dword v28, v23, s[36:39], s16 offen sc1
  s_waitcnt vmcnt(0)
  s_branch L_ugp
L_ugp_ok:
  s_barrier
  s_add_u32 m0, s80, 122880
  s_add_u32 s7, s82, 3538944
  buffer_load_dwordx4 v16, s[28:31], s7 offen lds
  s_add_u32 m0, s80, 126976
  s_add_u32 s7, s82, 3833856
  buffer_load_dwordx4 v16, s[28:31], s7 offen lds
  s_add_u32 m0, s80, 131072
  s_add_u32 s7, s82, 4128768
  buffer_load_dwordx4 v16, s[28:31], s7 offen lds
  s_add_u32 m0, s80, 135168
  s_add_u32 s7, s82, 4423680
  buffer_load_dwordx4 v16, s[28:31], s7 offen lds
  s_add_u32 m0, s80, 139264
  s_add_u32 s7, s82, 4718592
  buffer_load_dwordx4 v16, s[28:31], s7 offen lds
  s_add_u32 m0, s80, 143360
  s_add_u32 s7, s82, 5013504
  buffer_load_dwordx4 v16, s[28:31], s7 offen lds
  s_mul_i32 s62, s57, 128
  s_add_u32 s62, s62, s19
  s_add_u32 s62, s62, 0
  s_lshl_b32 s63, s20, 1
  s_add_u32 m0, s63, 147456
  s_nop 0
  buffer_load_dwordx4 v24, s[36:39], s62 offen sc1 lds
  s_mul_i32 s62, s57, 128
  s_add_u32 s62, s62, s19
  s_add_u32 s62, s62, 4096
  s_lshl_b32 s63, s20, 1
  s_add_u32 m0, s63, 151552
  s_nop 0
  buffer_load_dwordx4 v24, s[36:39], s62 offen sc1 lds
  s_mul_i32 s62, s57, 64
  s_add_u32 s62, s62, s19
  s_add_u32 s62, s62, 8192
  s_add_u32 m0, s20, 155648
  s_mov_b64 exec, 0xffffffff
  buffer_load_dwordx4 v25, s[36:39], s62 offen sc1 lds
  s_mov_b64 exec, -1
  v_lshrrev_b32 v30, 2, v22
  v_and_b32 v31, 3, v22
  v_lshlrev_b32 v31, 3, v31
  v_lshl_add_u32 v28, v30, 7, v31
  v_lshl_add_u32 v29, v30, 5, v31
  s_and_b32 s62, s60, 1
  s_lshl_b32 s62, s62, 6
  s_lshr_b32 s63, s60, 1
  s_lshl_b32 s63, s63, 5
  s_add_u32 s62, s62, s63
  s_add_u32 s62, s62, 57344
  v_add_u32 v28, s62, v28
  v_add_u32 v29, 65536, v29
  ds_read_b64_tr_b16 v[56:57], v28 offset:0
  ds_read_b64_tr_b16 v[58:59], v28 offset:2048
  ds_read_b64_tr_b16 v[60:61], v28 offset:4096
  ds_read_b64_tr_b16 v[62:63], v28 offset:6144
  ds_read_b64_tr_b16 v[64:65], v29 offset:0
  ds_read_b64_tr_b16 v[66:67], v29 offset:512
  ds_read_b64_tr_b16 v[68:69], v29 offset:1024
  ds_read_b64_tr_b16 v[70:71], v29 offset:1536
  s_waitcnt lgkmcnt(0)
  s_waitcnt vmcnt(9)
  s_barrier
  s_add_u32 s82, s61, 4
  s_cmp_ge_u32 s82, 9
  s_cselect_b32 s7, 9, 0
  s_sub_u32 s82, s82, s7
  s_lshl_b32 s82, s82, 7
  s_add_u32 s82, s82, s81
  s_add_u32 m0, s80, 73728
  s_add_u32 s7, s82, 0
  buffer_load_dwordx4 v16, s[28:31], s7 offen lds
  s_add_u32 m0, s80, 77824
  s_add_u32 s7, s82, 294912
  buffer_load_dwordx4 v16, s[28:31], s7 offen lds
  s_add_u32 m0, s80, 81920
  s_add_u32 s7, s82, 589824
  buffer_load_dwordx4 v16, s[28:31], s7 offen lds
  s_add_u32 m0, s80, 86016
  s_add_u32 s7, s82, 884736
  buffer_load_dwordx4 v16, s[28:31], s7 offen lds
  s_add_u32 m0, s80, 90112
  s_add_u32 s7, s82, 1179648
  buffer_load_dwordx4 v16, s[28:31], s7 offen lds
  s_add_u32 m0, s80, 94208
  s_add_u32 s7, s82, 1474560
  buffer_load_dwordx4 v16, s[28:31], s7 offen lds
  s_waitcnt vmcnt(6)
  s_barrier
  s_add_u32 m0, s80, 98304
  s_add_u32 s7, s82, 1769472
  buffer_load_dwordx4 v16, s[28:31], s7 offen lds
  v_lshrrev_b32 v96, 2, v22
  v_and_b32 v97, 3, v22
  v_lshlrev_b32 v97, 4, v97
  v_lshl_add_u32 v26, v96, 7, v97
  s_lshr_b32 s62, s60, 1
  s_lshl_b32 s62, s62, 12
  s_and_b32 s63, s60, 1
  s_lshl_b32 s63, s63, 6
  s_add_u32 s62, s62, s63
  s_add_u32 s62, s62, 147456
  v_add_u32 v26, s62, v26
  s_lshl_b32 s62, s60, 6
  s_add_u32 s62, s62, s6
  v_mul_u32_u24 v27, 320, v20
  v_lshl_add_u32 v27, v21, 4, v27
  s_add_u32 s63, s62, 5120
  ds_read_b64_tr_b16 v[72:73], v26 offset:0
  ds_read_b64_tr_b16 v[74:75], v26 offset:2048
  s_add_u32 m0, s80, 102400
  s_add_u32 s7, s82, 2064384
  buffer_load_dwordx4 v16, s[28:31], s7 offen lds
  ds_read_b64_tr_b16 v[76:77], v26 offset:8
  ds_read_b64_tr_b16 v[78:79], v26 offset:2056
  s_waitcnt lgkmcnt(0)
  v_mfma_f32_16x16x32_bf16 v[80:83], v[32:35], v[72:75], 0
  v_mfma_f32_16x16x32_bf16 v[84:87], v[32:35], v[76:79], 0
  v_mfma_f32_16x16x32_bf16 v[80:83], v[36:39], v[76:79], v[80:83]
  s_add_u32 m0, s80, 106496
  s_add_u32 s7, s82, 2359296
  buffer_load_dwordx4 v16, s[28:31], s7 offen lds
  v_mfma_f32_16x16x32_bf16 v[84:87], v[40:43], v[72:75], v[84:87]
  v_mfma_f32_16x16x32_bf16 v[88:91], v[44:47], v[72:75], 0
  v_mfma_f32_16x16x32_bf16 v[92:95], v[44:47], v[76:79], 0
  s_add_u32 m0, s80, 110592
  s_add_u32 s7, s82, 2654208
  buffer_load_dwordx4 v16, s[28:31], s7 offen lds
  v_mfma_f32_16x16x32_bf16 v[88:91], v[48:51], v[76:79], v[88:91]
  v_mfma_f32_16x16x32_bf16 v[92:95], v[52:55], v[72:75], v[92:95]
  s_nop 7
  v_lshlrev_b32 v96, 16, v56
  v_lshlrev_b32 v97, 16, v60
  v_mul_f32 v98, v80, v96
  v_mul_f32 v100, v80, v97
  v_fma_f32 v98, -v84, v97, v98
  v_fma_f32 v100, v84, v96, v100
  v_and_b32 v96, s71, v56
  s_add_u32 m0, s80, 114688
  s_add_u32 s7, s82, 2949120
  buffer_load_dwordx4 v16, s[28:31], s7 offen lds
  v_and_b32 v97, s71, v60
  v_mul_f32 v99, v81, v96
  v_mul_f32 v101, v81, v97
  v_fma_f32 v99, -v85, v97, v99
  v_fma_f32 v101, v85, v96, v101
  v_cvt_pk_bf16_f32 v72, v98, v99
  v_cvt_pk_bf16_f32 v76, v100, v101
  v_lshlrev_b32 v96, 16, v57
  v_lshlrev_b32 v97, 16, v61
  v_mul_f32 v98, v82, v96
  v_mul_f32 v100, v82, v97
  v_fma_f32 v98, -v86, v97, v98
  v_fma_f32 v100, v86, v96, v100
  v_and_b32 v96, s71, v57
  v_and_b32 v97, s71, v61
  v_mul_f32 v99, v83, v96
  v_mul_f32 v101, v83, v97
  v_fma_f32 v99, -v87, v97, v99
  v_fma_f32 v101, v87, v96, v101
  v_cvt_pk_bf16_f32 v73, v98, v99
  s_add_u32 m0, s80, 118784
  s_add_u32 s7, s82, 3244032
  buffer_load_dwordx4 v16, s[28:31], s7 offen lds
  v_cvt_pk_bf16_f32 v77, v100, v101
  v_lshlrev_b32 v96, 16, v58
  v_lshlrev_b32 v97, 16, v62
  v_mul_f32 v98, v88, v96
  v_mul_f32 v100, v88, v97
  v_fma_f32 v98, -v92, v97, v98
  v_fma_f32 v100, v92, v96, v100
  v_and_b32 v96, s71, v58
  v_and_b32 v97, s71, v62
  v_mul_f32 v99, v89, v96
  v_mul_f32 v101, v89, v97
  v_fma_f32 v99, -v93, v97, v99
  v_fma_f32 v101, v93, v96, v101
  v_cvt_pk_bf16_f32 v74, v98, v99
  v_cvt_pk_bf16_f32 v78, v100, v101
  v_lshlrev_b32 v96, 16, v59
  v_lshlrev_b32 v97, 16, v63
  v_mul_f32 v98, v90, v96
  v_mul_f32 v100, v90, v97
  v_fma_f32 v98, -v94, v97, v98
  v_fma_f32 v100, v94, v96, v100
  v_and_b32 v96, s71, v59
  v_and_b32 v97, s71, v63
  v_mul_f32 v99, v91, v96
  v_mul_f32 v101, v91, v97
  v_fma_f32 v99, -v95, v97, v99
  v_fma_f32 v101, v95, v96, v101
  v_cvt_pk_bf16_f32 v75, v98, v99
  v_cvt_pk_bf16_f32 v79, v100, v101
  s_nop 1
  v_mfma_f32_16x16x32_bf16 v[80:83], v[72:75], v[32:35], 0
  v_mfma_f32_16x16x32_bf16 v[84:87], v[76:79], v[32:35], 0
  v_mfma_f32_16x16x32_bf16 v[80:83], v[76:79], v[40:43], v[80:83]
  s_waitcnt vmcnt(6)
  s_barrier
  s_add_u32 m0, s80, 122880
  s_add_u32 s7, s82, 3538944
  buffer_load_dwordx4 v16, s[28:31], s7 offen lds
  v_mfma_f32_16x16x32_bf16 v[84:87], v[72:75], v[36:39], v[84:87]
  v_mfma_f32_16x16x32_bf16 v[88:91], v[72:75], v[44:47], 0
  v_mfma_f32_16x16x32_bf16 v[92:95], v[76:79], v[44:47], 0
  v_mfma_f32_16x16x32_bf16 v[88:91], v[76:79], v[52:55], v[88:91]
  s_add_u32 m0, s80, 126976
  s_add_u32 s7, s82, 3833856
  buffer_load_dwordx4 v16, s[28:31], s7 offen lds
  v_mfma_f32_16x16x32_bf16 v[92:95], v[72:75], v[48:51], v[92:95]
  s_nop 0
  v_cvt_pk_bf16_f32 v72, v80, v84
  v_cvt_pk_bf16_f32 v73, v81, v85
  v_cvt_pk_bf16_f32 v74, v82, v86
  v_cvt_pk_bf16_f32 v75, v83, v87
  buffer_store_dwordx4 v[72:75], v27, s[36:39], s62 offen sc1
  s_add_u32 m0, s80, 131072
  s_add_u32 s7, s82, 4128768
  buffer_load_dwordx4 v16, s[28:31], s7 offen lds
  v_cvt_pk_bf16_f32 v76, v88, v92
  v_cvt_pk_bf16_f32 v77, v89, v93
  v_cvt_pk_bf16_f32 v78, v90, v94
  v_cvt_pk_bf16_f32 v79, v91, v95
  buffer_store_dwordx4 v[76:79], v27, s[36:39], s63 offen sc1
  s_nop 1
  v_lshrrev_b32 v96, 2, v22
  v_and_b32 v97, 3, v22
  v_lshlrev_b32 v96, 6, v96
  v_lshrrev_b32 v26, 1, v97
  v_lshl_add_u32 v26, v26, 5, v96
  v_and_b32 v97, 1, v97
  v_lshl_add_u32 v26, v97, 3, v26
  v_add_u32 v26, 155648, v26
  s_add_u32 s62, s6, 256
  s_add_u32 m0, s80, 135168
  s_add_u32 s7, s82, 4423680
  buffer_load_dwordx4 v16, s[28:31], s7 offen lds
  v_mul_u32_u24 v27, 320, v20
  v_lshl_add_u32 v27, v21, 4, v27
  s_add_u32 s63, s62, 5120
  s_cmp_eq_u32 s60, 0
  s_cbranch_scc0 L_k2_skip1
  ds_read_b64_tr_b16 v[72:73], v26 offset:0
  ds_read_b64_tr_b16 v[74:75], v26 offset:1024
  ds_read_b64_tr_b16 v[76:77], v26 offset:16
  ds_read_b64_tr_b16 v[78:79], v26 offset:1040
  s_waitcnt lgkmcnt(0)
  v_mfma_f32_16x16x32_bf16 v[80:83], v[32:35], v[72:75], 0
  v_mfma_f32_16x16x32_bf16 v[84:87], v[32:35], v[76:79], 0
  v_mfma_f32_16x16x32_bf16 v[80:83], v[36:39], v[76:79], v[80:83]
  v_mfma_f32_16x16x32_bf16 v[84:87], v[40:43], v[72:75], v[84:87]
  v_mfma_f32_16x16x32_bf16 v[88:91], v[44:47], v[72:75], 0
  v_mfma_f32_16x16x32_bf16 v[92:95], v[44:47], v[76:79], 0
  v_mfma_f32_16x16x32_bf16 v[88:91], v[48:51], v[76:79], v[88:91]
  v_mfma_f32_16x16x32_bf16 v[92:95], v[52:55], v[72:75], v[92:95]
  s_nop 7
L_k2_skip1:
  s_nop 0
  s_add_u32 m0, s80, 139264
  s_add_u32 s7, s82, 4718592
  buffer_load_dwordx4 v16, s[28:31], s7 offen lds
  s_add_u32 m0, s80, 143360
  s_add_u32 s7, s82, 5013504
  buffer_load_dwordx4 v16, s[28:31], s7 offen lds
  s_waitcnt vmcnt(8)
  s_barrier
  s_add_u32 s82, s61, 5
  s_cmp_ge_u32 s82, 9
  s_cselect_b32 s7, 9, 0
  s_sub_u32 s82, s82, s7
  s_lshl_b32 s82, s82, 7
  s_add_u32 s82, s82, s81
  s_add_u32 m0, s80, 73728
  s_add_u32 s7, s82, 0
  buffer_load_dwordx4 v16, s[28:31], s7 offen lds
  s_cmp_eq_u32 s60, 0
  s_cbranch_scc0 L_k2_skip2
  v_lshlrev_b32 v96, 16, v64
  v_lshlrev_b32 v97, 16, v68
  v_mul_f32 v98, v80, v96
  v_mul_f32 v100, v80, v97
  v_fma_f32 v98, -v84, v97, v98
  v_fma_f32 v100, v84, v96, v100
  v_and_b32 v96, s71, v64
  v_and_b32 v97, s71, v68
  v_mul_f32 v99, v81, v96
  v_mul_f32 v101, v81, v97
  v_fma_f32 v99, -v85, v97, v99
  v_fma_f32 v101, v85, v96, v101
  v_cvt_pk_bf16_f32 v72, v98, v99
  v_cvt_pk_bf16_f32 v76, v100, v101
  v_lshlrev_b32 v96, 16, v65
  v_lshlrev_b32 v97, 16, v69
  v_mul_f32 v98, v82, v96
  v_mul_f32 v100, v82, v97
  v_fma_f32 v98, -v86, v97, v98
  v_fma_f32 v100, v86, v96, v100
  v_and_b32 v96, s71, v65
  v_and_b32 v97, s71, v69
  v_mul_f32 v99, v83, v96
  v_mul_f32 v101, v83, v97
  v_fma_f32 v99, -v87, v97, v99
  v_fma_f32 v101, v87, v96, v101
  v_cvt_pk_bf16_f32 v73, v98, v99
  v_cvt_pk_bf16_f32 v77, v100, v101
L_k2_skip2:
  s_nop 0
  s_add_u32 m0, s80, 77824
  s_add_u32 s7, s82, 294912
  buffer_load_dwordx4 v16, s[28:31], s7 offen lds
  s_cmp_eq_u32 s60, 0
  s_cbranch_scc0 L_k2_skip3
  v_lshlrev_b32 v96, 16, v66
  v_lshlrev_b32 v97, 16, v70
  v_mul_f32 v98, v88, v96
  v_mul_f32 v100, v88, v97
  v_fma_f32 v98, -v92, v97, v98
  v_fma_f32 v100, v92, v96, v100
  v_and_b32 v96, s71, v66
  v_and_b32 v97, s71, v70
  v_mul_f32 v99, v89, v96
  v_mul_f32 v101, v89, v97
  v_fma_f32 v99, -v93, v97, v99
  v_fma_f32 v101, v93, v96, v101
  v_cvt_pk_bf16_f32 v74, v98, v99
  v_cvt_pk_bf16_f32 v78, v100, v101
  v_lshlrev_b32 v96, 16, v67
  v_lshlrev_b32 v97, 16, v71
  v_mul_f32 v98, v90, v96
  v_mul_f32 v100, v90, v97
  v_fma_f32 v98, -v94, v97, v98
  v_fma_f32 v100, v94, v96, v100
  v_and_b32 v96, s71, v67
  v_and_b32 v97, s71, v71
  v_mul_f32 v99, v91, v96
  v_mul_f32 v101, v91, v97
  v_fma_f32 v99, -v95, v97, v99
  v_fma_f32 v101, v95, v96, v101
  v_cvt_pk_bf16_f32 v75, v98, v99
  v_cvt_pk_bf16_f32 v79, v100, v101
L_k2_skip3:
  s_nop 0
  s_add_u32 m0, s80, 81920
  s_add_u32 s7, s82, 589824
  buffer_load_dwordx4 v16, s[28:31], s7 offen lds
  s_add_u32 m0, s80, 86016
  s_add_u32 s7, s82, 884736
  buffer_load_dwordx4 v16, s[28:31], s7 offen lds
  s_add_u32 m0, s80, 90112
  s_add_u32 s7, s82, 1179648
  buffer_load_dwordx4 v16, s[28:31], s7 offen lds
  s_add_u32 m0, s80, 94208
  s_add_u32 s7, s82, 1474560
  buffer_load_dwordx4 v16, s[28:31], s7 offen lds
  s_cmp_eq_u32 s60, 0
  s_cbranch_scc0 L_k2_skip4
  s_nop 1
  v_mfma_f32_16x16x32_bf16 v[80:83], v[72:75], v[32:35], 0
  v_mfma_f32_16x16x32_bf16 v[84:87], v[76:79], v[32:35], 0
  v_mfma_f32_16x16x32_bf16 v[80:83], v[76:79], v[40:43], v[80:83]
  v_mfma_f32_16x16x32_bf16 v[84:87], v[72:75], v[36:39], v[84:87]
  v_mfma_f32_16x16x32_bf16 v[88:91], v[72:75], v[44:47], 0
  v_mfma_f32_16x16x32_bf16 v[92:95], v[76:79], v[44:47], 0
  v_mfma_f32_16x16x32_bf16 v[88:91], v[76:79], v[52:55], v[88:91]
  v_mfma_f32_16x16x32_bf16 v[92:95], v[72:75], v[48:51], v[92:95]
  s_nop 3
  v_cvt_pk_bf16_f32 v72, v80, v84
  v_cvt_pk_bf16_f32 v73, v81, v85
  v_cvt_pk_bf16_f32 v74, v82, v86
  v_cvt_pk_bf16_f32 v75, v83, v87
  buffer_store_dwordx4 v[72:75], v27, s[36:39], s62 offen sc1
  v_cvt_pk_bf16_f32 v76, v88, v92
  v_cvt_pk_bf16_f32 v77, v89, v93
  v_cvt_pk_bf16_f32 v78, v90, v94
  v_cvt_pk_bf16_f32 v79, v91, v95
  buffer_store_dwordx4 v[76:79], v27, s[36:39], s63 offen sc1
L_k2_skip4:
  s_nop 7
  s_waitcnt vmcnt(6)
  s_barrier
  s_add_u32 m0, s80, 98304
  s_add_u32 s7, s82, 1769472
  buffer_load_dwordx4 v16, s[28:31], s7 offen lds
  s_lshl_b32 s62, s60, 9
  s_add_u32 s62, s62, s57
  v_lshlrev_b32 v26, 5, v20
  v_add_u32 v26, s62, v26
  v_cvt_f32_u32 v26, v26
  v_mul_f32 v26, 0x3a000000, v26
  v_lshlrev_b32 v23, 2, v21
  v_cvt_f32_u32 v23, v23
  v_mul_f32 v23, v23, v26
  v_fmamk_f32 v44, v26, 0x00000000, v23
  s_add_u32 m0, s80, 102400
  s_add_u32 s7, s82, 2064384
  buffer_load_dwordx4 v16, s[28:31], s7 offen lds
  v_fmamk_f32 v45, v26, 0x3f800000, v23
  v_cos_f32 v48, v44
  v_cos_f32 v49, v45
  v_sin_f32 v50, v44
  v_sin_f32 v51, v45
  v_cvt_pk_bf16_f32 v28, v48, v49
  s_add_u32 m0, s80, 106496
  s_add_u32 s7, s82, 2359296
  buffer_load_dwordx4 v16, s[28:31], s7 offen lds
  v_cvt_pk_bf16_f32 v36, v50, v51
  v_fmamk_f32 v44, v26, 0x40000000, v23
  v_fmamk_f32 v45, v26, 0x40400000, v23
  v_cos_f32 v48, v44
  v_cos_f32 v49, v45
  v_sin_f32 v50, v44
  v_sin_f32 v51, v45
  s_add_u32 m0, s80, 110592
  s_add_u32 s7, s82, 2654208
  buffer_load_dwordx4 v16, s[28:31], s7 offen lds
  v_cvt_pk_bf16_f32 v29, v48, v49
  v_cvt_pk_bf16_f32 v37, v50, v51
  v_fmamk_f32 v44, v26, 0x41800000, v23
  v_fmamk_f32 v45, v26, 0x41880000, v23
  v_cos_f32 v48, v44
  v_cos_f32 v49, v45
  v_sin_f32 v50, v44
  s_add_u32 m0, s80, 114688
  s_add_u32 s7, s82, 2949120
  buffer_load_dwordx4 v16, s[28:31], s7 offen lds
  v_sin_f32 v51, v45
  v_cvt_pk_bf16_f32 v30, v48, v49
  v_cvt_pk_bf16_f32 v38, v50, v51
  v_fmamk_f32 v44, v26, 0x41900000, v23
  v_fmamk_f32 v45, v26, 0x41980000, v23
  v_cos_f32 v48, v44
  v_cos_f32 v49, v45
  s_add_u32 m0, s80, 118784
  s_add_u32 s7, s82, 3244032
  buffer_load_dwordx4 v16, s[28:31], s7 offen lds
  v_sin_f32 v50, v44
  v_sin_f32 v51, v45
  v_cvt_pk_bf16_f32 v31, v48, v49
  v_cvt_pk_bf16_f32 v39, v50, v51
  v_fmamk_f32 v44, v26, 0x42000000, v23
  v_fmamk_f32 v45, v26, 0x42040000, v23
  v_cos_f32 v48, v44
  v_cos_f32 v49, v45
  v_sin_f32 v50, v44
  v_sin_f32 v51, v45
  v_cvt_pk_bf16_f32 v32, v48, v49
  v_cvt_pk_bf16_f32 v40, v50, v51
  v_fmamk_f32 v44, v26, 0x42080000, v23
  v_fmamk_f32 v45, v26, 0x420c0000, v23
  v_cos_f32 v48, v44
  v_cos_f32 v49, v45
  s_waitcnt vmcnt(6)
  s_barrier
  s_add_u32 m0, s80, 122880
  s_add_u32 s7, s82, 3538944
  buffer_load_dwordx4 v16, s[28:31], s7 offen lds
  v_sin_f32 v50, v44
  v_sin_f32 v51, v45
  v_cvt_pk_bf16_f32 v33, v48, v49
  v_cvt_pk_bf16_f32 v41, v50, v51
  v_fmamk_f32 v44, v26, 0x42400000, v23
  v_fmamk_f32 v45, v26, 0x42440000, v23
  v_cos_f32 v48, v44
  s_add_u32 m0, s80, 126976
  s_add_u32 s7, s82, 3833856
  buffer_load_dwordx4 v16, s[28:31], s7 offen lds
  v_cos_f32 v49, v45
  v_sin_f32 v50, v44
  v_sin_f32 v51, v45
  v_cvt_pk_bf16_f32 v34, v48, v49
  v_cvt_pk_bf16_f32 v42, v50, v51
  v_fmamk_f32 v44, v26, 0x42480000, v23
  v_fmamk_f32 v45, v26, 0x424c0000, v23
  s_add_u32 m0, s80, 131072
  s_add_u32 s7, s82, 4128768
  buffer_load_dwordx4 v16, s[28:31], s7 offen lds
  v_cos_f32 v48, v44
  v_cos_f32 v49, v45
  v_sin_f32 v50, v44
  v_sin_f32 v51, v45
  v_cvt_pk_bf16_f32 v35, v48, v49
  v_cvt_pk_bf16_f32 v43, v50, v51
  s_add_u32 m0, s80, 135168
  s_add_u32 s7, s82, 4423680
  buffer_load_dwordx4 v16, s[28:31], s7 offen lds
  s_add_u32 m0, s80, 139264
  s_add_u32 s7, s82, 4718592
  buffer_load_dwordx4 v16, s[28:31], s7 offen lds
  s_add_u32 m0, s80, 143360
  s_add_u32 s7, s82, 5013504
  buffer_load_dwordx4 v16, s[28:31], s7 offen lds
  s_waitcnt vmcnt(12)
  s_waitcnt vmcnt(6)
  s_barrier
  s_add_u32 s82, s61, 6
  s_cmp_ge_u32 s82, 9
  s_cselect_b32 s7, 9, 0
  s_sub_u32 s82, s82, s7
  s_lshl_b32 s82, s82, 7
  s_add_u32 s82, s82, s81
  s_add_u32 m0, s80, 73728
  s_add_u32 s7, s82, 0
  buffer_load_dwordx4 v16, s[28:31], s7 offen lds
  s_add_u32 m0, s80, 77824
  s_add_u32 s7, s82, 294912
  buffer_load_dwordx4 v16, s[28:31], s7 offen lds
  s_add_u32 m0, s80, 81920
  s_add_u32 s7, s82, 589824
  buffer_load_dwordx4 v16, s[28:31], s7 offen lds
  s_add_u32 m0, s80, 86016
  s_add_u32 s7, s82, 884736
  buffer_load_dwordx4 v16, s[28:31], s7 offen lds
  s_add_u32 m0, s80, 90112
  s_add_u32 s7, s82, 1179648
  buffer_load_dwordx4 v16, s[28:31], s7 offen lds
  s_add_u32 m0, s80, 94208
  s_add_u32 s7, s82, 1474560
  buffer_load_dwordx4 v16, s[28:31], s7 offen lds
  s_waitcnt vmcnt(6)
  s_barrier
  s_add_u32 m0, s80, 98304
  s_add_u32 s7, s82, 1769472
  buffer_load_dwordx4 v16, s[28:31], s7 offen lds
  s_add_u32 m0, s80, 102400
  s_add_u32 s7, s82, 2064384
  buffer_load_dwordx4 v16, s[28:31], s7 offen lds
  s_add_u32 m0, s80, 106496
  s_add_u32 s7, s82, 2359296
  buffer_load_dwordx4 v16, s[28:31], s7 offen lds
  s_add_u32 m0, s80, 110592
  s_add_u32 s7, s82, 2654208
  buffer_load_dwordx4 v16, s[28:31], s7 offen lds
  s_add_u32 m0, s80, 114688
  s_add_u32 s7, s82, 2949120
  buffer_load_dwordx4 v16, s[28:31], s7 offen lds
  s_add_u32 m0, s80, 118784
  s_add_u32 s7, s82, 3244032
  buffer_load_dwordx4 v16, s[28:31], s7 offen lds
  s_waitcnt vmcnt(6)
  s_barrier
  s_add_u32 m0, s80, 122880
  s_add_u32 s7, s82, 3538944
  buffer_load_dwordx4 v16, s[28:31], s7 offen lds
  s_add_u32 m0, s80, 126976
  s_add_u32 s7, s82, 3833856
  buffer_load_dwordx4 v16, s[28:31], s7 offen lds
  s_add_u32 m0, s80, 131072
  s_add_u32 s7, s82, 4128768
  buffer_load_dwordx4 v16, s[28:31], s7 offen lds
  s_add_u32 m0, s80, 135168
  s_add_u32 s7, s82, 4423680
  buffer_load_dwordx4 v16, s[28:31], s7 offen lds
  s_add_u32 m0, s80, 139264
  s_add_u32 s7, s82, 4718592
  buffer_load_dwordx4 v16, s[28:31], s7 offen lds
  s_add_u32 m0, s80, 143360
  s_add_u32 s7, s82, 5013504
  buffer_load_dwordx4 v16, s[28:31], s7 offen lds
  s_waitcnt vmcnt(6)
  s_barrier
  s_add_u32 s82, s61, 7
  s_cmp_ge_u32 s82, 9
  s_cselect_b32 s7, 9, 0
  s_sub_u32 s82, s82, s7
  s_lshl_b32 s82, s82, 7
  s_add_u32 s82, s82, s81
  s_add_u32 m0, s80, 73728
  s_add_u32 s7, s82, 0
  buffer_load_dwordx4 v16, s[28:31], s7 offen lds
  v_and_b32 v23, 31, v0
  v_lshlrev_b32 v23, 2, v23
  s_lshl_b32 s16, s56, 7
  s_add_u32 s16, s16, 1024
  s_add_u32 m0, s80, 77824
  s_add_u32 s7, s82, 294912
  buffer_load_dwordx4 v16, s[28:31], s7 offen lds
  s_add_u32 m0, s80, 81920
  s_add_u32 s7, s82, 589824
  buffer_load_dwordx4 v16, s[28:31], s7 offen lds
  s_add_u32 m0, s80, 86016
  s_add_u32 s7, s82, 884736
  buffer_load_dwordx4 v16, s[28:31], s7 offen lds
  s_add_u32 m0, s80, 90112
  s_add_u32 s7, s82, 1179648
  buffer_load_dwordx4 v16, s[28:31], s7 offen lds
  s_add_u32 m0, s80, 94208
  s_add_u32 s7, s82, 1474560
  buffer_load_dwordx4 v16, s[28:31], s7 offen lds
  s_mov_b64 exec, s[10:11]
  buffer_load_dword v26, v23, s[36:39], s16 offen sc1
  s_mov_b64 exec, -1
  s_waitcnt vmcnt(7)
  s_barrier
  s_add_u32 m0, s80, 98304
  s_add_u32 s7, s82, 1769472
  buffer_load_dwordx4 v16, s[28:31], s7 offen lds
  s_lshl_b32 s19, s56, 2
  s_add_u32 s19, s19, s60
  s_mul_i32 s19, s19, 81920
  s_add_u32 s19, s19, 2686976
  s_lshl_b32 s20, s60, 9
  s_add_u32 m0, s80, 102400
  s_add_u32 s7, s82, 2064384
  buffer_load_dwordx4 v16, s[28:31], s7 offen lds
  s_add_u32 m0, s80, 106496
  s_add_u32 s7, s82, 2359296
  buffer_load_dwordx4 v16, s[28:31], s7 offen lds
  s_add_u32 m0, s80, 110592
  s_add_u32 s7, s82, 2654208
  buffer_load_dwordx4 v16, s[28:31], s7 offen lds
  s_add_u32 m0, s80, 114688
  s_add_u32 s7, s82, 2949120
  buffer_load_dwordx4 v16, s[28:31], s7 offen lds
  s_add_u32 m0, s80, 118784
  s_add_u32 s7, s82, 3244032
  buffer_load_dwordx4 v16, s[28:31], s7 offen lds
  s_waitcnt vmcnt(6)
  s_and_b64 s[64:65], exec, s[10:11]
  s_mov_b32 s66, 0
L_vgp:
  v_cmp_ne_u32 vcc, 0, v26
  s_nop 1
  s_andn2_b64 s[68:69], s[64:65], vcc
  s_cbranch_scc0 L_vgp_ok
  s_add_u32 s66, s66, 1
  s_cmp_lt_u32 s66, 32768
  s_cbranch_scc0 L_vgp_ok
  s_sleep 8
  buffer_load_dword v26, v23, s[36:39], s16 offen sc1
  s_waitcnt vmcnt(0)
  s_branch L_vgp
L_vgp_ok:
  s_barrier
  s_add_u32 m0, s80, 122880
  s_add_u32 s7, s82, 3538944
  buffer_load_dwordx4 v16, s[28:31], s7 offen lds
  s_add_u32 m0, s80, 126976
  s_add_u32 s7, s82, 3833856
  buffer_load_dwordx4 v16, s[28:31], s7 offen lds
  s_add_u32 m0, s80, 131072
  s_add_u32 s7, s82, 4128768
  buffer_load_dwordx4 v16, s[28:31], s7 offen lds
  s_add_u32 m0, s80, 135168
  s_add_u32 s7, s82, 4423680
  buffer_load_dwordx4 v16, s[28:31], s7 offen lds
  s_add_u32 m0, s80, 139264
  s_add_u32 s7, s82, 4718592
  buffer_load_dwordx4 v16, s[28:31], s7 offen lds
  s_add_u32 m0, s80, 143360
  s_add_u32 s7, s82, 5013504
  buffer_load_dwordx4 v16, s[28:31], s7 offen lds
  s_mul_i32 s62, s57, 320
  s_add_u32 s62, s62, s19
  s_add_u32 s62, s62, 0
  s_lshl_b32 s63, s20, 1
  s_add_u32 m0, s63, 147456
  s_nop 0
  buffer_load_dwordx4 v24, s[36:39], s62 offen sc1 lds
  s_mul_i32 s62, s57, 320
  s_add_u32 s62, s62, s19
  s_add_u32 s62, s62, 128
  s_lshl_b32 s63, s20, 1
  s_add_u32 m0, s63, 151552
  s_nop 0
  buffer_load_dwordx4 v24, s[36:39], s62 offen sc1 lds
  s_mul_i32 s62, s57, 320
  s_add_u32 s62, s62, s19
  s_add_u32 s62, s62, 256
  s_add_u32 m0, s20, 155648
  s_mov_b64 exec, 0xffffffff
  buffer_load_dwordx4 v25, s[36:39], s62 offen sc1 lds
  s_mov_b64 exec, -1
  s_waitcnt vmcnt(9)
  s_barrier
  s_add_u32 s82, s61, 8
  s_cmp_ge_u32 s82, 9
  s_cselect_b32 s7, 9, 0
  s_sub_u32 s82, s82, s7
  s_lshl_b32 s82, s82, 7
  s_add_u32 s82, s82, s81
  s_add_u32 m0, s80, 73728
  s_add_u32 s7, s82, 0
  buffer_load_dwordx4 v16, s[28:31], s7 offen lds
  s_add_u32 m0, s80, 77824
  s_add_u32 s7, s82, 294912
  buffer_load_dwordx4 v16, s[28:31], s7 offen lds
  s_add_u32 m0, s80, 81920
  s_add_u32 s7, s82, 589824
  buffer_load_dwordx4 v16, s[28:31], s7 offen lds
  s_add_u32 m0, s80, 86016
  s_add_u32 s7, s82, 884736
  buffer_load_dwordx4 v16, s[28:31], s7 offen lds
  s_add_u32 m0, s80, 90112
  s_add_u32 s7, s82, 1179648
  buffer_load_dwordx4 v16, s[28:31], s7 offen lds
  s_add_u32 m0, s80, 94208
  s_add_u32 s7, s82, 1474560
  buffer_load_dwordx4 v16, s[28:31], s7 offen lds
  s_waitcnt vmcnt(6)
  s_barrier
  s_add_u32 m0, s80, 98304
  s_add_u32 s7, s82, 1769472
  buffer_load_dwordx4 v16, s[28:31], s7 offen lds
  v_lshrrev_b32 v5, 2, v22
  v_and_b32 v4, 3, v22
  v_lshlrev_b32 v4, 3, v4
  v_add_u32 v4, 147456, v4
  v_lshl_add_u32 v24, v5, 6, v4
  v_lshl_add_u32 v25, v5, 5, v4
  ds_read_b64_tr_b16 v[44:45], v24 offset:0
  ds_read_b64_tr_b16 v[46:47], v24 offset:1024
  ds_read_b64_tr_b16 v[48:49], v24 offset:2048
  ds_read_b64_tr_b16 v[50:51], v24 offset:3072
  ds_read_b64_tr_b16 v[52:53], v24 offset:32
  s_add_u32 m0, s80, 102400
  s_add_u32 s7, s82, 2064384
  buffer_load_dwordx4 v16, s[28:31], s7 offen lds
  ds_read_b64_tr_b16 v[54:55], v24 offset:1056
  ds_read_b64_tr_b16 v[56:57], v24 offset:2080
  ds_read_b64_tr_b16 v[58:59], v24 offset:3104
  s_waitcnt lgkmcnt(4)
  v_mfma_f32_16x16x32_bf16 v[68:71], v[44:47], v[28:31], 0
  v_mfma_f32_16x16x32_bf16 v[72:75], v[44:47], v[36:39], 0
  s_add_u32 m0, s80, 106496
  s_add_u32 s7, s82, 2359296
  buffer_load_dwordx4 v16, s[28:31], s7 offen lds
  v_mfma_f32_16x16x32_bf16 v[68:71], v[48:51], v[32:35], v[68:71]
  v_mfma_f32_16x16x32_bf16 v[72:75], v[48:51], v[40:43], v[72:75]
  s_add_u32 m0, s80, 110592
  s_add_u32 s7, s82, 2654208
  buffer_load_dwordx4 v16, s[28:31], s7 offen lds
  ds_read_b64_tr_b16 v[60:61], v24 offset:4096
  ds_read_b64_tr_b16 v[62:63], v24 offset:5120
  ds_read_b64_tr_b16 v[64:65], v24 offset:6144
  ds_read_b64_tr_b16 v[66:67], v24 offset:7168
  s_waitcnt lgkmcnt(4)
  v_mfma_f32_16x16x32_bf16 v[76:79], v[52:55], v[28:31], 0
  s_add_u32 m0, s80, 114688
  s_add_u32 s7, s82, 2949120
  buffer_load_dwordx4 v16, s[28:31], s7 offen lds
  v_mfma_f32_16x16x32_bf16 v[80:83], v[52:55], v[36:39], 0
  v_mfma_f32_16x16x32_bf16 v[76:79], v[56:59], v[32:35], v[76:79]
  v_mfma_f32_16x16x32_bf16 v[80:83], v[56:59], v[40:43], v[80:83]
  s_add_u32 m0, s80, 118784
  s_add_u32 s7, s82, 3244032
  buffer_load_dwordx4 v16, s[28:31], s7 offen lds
  ds_read_b64_tr_b16 v[44:45], v24 offset:4128
  ds_read_b64_tr_b16 v[46:47], v24 offset:5152
  ds_read_b64_tr_b16 v[48:49], v24 offset:6176
  ds_read_b64_tr_b16 v[50:51], v24 offset:7200
  s_waitcnt lgkmcnt(4)
  v_mfma_f32_16x16x32_bf16 v[84:87], v[60:63], v[28:31], 0
  v_mfma_f32_16x16x32_bf16 v[88:91], v[60:63], v[36:39], 0
  v_mfma_f32_16x16x32_bf16 v[84:87], v[64:67], v[32:35], v[84:87]
  v_mfma_f32_16x16x32_bf16 v[88:91], v[64:67], v[40:43], v[88:91]
  ds_read_b64_tr_b16 v[52:53], v25 offset:8192
  s_waitcnt lgkmcnt(0)
  s_waitcnt vmcnt(6)
  s_barrier
  s_add_u32 m0, s80, 122880
  s_add_u32 s7, s82, 3538944
  buffer_load_dwordx4 v16, s[28:31], s7 offen lds
  ds_read_b64_tr_b16 v[54:55], v25 offset:8704
  ds_read_b64_tr_b16 v[56:57], v25 offset:9216
  ds_read_b64_tr_b16 v[58:59], v25 offset:9728
  v_mfma_f32_16x16x32_bf16 v[92:95], v[44:47], v[28:31], 0
  v_mfma_f32_16x16x32_bf16 v[96:99], v[44:47], v[36:39], 0
  s_add_u32 m0, s80, 126976
  s_add_u32 s7, s82, 3833856
  buffer_load_dwordx4 v16, s[28:31], s7 offen lds
  v_mfma_f32_16x16x32_bf16 v[92:95], v[48:51], v[32:35], v[92:95]
  v_mfma_f32_16x16x32_bf16 v[96:99], v[48:51], v[40:43], v[96:99]
  s_add_u32 m0, s80, 131072
  s_add_u32 s7, s82, 4128768
  buffer_load_dwordx4 v16, s[28:31], s7 offen lds
  s_waitcnt lgkmcnt(0)
  v_mfma_f32_16x16x32_bf16 v[100:103], v[52:55], v[28:31], 0
  v_mfma_f32_16x16x32_bf16 v[104:107], v[52:55], v[36:39], 0
  v_mfma_f32_16x16x32_bf16 v[100:103], v[56:59], v[32:35], v[100:103]
  s_add_u32 m0, s80, 135168
  s_add_u32 s7, s82, 4423680
  buffer_load_dwordx4 v16, s[28:31], s7 offen lds
  v_mfma_f32_16x16x32_bf16 v[104:107], v[56:59], v[40:43], v[104:107]
  v_sub_f32 v68, v68, v73
  v_add_f32 v69, v69, v72
  v_cvt_pk_bf16_f32 v108, v68, v69
  v_sub_f32 v70, v70, v75
  v_add_f32 v71, v71, v74
  v_cvt_pk_bf16_f32 v109, v70, v71
  s_add_u32 m0, s80, 139264
  s_add_u32 s7, s82, 4718592
  buffer_load_dwordx4 v16, s[28:31], s7 offen lds
  v_sub_f32 v76, v76, v81
  v_add_f32 v77, v77, v80
  v_cvt_pk_bf16_f32 v110, v76, v77
  v_sub_f32 v78, v78, v83
  v_add_f32 v79, v79, v82
  v_cvt_pk_bf16_f32 v111, v78, v79
  v_sub_f32 v84, v84, v89
  v_add_f32 v85, v85, v88
  v_cvt_pk_bf16_f32 v112, v84, v85
  v_sub_f32 v86, v86, v91
  v_add_f32 v87, v87, v90
  v_cvt_pk_bf16_f32 v113, v86, v87
  v_sub_f32 v92, v92, v97
  v_add_f32 v93, v93, v96
  v_cvt_pk_bf16_f32 v114, v92, v93
  s_add_u32 m0, s80, 143360
  s_add_u32 s7, s82, 5013504
  buffer_load_dwordx4 v16, s[28:31], s7 offen lds
  v_sub_f32 v94, v94, v99
  v_add_f32 v95, v95, v98
  v_cvt_pk_bf16_f32 v115, v94, v95
  v_sub_f32 v100, v100, v105
  v_add_f32 v101, v101, v104
  v_cvt_pk_bf16_f32 v116, v100, v101
  v_sub_f32 v102, v102, v107
  v_add_f32 v103, v103, v106
  v_cvt_pk_bf16_f32 v117, v102, v103
  v_lshrrev_b32 v4, 1, v21
  v_lshlrev_b32 v23, 4, v20
  v_lshl_add_u32 v23, v4, 9, v23
  v_and_b32 v4, 1, v21
  v_lshl_add_u32 v23, v4, 3, v23
  s_lshr_b32 s62, s60, 1
  s_lshl_b32 s62, s62, 10
  s_and_b32 s63, s60, 1
  s_lshl_b32 s63, s63, 8
  s_add_u32 s62, s62, s63
  s_add_u32 s62, s62, 147456
  v_add_u32 v23, s62, v23
  s_waitcnt vmcnt(6)
  s_barrier
  s_mov_b32 s82, 1024
  s_add_u32 m0, s80, 73728
  s_add_u32 s7, s82, s83
  buffer_load_dwordx4 v18, s[32:35], s7 offen lds
  ds_write_b64 v23, v[108:109] offset:0
  ds_write_b64 v23, v[110:111] offset:2048
  s_add_u32 m0, s80, 77824
  s_add_u32 s7, s82, s83
  buffer_load_dwordx4 v19, s[32:35], s7 offen lds
  s_add_u32 m0, s80, 81920
  s_add_u32 s7, s82, s84
  buffer_load_dwordx4 v18, s[32:35], s7 offen lds
  s_add_u32 m0, s80, 86016
  s_add_u32 s7, s82, s84
  buffer_load_dwordx4 v19, s[32:35], s7 offen lds
  s_add_u32 m0, s80, 90112
  s_add_u32 s7, s82, s85
  buffer_load_dwordx4 v18, s[32:35], s7 offen lds
  s_add_u32 m0, s80, 94208
  s_add_u32 s7, s82, s85
  buffer_load_dwordx4 v19, s[32:35], s7 offen lds
  s_waitcnt lgkmcnt(0)
  s_waitcnt vmcnt(6)
  s_barrier
  s_add_u32 m0, s80, 98304
  s_add_u32 s7, s82, s86
  buffer_load_dwordx4 v18, s[32:35], s7 offen lds
  ds_write_b64 v23, v[112:113] offset:4096
  ds_write_b64 v23, v[114:115] offset:6144
  s_add_u32 m0, s80, 102400
  s_add_u32 s7, s82, s86
  buffer_load_dwordx4 v19, s[32:35], s7 offen lds
  s_add_u32 m0, s80, 106496
  s_add_u32 s7, s82, s87
  buffer_load_dwordx4 v18, s[32:35], s7 offen lds
  s_add_u32 m0, s80, 110592
  s_add_u32 s7, s82, s87
  buffer_load_dwordx4 v19, s[32:35], s7 offen lds
  s_add_u32 m0, s80, 114688
  s_add_u32 s7, s82, s88
  buffer_load_dwordx4 v18, s[32:35], s7 offen lds
  s_add_u32 m0, s80, 118784
  s_add_u32 s7, s82, s88
  buffer_load_dwordx4 v19, s[32:35], s7 offen lds
  s_waitcnt lgkmcnt(0)
  s_waitcnt vmcnt(6)
  s_barrier
  s_add_u32 m0, s80, 122880
  s_add_u32 s7, s82, s89
  buffer_load_dwordx4 v18, s[32:35], s7 offen lds
  ds_write_b64 v23, v[116:117] offset:8192
  s_add_u32 m0, s80, 126976
  s_add_u32 s7, s82, s89
  buffer_load_dwordx4 v19, s[32:35], s7 offen lds
  s_add_u32 m0, s80, 131072
  s_add_u32 s7, s82, s90
  buffer_load_dwordx4 v18, s[32:35], s7 offen lds
  s_add_u32 m0, s80, 135168
  s_add_u32 s7, s82, s90
  buffer_load_dwordx4 v19, s[32:35], s7 offen lds
  s_add_u32 m0, s80, 139264
  s_add_u32 s7, s82, s91
  buffer_load_dwordx4 v18, s[32:35], s7 offen lds
  s_add_u32 m0, s80, 143360
  s_add_u32 s7, s82, s91
  buffer_load_dwordx4 v19, s[32:35], s7 offen lds
  s_waitcnt lgkmcnt(0)
  s_waitcnt vmcnt(6)
  s_barrier
  s_add_u32 s82, s58, 1
  s_and_b32 s82, s82, 7
  s_lshl_b32 s82, s82, 7
  s_add_u32 m0, s80, 73728
  s_add_u32 s7, s82, s83
  buffer_load_dwordx4 v18, s[32:35], s7 offen lds
  v_and_b32 v8, 7, v0
  v_bfe_u32 v9, v0, 3, 1
  v_bfe_u32 v10, v0, 4, 1
  v_bfe_u32 v11, v0, 5, 1
  v_lshlrev_b32 v168, 4, v8
  v_lshl_add_u32 v168, v9, 9, v168
  v_lshl_add_u32 v168, v10, 3, v168
  v_mul_u32_u24 v169, 73728, v11
  v_add_u32 v168, v168, v169
  v_mul_u32_u24 v169, 36864, v8
  v_lshl_add_u32 v169, v9, 3, v169
  s_add_u32 m0, s80, 77824
  s_add_u32 s7, s82, s83
  buffer_load_dwordx4 v19, s[32:35], s7 offen lds
  v_lshl_add_u32 v169, v10, 4, v169
  s_lshr_b32 s72, s58, 2
  s_lshl_b32 s72, s72, 12
  s_and_b32 s73, s58, 3
  s_lshl_b32 s73, s73, 7
  s_add_u32 s72, s72, s73
  s_lshl_b32 s73, s60, 10
  s_add_u32 s72, s72, s73
  v_add_u32 v168, s72, v168
  s_lshl_b32 s18, s58, 8
  s_add_u32 s18, s18, s57
  s_add_u32 m0, s80, 81920
  s_add_u32 s7, s82, s84
  buffer_load_dwordx4 v18, s[32:35], s7 offen lds
  s_mul_i32 s18, s18, 1152
  s_lshl_b32 s74, s60, 5
  s_add_u32 s18, s18, s74
  v_and_b32 v8, 31, v0
  v_mul_u32_u24 v8, 36864, v8
  v_lshl_add_u32 v172, v11, 4, v8
  v_and_b32 v8, 7, v0
  v_lshlrev_b32 v8, 2, v8
  s_sub_u32 s75, 8, s58
  s_lshl_b32 s75, s75, 7
  v_mad_u32_u24 v174, v11, s75, v8
  s_add_u32 m0, s80, 86016
  s_add_u32 s7, s82, s84
  buffer_load_dwordx4 v19, s[32:35], s7 offen lds
  s_mul_i32 s92, s57, 9
  s_add_u32 s92, s92, s58
  s_lshl_b32 s92, s92, 7
  s_add_u32 s92, s92, 8192
  v_and_b32 v8, 63, v0
  v_lshlrev_b32 v8, 4, v8
  v_add_u32 v173, s73, v8
  s_mul_i32 s93, s57, 1152
  s_lshl_b32 s72, s58, 7
  s_add_u32 s93, s93, s72
  s_add_u32 s93, s93, s74
  s_add_u32 m0, s80, 90112
  s_add_u32 s7, s82, s85
  buffer_load_dwordx4 v18, s[32:35], s7 offen lds
  s_mul_i32 s17, s57, 589824
  s_add_u32 s17, s17, 7929856
  v_bfe_u32 v8, v0, 2, 1
  v_cmp_eq_u32 s[74:75], v8, v11
  v_and_b32 v8, 1, v0
  v_mov_b32 v11, 0x3f80
  v_lshlrev_b32 v8, 4, v8
  v_lshlrev_b32 v11, v8, v11
  v_cndmask_b32 v11, 0, v11, s[74:75]
  v_bfe_u32 v8, v0, 1, 1
  v_lshl_add_u32 v8, v9, 1, v8
  s_add_u32 m0, s80, 94208
  s_add_u32 s7, s82, s85
  buffer_load_dwordx4 v19, s[32:35], s7 offen lds
  v_lshl_add_u32 v8, v10, 2, v8
  v_cmp_eq_u32 s[74:75], 0, v8
  v_mov_b32 v184, 0
  v_mov_b32 v185, 0
  v_cndmask_b32 v176, 0, v11, s[74:75]
  v_cmp_eq_u32 s[74:75], 1, v8
  v_mov_b32 v186, 0
  v_mov_b32 v187, 0
  v_cndmask_b32 v177, 0, v11, s[74:75]
  v_cmp_eq_u32 s[74:75], 2, v8
  v_mov_b32 v188, 0
  v_mov_b32 v189, 0
  v_cndmask_b32 v178, 0, v11, s[74:75]
  v_cmp_eq_u32 s[74:75], 3, v8
  v_mov_b32 v190, 0
  v_mov_b32 v191, 0
  v_cndmask_b32 v179, 0, v11, s[74:75]
  v_cmp_eq_u32 s[74:75], 4, v8
  v_mov_b32 v192, 0
  v_mov_b32 v193, 0
  v_cndmask_b32 v180, 0, v11, s[74:75]
  v_cmp_eq_u32 s[74:75], 5, v8
  v_mov_b32 v194, 0
  v_mov_b32 v195, 0
  v_cndmask_b32 v181, 0, v11, s[74:75]
  s_waitcnt vmcnt(6)
  s_barrier
  s_add_u32 m0, s80, 98304
  s_add_u32 s7, s82, s86
  buffer_load_dwordx4 v18, s[32:35], s7 offen lds
  v_cmp_eq_u32 s[74:75], 6, v8
  v_mov_b32 v196, 0
  v_mov_b32 v197, 0
  v_cndmask_b32 v182, 0, v11, s[74:75]
  v_cmp_eq_u32 s[74:75], 7, v8
  v_mov_b32 v198, 0
  v_mov_b32 v199, 0
  v_cndmask_b32 v183, 0, v11, s[74:75]
  s_add_u32 m0, s80, 102400
  s_add_u32 s7, s82, s86
  buffer_load_dwordx4 v19, s[32:35], s7 offen lds
  s_add_u32 m0, s80, 106496
  s_add_u32 s7, s82, s87
  buffer_load_dwordx4 v18, s[32:35], s7 offen lds
  s_add_u32 m0, s80, 110592
  s_add_u32 s7, s82, s87
  buffer_load_dwordx4 v19, s[32:35], s7 offen lds
  s_add_u32 m0, s80, 114688
  s_add_u32 s7, s82, s88
  buffer_load_dwordx4 v18, s[32:35], s7 offen lds
  s_add_u32 m0, s80, 118784
  s_add_u32 s7, s82, s88
  buffer_load_dwordx4 v19, s[32:35], s7 offen lds
  s_waitcnt vmcnt(6)
  s_barrier
  s_add_u32 m0, s80, 122880
  s_add_u32 s7, s82, s89
  buffer_load_dwordx4 v18, s[32:35], s7 offen lds
  v_bfe_u32 v8, v0, 3, 3
  v_and_b32 v9, 7, v0
  v_mul_u32_u24 v8, 36864, v8
  v_lshl_add_u32 v8, v9, 4, v8
  s_mul_i32 s72, s60, 589792
  s_add_u32 s72, s72, s93
  s_lshl_b32 s73, s60, 11
  s_add_u32 m0, s73, 8192
  s_add_u32 s74, s72, 0
  buffer_load_dwordx4 v8, s[24:27], s74 offen lds
  s_add_u32 m0, s80, 126976
  s_add_u32 s7, s82, s89
  buffer_load_dwordx4 v19, s[32:35], s7 offen lds
  s_add_u32 m0, s73, 9216
  s_add_u32 s74, s72, 294912
  buffer_load_dwordx4 v8, s[24:27], s74 offen lds
  s_add_u32 m0, s80, 131072
  s_add_u32 s7, s82, s90
  buffer_load_dwordx4 v18, s[32:35], s7 offen lds
  buffer_load_dwordx2 v[170:171], v169, s[24:27], s18 offen offset:1024
  s_add_u32 m0, s80, 135168
  s_add_u32 s7, s82, s90
  buffer_load_dwordx4 v19, s[32:35], s7 offen lds
  s_add_u32 m0, s80, 139264
  s_add_u32 s7, s82, s91
  buffer_load_dwordx4 v18, s[32:35], s7 offen lds
  s_add_u32 m0, s80, 143360
  s_add_u32 s7, s82, s91
  buffer_load_dwordx4 v19, s[32:35], s7 offen lds
  s_add_u32 s82, s58, 2
  s_and_b32 s82, s82, 7
  s_lshl_b32 s82, s82, 7
  s_add_u32 m0, s80, 24576
  s_add_u32 s7, s82, s83
  buffer_load_dwordx4 v18, s[32:35], s7 offen lds
  s_add_u32 m0, s80, 28672
  s_add_u32 s7, s82, s83
  buffer_load_dwordx4 v19, s[32:35], s7 offen lds
  s_waitcnt vmcnt(11)
  s_barrier
  s_add_u32 m0, s80, 32768
  s_add_u32 s7, s82, s84
  buffer_load_dwordx4 v18, s[32:35], s7 offen lds
  s_add_u32 m0, s80, 36864
  s_add_u32 s7, s82, s84
  buffer_load_dwordx4 v19, s[32:35], s7 offen lds
  s_add_u32 m0, s80, 40960
  s_add_u32 s7, s82, s85
  buffer_load_dwordx4 v18, s[32:35], s7 offen lds
  s_add_u32 m0, s80, 45056
  s_add_u32 s7, s82, s85
  buffer_load_dwordx4 v19, s[32:35], s7 offen lds
  s_add_u32 m0, s80, 73728
  s_add_u32 s7, s82, s86
  buffer_load_dwordx4 v18, s[32:35], s7 offen lds
  s_add_u32 m0, s80, 77824
  s_add_u32 s7, s82, s86
  buffer_load_dwordx4 v19, s[32:35], s7 offen lds
  s_add_u32 m0, s80, 81920
  s_add_u32 s7, s82, s87
  buffer_load_dwordx4 v18, s[32:35], s7 offen lds
  s_add_u32 m0, s80, 86016
  s_add_u32 s7, s82, s87
  buffer_load_dwordx4 v19, s[32:35], s7 offen lds
  s_waitcnt vmcnt(10)
  s_barrier
  s_add_u32 m0, s80, 90112
  s_add_u32 s7, s82, s88
  buffer_load_dwordx4 v18, s[32:35], s7 offen lds
  s_add_u32 m0, s80, 94208
  s_add_u32 s7, s82, s88
  buffer_load_dwordx4 v19, s[32:35], s7 offen lds
  s_add_u32 m0, s80, 98304
  s_add_u32 s7, s82, s89
  buffer_load_dwordx4 v18, s[32:35], s7 offen lds
  s_add_u32 m0, s80, 102400
  s_add_u32 s7, s82, s89
  buffer_load_dwordx4 v19, s[32:35], s7 offen lds
  s_add_u32 m0, s80, 106496
  s_add_u32 s7, s82, s90
  buffer_load_dwordx4 v18, s[32:35], s7 offen lds
  s_add_u32 m0, s80, 110592
  s_add_u32 s7, s82, s90
  buffer_load_dwordx4 v19, s[32:35], s7 offen lds
  s_add_u32 m0, s80, 114688
  s_add_u32 s7, s82, s91
  buffer_load_dwordx4 v18, s[32:35], s7 offen lds
  s_add_u32 m0, s80, 118784
  s_add_u32 s7, s82, s91
  buffer_load_dwordx4 v19, s[32:35], s7 offen lds
  s_waitcnt vmcnt(12)
  s_barrier
  s_add_u32 s82, s58, 3
  s_and_b32 s82, s82, 7
  s_lshl_b32 s82, s82, 7
  s_add_u32 m0, s80, 122880
  s_add_u32 s7, s82, s83
  buffer_load_dwordx4 v18, s[32:35], s7 offen lds
  v_and_b32 v8, 15, v0
  v_bfe_u32 v9, v0, 4, 2
  v_lshlrev_b32 v8, 7, v8
  v_lshl_add_u32 v8, v9, 3, v8
  s_lshl_b32 s72, s60, 5
  s_add_u32 s72, s72, 8192
  v_add_u32 v8, s72, v8
  ds_read_b64 v[216:217], v8 offset:0
  ds_read_b64 v[218:219], v8 offset:2048
  s_add_u32 m0, s80, 126976
  s_add_u32 s7, s82, s83
  buffer_load_dwordx4 v19, s[32:35], s7 offen lds
  ds_read_b64 v[220:221], v8 offset:4096
  ds_read_b64 v[222:223], v8 offset:6144
  s_waitcnt lgkmcnt(0)
  v_lshlrev_b32 v200, 16, v216
  v_and_b32 v201, s71, v216
  v_lshlrev_b32 v202, 16, v217
  v_and_b32 v203, s71, v217
  v_lshlrev_b32 v204, 16, v218
  v_and_b32 v205, s71, v218
  v_lshlrev_b32 v206, 16, v219
  s_add_u32 m0, s80, 131072
  s_add_u32 s7, s82, s84
  buffer_load_dwordx4 v18, s[32:35], s7 offen lds
  v_and_b32 v207, s71, v219
  v_lshlrev_b32 v208, 16, v220
  v_and_b32 v209, s71, v220
  v_lshlrev_b32 v210, 16, v221
  v_and_b32 v211, s71, v221
  v_lshlrev_b32 v212, 16, v222
  v_and_b32 v213, s71, v222
  v_lshlrev_b32 v214, 16, v223
  v_and_b32 v215, s71, v223
  s_add_u32 m0, s80, 135168
  s_add_u32 s7, s82, s84
  buffer_load_dwordx4 v19, s[32:35], s7 offen lds
  s_add_u32 m0, s80, 139264
  s_add_u32 s7, s82, s85
  buffer_load_dwordx4 v18, s[32:35], s7 offen lds
  s_add_u32 m0, s80, 143360
  s_add_u32 s7, s82, s85
  buffer_load_dwordx4 v19, s[32:35], s7 offen lds
  s_waitcnt vmcnt(12)
  s_barrier
  s_add_u32 m0, s80, 24576
  s_add_u32 s7, s82, s86
  buffer_load_dwordx4 v18, s[32:35], s7 offen lds
  s_add_u32 m0, s80, 28672
  s_add_u32 s7, s82, s86
  buffer_load_dwordx4 v19, s[32:35], s7 offen lds
  s_add_u32 m0, s80, 32768
  s_add_u32 s7, s82, s87
  buffer_load_dwordx4 v18, s[32:35], s7 offen lds
  s_add_u32 m0, s80, 36864
  s_add_u32 s7, s82, s87
  buffer_load_dwordx4 v19, s[32:35], s7 offen lds
  s_add_u32 m0, s80, 40960
  s_add_u32 s7, s82, s88
  buffer_load_dwordx4 v18, s[32:35], s7 offen lds
  s_add_u32 m0, s80, 45056
  s_add_u32 s7, s82, s88
  buffer_load_dwordx4 v19, s[32:35], s7 offen lds
  s_waitcnt vmcnt(12)
  s_barrier
  s_add_u32 m0, s80, 73728
  s_add_u32 s7, s82, s89
  buffer_load_dwordx4 v18, s[32:35], s7 offen lds
  s_add_u32 m0, s80, 77824
  s_add_u32 s7, s82, s89
  buffer_load_dwordx4 v19, s[32:35], s7 offen lds
  s_add_u32 m0, s80, 81920
  s_add_u32 s7, s82, s90
  buffer_load_dwordx4 v18, s[32:35], s7 offen lds
  s_add_u32 m0, s80, 86016
  s_add_u32 s7, s82, s90
  buffer_load_dwordx4 v19, s[32:35], s7 offen lds
  s_add_u32 m0, s80, 90112
  s_add_u32 s7, s82, s91
  buffer_load_dwordx4 v18, s[32:35], s7 offen lds
  s_add_u32 m0, s80, 94208
  s_add_u32 s7, s82, s91
  buffer_load_dwordx4 v19, s[32:35], s7 offen lds
  s_waitcnt vmcnt(12)
  s_barrier
  s_add_u32 s82, s58, 4
  s_and_b32 s82, s82, 7
  s_lshl_b32 s82, s82, 7
  s_add_u32 m0, s80, 98304
  s_add_u32 s7, s82, s83
  buffer_load_dwordx4 v18, s[32:35], s7 offen lds
  s_add_u32 m0, s80, 102400
  s_add_u32 s7, s82, s83
  buffer_load_dwordx4 v19, s[32:35], s7 offen lds
  s_add_u32 m0, s80, 106496
  s_add_u32 s7, s82, s84
  buffer_load_dwordx4 v18, s[32:35], s7 offen lds
  s_add_u32 m0, s80, 110592
  s_add_u32 s7, s82, s84
  buffer_load_dwordx4 v19, s[32:35], s7 offen lds
  s_add_u32 m0, s80, 114688
  s_add_u32 s7, s82, s85
  buffer_load_dwordx4 v18, s[32:35], s7 offen lds
  s_add_u32 m0, s80, 118784
  s_add_u32 s7, s82, s85
  buffer_load_dwordx4 v19, s[32:35], s7 offen lds
  s_waitcnt vmcnt(12)
  s_barrier
  s_add_u32 m0, s80, 122880
  s_add_u32 s7, s82, s86
  buffer_load_dwordx4 v18, s[32:35], s7 offen lds
  s_add_u32 m0, s80, 126976
  s_add_u32 s7, s82, s86
  buffer_load_dwordx4 v19, s[32:35], s7 offen lds
  s_add_u32 m0, s80, 131072
  s_add_u32 s7, s82, s87
  buffer_load_dwordx4 v18, s[32:35], s7 offen lds
  s_add_u32 m0, s80, 135168
  s_add_u32 s7, s82, s87
  buffer_load_dwordx4 v19, s[32:35], s7 offen lds
  s_add_u32 m0, s80, 139264
  s_add_u32 s7, s82, s88
  buffer_load_dwordx4 v18, s[32:35], s7 offen lds
  s_add_u32 m0, s80, 143360
  s_add_u32 s7, s82, s88
  buffer_load_dwordx4 v19, s[32:35], s7 offen lds
  s_waitcnt vmcnt(12)
  s_barrier
  s_add_u32 m0, s80, 24576
  s_add_u32 s7, s82, s89
  buffer_load_dwordx4 v18, s[32:35], s7 offen lds
  s_add_u32 m0, s80, 28672
  s_add_u32 s7, s82, s89
  buffer_load_dwordx4 v19, s[32:35], s7 offen lds
  s_add_u32 m0, s80, 32768
  s_add_u32 s7, s82, s90
  buffer_load_dwordx4 v18, s[32:35], s7 offen lds
  s_add_u32 m0, s80, 36864
  s_add_u32 s7, s82, s90
  buffer_load_dwordx4 v19, s[32:35], s7 offen lds
  s_add_u32 m0, s80, 40960
  s_add_u32 s7, s82, s91
  buffer_load_dwordx4 v18, s[32:35], s7 offen lds
  s_add_u32 m0, s80, 45056
  s_add_u32 s7, s82, s91
  buffer_load_dwordx4 v19, s[32:35], s7 offen lds
  s_waitcnt vmcnt(12)
  s_barrier
  s_add_u32 s82, s58, 5
  s_and_b32 s82, s82, 7
  s_lshl_b32 s82, s82, 7
  s_add_u32 m0, s80, 73728
  s_add_u32 s7, s82, s83
  buffer_load_dwordx4 v18, s[32:35], s7 offen lds
  s_add_u32 m0, s80, 77824
  s_add_u32 s7, s82, s83
  buffer_load_dwordx4 v19, s[32:35], s7 offen lds
  s_add_u32 m0, s80, 81920
  s_add_u32 s7, s82, s84
  buffer_load_dwordx4 v18, s[32:35], s7 offen lds
  s_add_u32 m0, s80, 86016
  s_add_u32 s7, s82, s84
  buffer_load_dwordx4 v19, s[32:35], s7 offen lds
  s_add_u32 m0, s80, 90112
  s_add_u32 s7, s82, s85
  buffer_load_dwordx4 v18, s[32:35], s7 offen lds
  s_add_u32 m0, s80, 94208
  s_add_u32 s7, s82, s85
  buffer_load_dwordx4 v19, s[32:35], s7 offen lds
  buffer_load_dword v175, v174, s[36:39], s92 offen sc1
  s_waitcnt vmcnt(13)
  s_barrier
  s_add_u32 m0, s80, 98304
  s_add_u32 s7, s82, s86
  buffer_load_dwordx4 v18, s[32:35], s7 offen lds
  s_add_u32 m0, s80, 102400
  s_add_u32 s7, s82, s86
  buffer_load_dwordx4 v19, s[32:35], s7 offen lds
  s_add_u32 m0, s80, 106496
  s_add_u32 s7, s82, s87
  buffer_load_dwordx4 v18, s[32:35], s7 offen lds
  s_add_u32 m0, s80, 110592
  s_add_u32 s7, s82, s87
  buffer_load_dwordx4 v19, s[32:35], s7 offen lds
  s_add_u32 m0, s80, 114688
  s_add_u32 s7, s82, s88
  buffer_load_dwordx4 v18, s[32:35], s7 offen lds
  s_add_u32 m0, s80, 118784
  s_add_u32 s7, s82, s88
  buffer_load_dwordx4 v19, s[32:35], s7 offen lds
  s_waitcnt vmcnt(13)
  s_barrier
  s_add_u32 m0, s80, 122880
  s_add_u32 s7, s82, s89
  buffer_load_dwordx4 v18, s[32:35], s7 offen lds
  s_add_u32 m0, s80, 126976
  s_add_u32 s7, s82, s89
  buffer_load_dwordx4 v19, s[32:35], s7 offen lds
  s_add_u32 m0, s80, 131072
  s_add_u32 s7, s82, s90
  buffer_load_dwordx4 v18, s[32:35], s7 offen lds
  s_add_u32 m0, s80, 135168
  s_add_u32 s7, s82, s90
  buffer_load_dwordx4 v19, s[32:35], s7 offen lds
  s_add_u32 m0, s80, 139264
  s_add_u32 s7, s82, s91
  buffer_load_dwordx4 v18, s[32:35], s7 offen lds
  s_add_u32 m0, s80, 143360
  s_add_u32 s7, s82, s91
  buffer_load_dwordx4 v19, s[32:35], s7 offen lds
  s_waitcnt vmcnt(13)
  s_barrier
  s_add_u32 s82, s58, 6
  s_and_b32 s82, s82, 7
  s_lshl_b32 s82, s82, 7
  s_add_u32 m0, s80, 24576
  s_add_u32 s7, s82, s83
  buffer_load_dwordx4 v18, s[32:35], s7 offen lds
  s_mov_b32 s22, 0
  s_mov_b32 s23, 0xff
  s_add_u32 m0, s80, 28672
  s_add_u32 s7, s82, s83
  buffer_load_dwordx4 v19, s[32:35], s7 offen lds
  s_add_u32 m0, s80, 32768
  s_add_u32 s7, s82, s84
  buffer_load_dwordx4 v18, s[32:35], s7 offen lds
  s_add_u32 m0, s80, 36864
  s_add_u32 s7, s82, s84
  buffer_load_dwordx4 v19, s[32:35], s7 offen lds
  s_add_u32 m0, s80, 40960
  s_add_u32 s7, s82, s85
  buffer_load_dwordx4 v18, s[32:35], s7 offen lds
  s_add_u32 m0, s80, 45056
  s_add_u32 s7, s82, s85
  buffer_load_dwordx4 v19, s[32:35], s7 offen lds
  s_waitcnt vmcnt(18)
  s_and_b64 s[74:75], s[22:23], exec
  s_mov_b32 s76, 0
L_p0:
  v_cmp_ne_u32 vcc, 0, v175
  s_nop 1
  s_andn2_b64 s[78:79], s[74:75], vcc
  s_cbranch_scc0 L_p0_ok
  s_add_u32 s76, s76, 1
  s_cmp_lt_u32 s76, 32768
  s_cbranch_scc0 L_p0_ok
  s_sleep 8
  buffer_load_dword v175, v174, s[36:39], s92 offen sc1
  s_waitcnt vmcnt(0)
  s_branch L_p0
L_p0_ok:
  s_add_u32 s72, s17, 65536
  buffer_load_dwordx2 v[216:217], v168, s[36:39], s72 offen sc1
  s_add_u32 s72, s72, 147456
  buffer_load_dwordx2 v[218:219], v168, s[36:39], s72 offen sc1
  s_add_u32 s72, s72, 147456
  buffer_load_dwordx2 v[220:221], v168, s[36:39], s72 offen sc1
  s_add_u32 s72, s72, 147456
  buffer_load_dwordx2 v[222:223], v168, s[36:39], s72 offen sc1
  buffer_load_dword v175, v174, s[36:39], s92 offen sc1
  s_waitcnt vmcnt(17)
  s_barrier
  s_add_u32 m0, s80, 73728
  s_add_u32 s7, s82, s86
  buffer_load_dwordx4 v18, s[32:35], s7 offen lds
  s_add_u32 m0, s80, 77824
  s_add_u32 s7, s82, s86
  buffer_load_dwordx4 v19, s[32:35], s7 offen lds
  s_add_u32 m0, s80, 81920
  s_add_u32 s7, s82, s87
  buffer_load_dwordx4 v18, s[32:35], s7 offen lds
  s_add_u32 m0, s80, 86016
  s_add_u32 s7, s82, s87
  buffer_load_dwordx4 v19, s[32:35], s7 offen lds
  s_add_u32 m0, s80, 90112
  s_add_u32 s7, s82, s88
  buffer_load_dwordx4 v18, s[32:35], s7 offen lds
  s_add_u32 m0, s80, 94208
  s_add_u32 s7, s82, s88
  buffer_load_dwordx4 v19, s[32:35], s7 offen lds
  s_waitcnt vmcnt(17)
  s_barrier
  s_add_u32 m0, s80, 98304
  s_add_u32 s7, s82, s89
  buffer_load_dwordx4 v18, s[32:35], s7 offen lds
  s_add_u32 m0, s80, 102400
  s_add_u32 s7, s82, s89
  buffer_load_dwordx4 v19, s[32:35], s7 offen lds
  s_add_u32 m0, s80, 106496
  s_add_u32 s7, s82, s90
  buffer_load_dwordx4 v18, s[32:35], s7 offen lds
  s_add_u32 m0, s80, 110592
  s_add_u32 s7, s82, s90
  buffer_load_dwordx4 v19, s[32:35], s7 offen lds
  s_add_u32 m0, s80, 114688
  s_add_u32 s7, s82, s91
  buffer_load_dwordx4 v18, s[32:35], s7 offen lds
  s_add_u32 m0, s80, 118784
  s_add_u32 s7, s82, s91
  buffer_load_dwordx4 v19, s[32:35], s7 offen lds
  s_waitcnt vmcnt(13)
  v_lshlrev_b32 v224, 16, v216
  v_and_b32 v225, s71, v216
  v_lshlrev_b32 v226, 16, v217
  v_and_b32 v227, s71, v217
  v_lshlrev_b32 v228, 16, v218
  v_and_b32 v229, s71, v218
  v_add_f32 v224, v224, v228
  v_add_f32 v225, v225, v229
  v_lshlrev_b32 v228, 16, v219
  v_and_b32 v229, s71, v219
  v_add_f32 v226, v226, v228
  v_add_f32 v227, v227, v229
  v_lshlrev_b32 v228, 16, v220
  v_and_b32 v229, s71, v220
  v_add_f32 v224, v224, v228
  v_add_f32 v225, v225, v229
  v_lshlrev_b32 v228, 16, v221
  v_and_b32 v229, s71, v221
  v_add_f32 v226, v226, v228
  v_add_f32 v227, v227, v229
  v_lshlrev_b32 v228, 16, v222
  v_and_b32 v229, s71, v222
  v_add_f32 v224, v224, v228
  v_add_f32 v225, v225, v229
  v_lshlrev_b32 v228, 16, v223
  v_and_b32 v229, s71, v223
  v_add_f32 v226, v226, v228
  v_add_f32 v227, v227, v229
  v_mov_b32 v228, v224
  v_mov_b32 v229, v225
  v_mov_b32 v230, v226
  v_mov_b32 v231, v227
  v_permlane32_swap_b32 v228, v224
  v_permlane32_swap_b32 v229, v225
  v_permlane32_swap_b32 v230, v226
  v_permlane32_swap_b32 v231, v227
  v_add_f32 v224, v224, v228
  v_add_f32 v225, v225, v229
  v_add_f32 v226, v226, v230
  v_add_f32 v227, v227, v231
  s_mov_b32 s72, 0x3f317218
  v_lshlrev_b32 v228, 16, v170
  v_and_b32 v229, s71, v170
  v_fma_f32 v228, v224, s72, v228
  v_fma_f32 v229, v225, s72, v229
  v_cvt_pk_bf16_f32 v230, v228, v229
  v_lshlrev_b32 v228, 16, v171
  v_and_b32 v229, s71, v171
  v_fma_f32 v228, v226, s72, v228
  v_fma_f32 v229, v227, s72, v229
  v_cvt_pk_bf16_f32 v231, v228, v229
  s_mov_b64 exec, 0xffffffff
  buffer_store_dwordx2 v[230:231], v169, s[40:43], s18 offen offset:1024
  s_mov_b64 exec, -1
  s_barrier
  s_add_u32 s82, s58, 7
  s_and_b32 s82, s82, 7
  s_lshl_b32 s82, s82, 7
  s_add_u32 m0, s80, 122880
  s_add_u32 s7, s82, s83
  buffer_load_dwordx4 v18, s[32:35], s7 offen lds
  s_add_u32 m0, s80, 126976
  s_add_u32 s7, s82, s83
  buffer_load_dwordx4 v19, s[32:35], s7 offen lds
  s_add_u32 m0, s80, 131072
  s_add_u32 s7, s82, s84
  buffer_load_dwordx4 v18, s[32:35], s7 offen lds
  s_add_u32 m0, s80, 135168
  s_add_u32 s7, s82, s84
  buffer_load_dwordx4 v19, s[32:35], s7 offen lds
  s_add_u32 m0, s80, 139264
  s_add_u32 s7, s82, s85
  buffer_load_dwordx4 v18, s[32:35], s7 offen lds
  s_add_u32 m0, s80, 143360
  s_add_u32 s7, s82, s85
  buffer_load_dwordx4 v19, s[32:35], s7 offen lds
  s_waitcnt vmcnt(13)
  s_barrier
  s_add_u32 m0, s80, 24576
  s_add_u32 s7, s82, s86
  buffer_load_dwordx4 v18, s[32:35], s7 offen lds
  s_add_u32 m0, s80, 28672
  s_add_u32 s7, s82, s86
  buffer_load_dwordx4 v19, s[32:35], s7 offen lds
  s_add_u32 m0, s80, 32768
  s_add_u32 s7, s82, s87
  buffer_load_dwordx4 v18, s[32:35], s7 offen lds
  s_add_u32 m0, s80, 36864
  s_add_u32 s7, s82, s87
  buffer_load_dwordx4 v19, s[32:35], s7 offen lds
  s_add_u32 m0, s80, 40960
  s_add_u32 s7, s82, s88
  buffer_load_dwordx4 v18, s[32:35], s7 offen lds
  s_add_u32 m0, s80, 45056
  s_add_u32 s7, s82, s88
  buffer_load_dwordx4 v19, s[32:35], s7 offen lds
  s_waitcnt vmcnt(13)
  s_barrier
  s_add_u32 m0, s80, 73728
  s_add_u32 s7, s82, s89
  buffer_load_dwordx4 v18, s[32:35], s7 offen lds
  s_add_u32 m0, s80, 77824
  s_add_u32 s7, s82, s89
  buffer_load_dwordx4 v19, s[32:35], s7 offen lds
  s_add_u32 m0, s80, 81920
  s_add_u32 s7, s82, s90
  buffer_load_dwordx4 v18, s[32:35], s7 offen lds
  s_add_u32 m0, s80, 86016
  s_add_u32 s7, s82, s90
  buffer_load_dwordx4 v19, s[32:35], s7 offen lds
  s_add_u32 m0, s80, 90112
  s_add_u32 s7, s82, s91
  buffer_load_dwordx4 v18, s[32:35], s7 offen lds
  s_add_u32 m0, s80, 94208
  s_add_u32 s7, s82, s91
  buffer_load_dwordx4 v19, s[32:35], s7 offen lds
  s_waitcnt vmcnt(12)
  s_barrier
  s_add_u32 s82, s58, 8
  s_and_b32 s82, s82, 7
  s_lshl_b32 s82, s82, 7
  s_add_u32 m0, s80, 98304
  s_add_u32 s7, s82, s83
  buffer_load_dwordx4 v18, s[32:35], s7 offen lds
  s_mov_b32 s22, 0
  s_mov_b32 s23, 0
  s_sub_u32 s72, s56, 1
  s_and_b32 s72, s72, 7
  s_bitset1_b32 s22, s72
  s_sub_u32 s72, s56, 2
  s_and_b32 s72, s72, 7
  s_bitset1_b32 s22, s72
  s_sub_u32 s72, s56, 3
  s_and_b32 s72, s72, 7
  s_bitset1_b32 s22, s72
  s_add_u32 m0, s80, 102400
  s_add_u32 s7, s82, s83
  buffer_load_dwordx4 v19, s[32:35], s7 offen lds
  s_add_u32 m0, s80, 106496
  s_add_u32 s7, s82, s84
  buffer_load_dwordx4 v18, s[32:35], s7 offen lds
  s_add_u32 m0, s80, 110592
  s_add_u32 s7, s82, s84
  buffer_load_dwordx4 v19, s[32:35], s7 offen lds
  s_add_u32 m0, s80, 114688
  s_add_u32 s7, s82, s85
  buffer_load_dwordx4 v18, s[32:35], s7 offen lds
  s_add_u32 m0, s80, 118784
  s_add_u32 s7, s82, s85
  buffer_load_dwordx4 v19, s[32:35], s7 offen lds
  s_and_b64 s[74:75], s[22:23], exec
  s_mov_b32 s76, 0
L_p1:
  v_cmp_ne_u32 vcc, 0, v175
  s_nop 1
  s_andn2_b64 s[78:79], s[74:75], vcc
  s_cbranch_scc0 L_p1_ok
  s_add_u32 s76, s76, 1
  s_cmp_lt_u32 s76, 32768
  s_cbranch_scc0 L_p1_ok
  s_sleep 8
  buffer_load_dword v175, v174, s[36:39], s92 offen sc1
  s_waitcnt vmcnt(0)
  s_branch L_p1
L_p1_ok:
  s_sub_u32 s72, s56, 1
  s_and_b32 s72, s72, 7
  s_mul_i32 s72, s72, 9
  s_add_u32 s72, s72, s58
  s_lshl_b32 s72, s72, 13
  s_add_u32 s72, s72, s17
  s_add_u32 s73, s72, 4096
  buffer_load_dwordx4 v[216:219], v173, s[36:39], s72 offen sc1
  buffer_load_dwordx4 v[220:223], v173, s[36:39], s73 offen sc1
  s_sub_u32 s72, s56, 2
  s_and_b32 s72, s72, 7
  s_mul_i32 s72, s72, 9
  s_add_u32 s72, s72, s58
  s_lshl_b32 s72, s72, 13
  s_add_u32 s72, s72, s17
  s_add_u32 s73, s72, 4096
  buffer_load_dwordx4 v[224:227], v173, s[36:39], s72 offen sc1
  buffer_load_dwordx4 v[228:231], v173, s[36:39], s73 offen sc1
  s_sub_u32 s72, s56, 3
  s_and_b32 s72, s72, 7
  s_mul_i32 s72, s72, 9
  s_add_u32 s72, s72, s58
  s_lshl_b32 s72, s72, 13
  s_add_u32 s72, s72, s17
  s_add_u32 s73, s72, 4096
  buffer_load_dwordx4 v[232:235], v173, s[36:39], s72 offen sc1
  buffer_load_dwordx4 v[236:239], v173, s[36:39], s73 offen sc1
  s_waitcnt vmcnt(18)
  s_barrier
  s_add_u32 m0, s80, 122880
  s_add_u32 s7, s82, s86
  buffer_load_dwordx4 v18, s[32:35], s7 offen lds
  s_add_u32 m0, s80, 126976
  s_add_u32 s7, s82, s86
  buffer_load_dwordx4 v19, s[32:35], s7 offen lds
  s_add_u32 m0, s80, 131072
  s_add_u32 s7, s82, s87
  buffer_load_dwordx4 v18, s[32:35], s7 offen lds
  s_add_u32 m0, s80, 135168
  s_add_u32 s7, s82, s87
  buffer_load_dwordx4 v19, s[32:35], s7 offen lds
  s_add_u32 m0, s80, 139264
  s_add_u32 s7, s82, s88
  buffer_load_dwordx4 v18, s[32:35], s7 offen lds
  s_add_u32 m0, s80, 143360
  s_add_u32 s7, s82, s88
  buffer_load_dwordx4 v19, s[32:35], s7 offen lds
  buffer_load_dword v175, v174, s[36:39], s92 offen sc1
  s_waitcnt vmcnt(19)
  s_barrier
  s_add_u32 m0, s80, 24576
  s_add_u32 s7, s82, s89
  buffer_load_dwordx4 v18, s[32:35], s7 offen lds
  s_add_u32 m0, s80, 28672
  s_add_u32 s7, s82, s89
  buffer_load_dwordx4 v19, s[32:35], s7 offen lds
  s_add_u32 m0, s80, 32768
  s_add_u32 s7, s82, s90
  buffer_load_dwordx4 v18, s[32:35], s7 offen lds
  s_add_u32 m0, s80, 36864
  s_add_u32 s7, s82, s90
  buffer_load_dwordx4 v19, s[32:35], s7 offen lds
  s_add_u32 m0, s80, 40960
  s_add_u32 s7, s82, s91
  buffer_load_dwordx4 v18, s[32:35], s7 offen lds
  s_add_u32 m0, s80, 45056
  s_add_u32 s7, s82, s91
  buffer_load_dwordx4 v19, s[32:35], s7 offen lds
  s_waitcnt vmcnt(17)
  v_mfma_f32_16x16x32_bf16 v[184:187], v[176:179], v[216:219], v[184:187]
  v_mfma_f32_16x16x32_bf16 v[188:191], v[180:183], v[216:219], v[188:191]
  v_mfma_f32_16x16x32_bf16 v[192:195], v[176:179], v[220:223], v[192:195]
  v_mfma_f32_16x16x32_bf16 v[196:199], v[180:183], v[220:223], v[196:199]
  s_waitcnt vmcnt(15)
  v_mfma_f32_16x16x32_bf16 v[184:187], v[176:179], v[224:227], v[184:187]
  v_mfma_f32_16x16x32_bf16 v[188:191], v[180:183], v[224:227], v[188:191]
  v_mfma_f32_16x16x32_bf16 v[192:195], v[176:179], v[228:231], v[192:195]
  v_mfma_f32_16x16x32_bf16 v[196:199], v[180:183], v[228:231], v[196:199]
  s_waitcnt vmcnt(13)
  v_mfma_f32_16x16x32_bf16 v[184:187], v[176:179], v[232:235], v[184:187]
  v_mfma_f32_16x16x32_bf16 v[188:191], v[180:183], v[232:235], v[188:191]
  v_mfma_f32_16x16x32_bf16 v[192:195], v[176:179], v[236:239], v[192:195]
  v_mfma_f32_16x16x32_bf16 v[196:199], v[180:183], v[236:239], v[196:199]
  s_barrier
  s_waitcnt vmcnt(7)
  s_barrier
  s_mov_b32 s22, 0
  s_mov_b32 s23, 0
  s_sub_u32 s72, s56, 4
  s_and_b32 s72, s72, 7
  s_bitset1_b32 s22, s72
  s_sub_u32 s72, s56, 5
  s_and_b32 s72, s72, 7
  s_bitset1_b32 s22, s72
  s_waitcnt vmcnt(6)
  s_and_b64 s[74:75], s[22:23], exec
  s_mov_b32 s76, 0
L_p2:
  v_cmp_ne_u32 vcc, 0, v175
  s_nop 1
  s_andn2_b64 s[78:79], s[74:75], vcc
  s_cbranch_scc0 L_p2_ok
  s_add_u32 s76, s76, 1
  s_cmp_lt_u32 s76, 32768
  s_cbranch_scc0 L_p2_ok
  s_sleep 8
  buffer_load_dword v175, v174, s[36:39], s92 offen sc1
  s_waitcnt vmcnt(0)
  s_branch L_p2
L_p2_ok:
  s_sub_u32 s72, s56, 4
  s_and_b32 s72, s72, 7
  s_mul_i32 s72, s72, 9
  s_add_u32 s72, s72, s58
  s_lshl_b32 s72, s72, 13
  s_add_u32 s72, s72, s17
  s_add_u32 s73, s72, 4096
  buffer_load_dwordx4 v[216:219], v173, s[36:39], s72 offen sc1
  buffer_load_dwordx4 v[220:223], v173, s[36:39], s73 offen sc1
  s_sub_u32 s72, s56, 5
  s_and_b32 s72, s72, 7
  s_mul_i32 s72, s72, 9
  s_add_u32 s72, s72, s58
  s_lshl_b32 s72, s72, 13
  s_add_u32 s72, s72, s17
  s_add_u32 s73, s72, 4096
  buffer_load_dwordx4 v[224:227], v173, s[36:39], s72 offen sc1
  buffer_load_dwordx4 v[228:231], v173, s[36:39], s73 offen sc1
  s_add_u32 s21, s93, 1179648
  s_mov_b32 s100, 0x3f317218
  s_waitcnt vmcnt(4)
  s_barrier
  s_waitcnt vmcnt(2)
  v_mfma_f32_16x16x32_bf16 v[184:187], v[176:179], v[216:219], v[184:187]
  v_mfma_f32_16x16x32_bf16 v[188:191], v[180:183], v[216:219], v[188:191]
  v_mfma_f32_16x16x32_bf16 v[192:195], v[176:179], v[220:223], v[192:195]
  v_mfma_f32_16x16x32_bf16 v[196:199], v[180:183], v[220:223], v[196:199]
  s_waitcnt vmcnt(0)
  v_mfma_f32_16x16x32_bf16 v[184:187], v[176:179], v[224:227], v[184:187]
  v_mfma_f32_16x16x32_bf16 v[188:191], v[180:183], v[224:227], v[188:191]
  v_mfma_f32_16x16x32_bf16 v[192:195], v[176:179], v[228:231], v[192:195]
  v_mfma_f32_16x16x32_bf16 v[196:199], v[180:183], v[228:231], v[196:199]
  buffer_load_dword v175, v174, s[36:39], s92 offen sc1
  s_mov_b32 s22, 0
  s_mov_b32 s23, 0
  s_sub_u32 s72, s56, 6
  s_and_b32 s72, s72, 7
  s_bitset1_b32 s22, s72
  s_sub_u32 s72, s56, 7
  s_and_b32 s72, s72, 7
  s_bitset1_b32 s22, s72
  s_waitcnt vmcnt(0)
  s_and_b64 s[74:75], s[22:23], exec
  s_mov_b32 s76, 0
L_late:
  v_cmp_ne_u32 vcc, 0, v175
  s_nop 1
  s_andn2_b64 s[78:79], s[74:75], vcc
  s_cbranch_scc0 L_late_ok
  s_add_u32 s76, s76, 1
  s_cmp_lt_u32 s76, 32768
  s_cbranch_scc0 L_late_ok
  s_sleep 2
  buffer_load_dword v175, v174, s[36:39], s92 offen sc1
  s_waitcnt vmcnt(0)
  s_branch L_late
L_late_ok:
  s_sub_u32 s72, s56, 6
  s_and_b32 s72, s72, 7
  s_mul_i32 s72, s72, 9
  s_add_u32 s72, s72, s58
  s_lshl_b32 s72, s72, 13
  s_add_u32 s72, s72, s17
  s_add_u32 s73, s72, 4096
  buffer_load_dwordx4 v[216:219], v173, s[36:39], s72 offen sc1
  buffer_load_dwordx4 v[220:223], v173, s[36:39], s73 offen sc1
  s_sub_u32 s72, s56, 7
  s_and_b32 s72, s72, 7
  s_mul_i32 s72, s72, 9
  s_add_u32 s72, s72, s58
  s_lshl_b32 s72, s72, 13
  s_add_u32 s72, s72, s17
  s_add_u32 s73, s72, 4096
  buffer_load_dwordx4 v[224:227], v173, s[36:39], s72 offen sc1
  buffer_load_dwordx4 v[228:231], v173, s[36:39], s73 offen sc1
  s_barrier
  ds_read_b128 v[232:235], v173 offset:0
  ds_read_b128 v[236:239], v173 offset:4096
  s_waitcnt lgkmcnt(0)
  v_mfma_f32_16x16x32_bf16 v[184:187], v[176:179], v[232:235], v[184:187]
  v_mfma_f32_16x16x32_bf16 v[188:191], v[180:183], v[232:235], v[188:191]
  v_mfma_f32_16x16x32_bf16 v[192:195], v[176:179], v[236:239], v[192:195]
  v_mfma_f32_16x16x32_bf16 v[196:199], v[180:183], v[236:239], v[196:199]
  s_waitcnt vmcnt(2)
  v_mfma_f32_16x16x32_bf16 v[184:187], v[176:179], v[216:219], v[184:187]
  v_mfma_f32_16x16x32_bf16 v[188:191], v[180:183], v[216:219], v[188:191]
  v_mfma_f32_16x16x32_bf16 v[192:195], v[176:179], v[220:223], v[192:195]
  v_mfma_f32_16x16x32_bf16 v[196:199], v[180:183], v[220:223], v[196:199]
  s_waitcnt vmcnt(0)
  v_mfma_f32_16x16x32_bf16 v[184:187], v[176:179], v[224:227], v[184:187]
  v_mfma_f32_16x16x32_bf16 v[188:191], v[180:183], v[224:227], v[188:191]
  v_mfma_f32_16x16x32_bf16 v[192:195], v[176:179], v[228:231], v[192:195]
  v_mfma_f32_16x16x32_bf16 v[196:199], v[180:183], v[228:231], v[196:199]
  s_nop 4
  v_fma_f32 v200, v184, s100, v200
  v_fma_f32 v201, v185, s100, v201
  v_cvt_pk_bf16_f32 v232, v200, v201
  v_fma_f32 v202, v186, s100, v202
  v_fma_f32 v203, v187, s100, v203
  v_cvt_pk_bf16_f32 v233, v202, v203
  v_fma_f32 v204, v188, s100, v204
  v_fma_f32 v205, v189, s100, v205
  v_cvt_pk_bf16_f32 v234, v204, v205
  v_fma_f32 v206, v190, s100, v206
  v_fma_f32 v207, v191, s100, v207
  v_cvt_pk_bf16_f32 v235, v206, v207
  v_permlane16_swap_b32 v232, v234
  s_nop 0
  v_permlane16_swap_b32 v233, v235
  buffer_store_dwordx4 v[232:235], v172, s[40:43], s93 offen
  v_fma_f32 v208, v192, s100, v208
  v_fma_f32 v209, v193, s100, v209
  v_cvt_pk_bf16_f32 v236, v208, v209
  v_fma_f32 v210, v194, s100, v210
  v_fma_f32 v211, v195, s100, v211
  v_cvt_pk_bf16_f32 v237, v210, v211
  v_fma_f32 v212, v196, s100, v212
  v_fma_f32 v213, v197, s100, v213
  v_cvt_pk_bf16_f32 v238, v212, v213
  v_fma_f32 v214, v198, s100, v214
  v_fma_f32 v215, v199, s100, v215
  v_cvt_pk_bf16_f32 v239, v214, v215
  v_permlane16_swap_b32 v236, v238
  s_nop 0
  v_permlane16_swap_b32 v237, v239
  buffer_store_dwordx4 v[236:239], v172, s[40:43], s21 offen
  s_endpgm
L_end:
  s_endpgm
.section .rodata,"a"
.p2align 6
.amdhsa_kernel parallel_sum__spectral_gfnet__dense_activation_silu__prompt_kernel
  .amdhsa_next_free_vgpr 256
  .amdhsa_next_free_sgpr 102
  .amdhsa_accum_offset 256
  .amdhsa_group_segment_fixed_size 0
  .amdhsa_kernarg_size 72
  .amdhsa_user_sgpr_count 2
  .amdhsa_user_sgpr_kernarg_segment_ptr 1
  .amdhsa_system_sgpr_workgroup_id_x 1
  .amdhsa_float_denorm_mode_32 3
.end_amdhsa_kernel
```
